```python
import torch

def _softmax(x, axis=-1):
    return torch.softmax(x, dim=axis)
def _gelu(x):
    return torch.nn.functional.gelu(x, approximate="tanh")
def _silu(x):
    return torch.nn.functional.silu(x)
def _sigmoid(x):
    return torch.sigmoid(x)
def _layernorm(x, axis=-1, eps=1e-5):
    m = x.mean(dim=axis, keepdim=True)
    v = x.var(dim=axis, keepdim=True, unbiased=False)
    return (x - m) / torch.sqrt(v + eps)
def _scatter_add(tgt, idx, src, axis=0):
    return tgt.clone().index_add_(axis, idx, src)
def _segment_sum(src, seg, n):
    out = torch.zeros((n,) + src.shape[1:], dtype=src.dtype)
    return out.index_add_(0, seg, src)
def _pad(x, pw):
    flat = tuple(v for pair in reversed(pw) for v in pair)
    return torch.nn.functional.pad(x, flat)

kernel_name = 'concat_heads__mha_block_cached__mha_block_cached__near_ridge'

def setup_inputs():

    _w = (lambda a: (lambda t: t.to(torch.bfloat16) if t.is_floating_point() else t)(torch.as_tensor(a)))
    def _A_setup():
        B, Sq, D = 32, 32, 576
        H, Sk, Dh = 32, 32, 128
        return {
            "x": _w((lambda *s: torch.randn(*s, dtype=torch.bfloat16) * 0.8)(B, Sq, D)),
            "k_cache": _w((lambda *s: torch.randn(*s, dtype=torch.bfloat16) * 0.8)(B, H, Sk, Dh)),
            "v_cache": _w((lambda *s: torch.randn(*s, dtype=torch.bfloat16) * 0.05)(B, H, Sk, Dh)),
            "wq": _w((lambda *s: torch.randn(*s, dtype=torch.bfloat16) * 0.8)(D, H * Dh) * (D ** -0.5)),
            "wo": _w((lambda *s: torch.randn(*s, dtype=torch.bfloat16) * 0.05)(H * Dh, D) * ((H * Dh) ** -0.5)),
        }
    _A_in = _A_setup()

    def _B_setup():
        B, Sq, D = 32, 32, 576
        H, Sk, Dh = 32, 32, 128
        return {
            "x": _w((lambda *s: torch.randn(*s, dtype=torch.bfloat16) * 0.8)(B, Sq, D)),
            "k_cache": _w((lambda *s: torch.randn(*s, dtype=torch.bfloat16) * 0.8)(B, H, Sk, Dh)),
            "v_cache": _w((lambda *s: torch.randn(*s, dtype=torch.bfloat16) * 0.05)(B, H, Sk, Dh)),
            "wq": _w((lambda *s: torch.randn(*s, dtype=torch.bfloat16) * 0.8)(D, H * Dh) * (D ** -0.5)),
            "wo": _w((lambda *s: torch.randn(*s, dtype=torch.bfloat16) * 0.05)(H * Dh, D) * ((H * Dh) ** -0.5)),
        }
    _B_in = _B_setup()

    return {
        "A_x": _A_in["x"],
        "A_k_cache": _A_in["k_cache"],
        "A_v_cache": _A_in["v_cache"],
        "A_wq": _A_in["wq"],
        "A_wo": _A_in["wo"],
        "B_x": _B_in["x"],
        "B_k_cache": _B_in["k_cache"],
        "B_v_cache": _B_in["v_cache"],
        "B_wq": _B_in["wq"],
        "B_wo": _B_in["wo"],
    }

def reference(A_x, A_k_cache, A_v_cache, A_wq, A_wo, B_x, B_k_cache, B_v_cache, B_wq, B_wo):
    def _A_ref(x, k_cache, v_cache, wq, wo):
        B, Sq, D = x.shape
        H, Dh = 32, 128
        q = (lambda x, *d: x.permute(*d))((x @ wq).reshape(B, Sq, H, Dh), 0, 2, 1, 3)
        scores = torch.einsum("bhqd,bhkd->bhqk", q, k_cache) * (Dh ** -0.5)
        p = _softmax(scores, axis=-1)
        o = torch.einsum("bhqk,bhkd->bhqd", p, v_cache)
        return (lambda x, *d: x.permute(*d))(o, 0, 2, 1, 3).reshape(B, Sq, H * Dh) @ wo

    def _B_ref(x, k_cache, v_cache, wq, wo):
        B, Sq, D = x.shape
        H, Dh = 32, 128
        q = (lambda x, *d: x.permute(*d))((x @ wq).reshape(B, Sq, H, Dh), 0, 2, 1, 3)
        scores = torch.einsum("bhqd,bhkd->bhqk", q, k_cache) * (Dh ** -0.5)
        p = _softmax(scores, axis=-1)
        o = torch.einsum("bhqk,bhkd->bhqd", p, v_cache)
        return (lambda x, *d: x.permute(*d))(o, 0, 2, 1, 3).reshape(B, Sq, H * Dh) @ wo

    a = _A_ref(A_x, A_k_cache, A_v_cache, A_wq, A_wo)
    b = _B_ref(B_x, B_k_cache, B_v_cache, B_wq, B_wo)
    return torch.concatenate([a, b], axis=-1)
```

```asm
; @launch grid=(256,1,1) block=(512,1,1) lds=163840
.amdgcn_target "amdgcn-amd-amdhsa--gfx950"
.text
.globl concat_heads__mha_block_cached__mha_block_cached__near_ridge_kernel
.p2align 8
.type concat_heads__mha_block_cached__mha_block_cached__near_ridge_kernel,@function
concat_heads__mha_block_cached__mha_block_cached__near_ridge_kernel:
    s_cmp_ge_u32 s2, 256
    s_cbranch_scc1 L_end
    s_load_dwordx16 s[16:31], s[0:1], 0
    s_load_dwordx8 s[32:39], s[0:1], 64
    s_load_dwordx2 s[40:41], s[0:1], 96
    v_lshrrev_b32 v2, 6, v0
    v_and_b32 v1, 63, v0
    v_readfirstlane_b32 s4, v2
    s_and_b32 s3, s2, 7
    s_lshr_b32 s5, s3, 2
    s_and_b32 s6, s2, 3
    s_lshr_b32 s7, s2, 5
    s_bfe_u32 s8, s2, 0x20003
    s_and_b32 s9, s4, 3
    s_lshl_b32 s10, s7, 2
    s_add_u32 s10, s10, s9
    s_cmp_lt_u32 s4, 4
    s_cbranch_scc1 L_compute
    v_lshrrev_b32 v20, 3, v1
    v_mul_u32_u24 v20, 1152, v20
    v_and_b32 v21, 7, v1
    v_lshrrev_b32 v22, 4, v1
    v_xor_b32 v21, v21, v22
    v_lshlrev_b32 v21, 4, v21
    v_add_u32 v160, v20, v21
    v_xor_b32 v21, 64, v21
    v_add_u32 v161, v20, v21
    v_add_u32 v162, 16384, v160
    v_add_u32 v163, 24576, v161
    v_add_u32 v161, 8192, v161
    v_bfe_u32 v23, v1, 2, 2
    v_lshlrev_b32 v21, 6, v22
    v_lshl_add_u32 v20, v23, 13, v21
    v_and_b32 v21, 3, v1
    v_lshl_add_u32 v4, v21, 4, v20
    v_add_u32 v5, 31744, v4
    v_xor_b32 v7, 32, v4
    v_add_u32 v6, 63488, v7
    v_add_u32 v7, 95232, v7
    v_lshlrev_b32 v20, 2, v1
    s_lshl_b32 s94, s8, 0
    s_add_u32 s94, s94, s7
    s_and_b32 s94, s94, 3
    s_mul_i32 s94, s94, 2
    s_lshr_b32 s12, s9, 1
    s_lshl_b32 s3, s6, 3
    s_lshl_b32 s11, s8, 1
    s_add_u32 s3, s3, s11
    s_add_u32 s3, s3, s12
    s_lshl_b32 s3, s3, 8
    s_and_b32 s11, s9, 1
    s_lshl_b32 s11, s11, 17
    s_add_u32 s3, s3, s11
    s_sub_u32 s58, 4718592, s3
    s_mov_b32 s59, 0x00020000
    s_mul_i32 s11, s10, 36864
    s_mov_b32 s98, 36864
    s_mov_b32 s99, 0x00020000
    s_lshl_b32 s12, s2, 8
    s_add_u32 s12, s12, 42991616
    s_lshl_b32 s88, s9, 12
    s_cmp_eq_u32 s5, 0
    s_waitcnt lgkmcnt(0)
    s_cselect_b64 s[44:45], s[16:17], s[26:27]
    s_cselect_b64 s[50:51], s[22:23], s[32:33]
    s_cselect_b64 s[46:47], s[18:19], s[28:29]
    s_cselect_b64 s[48:49], s[20:21], s[30:31]
    s_cselect_b64 s[52:53], s[24:25], s[34:35]
    s_add_u32 s96, s44, s11
    s_addc_u32 s97, s45, 0
    s_add_u32 s56, s50, s3
    s_addc_u32 s57, s51, 0
    s_add_u32 s20, s40, s12
    s_addc_u32 s21, s41, 0
    s_mov_b32 s22, 256
    s_mov_b32 s23, 0x00020000
    buffer_store_dword v1, v20, s[20:23], 0 offen sc1
    s_add_u32 m0, s88, 16384
    s_mov_b32 s15, 0
    s_mov_b32 s13, 0
    buffer_load_dwordx4 v160, s[96:99], s15 offen offset:0  lds
    buffer_load_dwordx4 v161, s[96:99], s15 offen offset:1024  lds
    buffer_load_dwordx4 v162, s[96:99], s15 offen offset:2048  lds
    buffer_load_dwordx4 v163, s[96:99], s15 offen offset:3072  lds
    s_add_u32 m0, s88, 0
    s_nop 0
    buffer_load_dwordx4 v4, s[56:59], s13 offen offset:0  lds
    buffer_load_dwordx4 v5, s[56:59], s13 offen offset:1024  lds
    buffer_load_dwordx4 v6, s[56:59], s13 offen offset:2048  lds
    buffer_load_dwordx4 v7, s[56:59], s13 offen offset:3072  lds
    v_mul_u32_u24 v26, 260, v21
    v_add_u32 v26, 148480, v26
    s_lshl_b32 s24, s9, 8
    s_add_u32 s24, s24, 147456
    v_lshl_add_u32 v27, v1, 2, s24
    s_barrier
    s_waitcnt vmcnt(8)
    s_mov_b32 m0, s24
    s_mov_b32 s11, 4
    buffer_load_dword off, s[20:23], s11 lds
    s_add_u32 m0, s88, 32768
    s_add_u32 s13, s13, 262144
    buffer_load_dwordx4 v4, s[56:59], s13 offen offset:0  lds
    buffer_load_dwordx4 v5, s[56:59], s13 offen offset:1024  lds
    buffer_load_dwordx4 v6, s[56:59], s13 offen offset:2048  lds
    buffer_load_dwordx4 v7, s[56:59], s13 offen offset:3072  lds
    s_mov_b32 m0, s24
    s_mov_b32 s11, 8
    buffer_load_dword off, s[20:23], s11 lds
    s_add_u32 m0, s88, 98304
    s_add_u32 s94, s94, 1
    s_lshl_b32 s15, s94, 7
    s_lshl_b32 s13, s94, 19
    s_and_b32 s94, s94, 7
    buffer_load_dwordx4 v160, s[96:99], s15 offen offset:0  lds
    buffer_load_dwordx4 v161, s[96:99], s15 offen offset:1024  lds
    buffer_load_dwordx4 v162, s[96:99], s15 offen offset:2048  lds
    buffer_load_dwordx4 v163, s[96:99], s15 offen offset:3072  lds
    s_add_u32 m0, s88, 81920
    s_nop 0
    buffer_load_dwordx4 v4, s[56:59], s13 offen offset:0  lds
    buffer_load_dwordx4 v5, s[56:59], s13 offen offset:1024  lds
    buffer_load_dwordx4 v6, s[56:59], s13 offen offset:2048  lds
    buffer_load_dwordx4 v7, s[56:59], s13 offen offset:3072  lds
    s_mov_b32 m0, s24
    s_mov_b32 s11, 12
    buffer_load_dword off, s[20:23], s11 lds
    s_add_u32 m0, s88, 49152
    s_add_u32 s13, s13, 262144
    buffer_load_dwordx4 v4, s[56:59], s13 offen offset:0  lds
    buffer_load_dwordx4 v5, s[56:59], s13 offen offset:1024  lds
    buffer_load_dwordx4 v6, s[56:59], s13 offen offset:2048  lds
    buffer_load_dwordx4 v7, s[56:59], s13 offen offset:3072  lds
    s_mov_b32 m0, s24
    s_mov_b32 s11, 16
    buffer_load_dword off, s[20:23], s11 lds
    s_lshl_b32 s3, s10, 5
    s_lshl_b32 s11, s6, 3
    s_add_u32 s3, s3, s11
    s_lshl_b32 s12, s3, 13
    s_add_u32 s64, s48, s12
    s_addc_u32 s65, s49, 0
    s_mov_b32 s66, 65536
    s_mov_b32 s67, 0x00020000
    s_lshl_b32 s11, s8, 14
    s_add_u32 s12, s12, s11
    s_add_u32 s60, s46, s12
    s_addc_u32 s61, s47, 0
    s_mov_b32 s62, 16384
    s_mov_b32 s63, 0x00020000
    v_and_b32 v20, 15, v1
    v_xor_b32 v20, v20, v22
    v_lshlrev_b32 v20, 4, v20
    v_lshl_add_u32 v8, v22, 8, v20
    v_xor_b32 v9, 64, v8
    v_xor_b32 v10, 0x80, v8
    v_xor_b32 v11, 0xc0, v8
    s_lshl_b32 s84, s9, 13
    s_lshl_b32 s85, s9, 10
    s_add_u32 s3, s84, 81920
    v_lshl_add_u32 v19, v1, 4, s3
    s_add_u32 s3, s88, 98304
    v_lshl_add_u32 v18, v1, 4, s3
    v_lshrrev_b32 v20, 3, v1
    v_and_b32 v164, 7, v1
    v_xor_b32 v164, v164, v22
    v_lshlrev_b32 v164, 4, v164
    v_lshl_add_u32 v164, v20, 8, v164
    v_xor_b32 v165, 64, v164
    v_add_u32 v166, 2048, v164
    v_add_u32 v167, 3072, v165
    v_add_u32 v165, 1024, v165
    s_mul_i32 s3, s6, 1179648
    s_add_u32 s72, s52, s3
    s_addc_u32 s73, s53, 0
    s_mov_b32 s74, 1179648
    s_mov_b32 s75, 0x00020000
    s_mul_i32 s11, s9, 36864
    s_add_u32 s3, s3, s11
    s_lshl_b32 s11, s8, 8
    s_add_u32 s3, s3, s11
    s_sub_u32 s12, 4718592, s3
    s_add_u32 s68, s52, s3
    s_addc_u32 s69, s53, 0
    s_mov_b32 s70, s12
    s_mov_b32 s71, 0x00020000
    s_and_b32 s3, s6, 2
    v_xor_b32 v20, s3, v22
    v_mul_u32_u24 v23, 1152, v23
    v_lshl_add_u32 v23, v20, 6, v23
    v_lshl_add_u32 v13, v21, 4, v23
    v_add_u32 v14, 3584, v13
    v_xor_b32 v16, 32, v13
    v_add_u32 v15, 7168, v16
    v_add_u32 v16, 10752, v16
    v_bfe_u32 v20, v1, 1, 2
    v_bfe_u32 v21, v1, 3, 1
    v_lshl_add_u32 v20, v21, 3, v20
    v_bfe_u32 v21, v1, 4, 1
    v_lshl_add_u32 v20, v21, 2, v20
    v_bfe_u32 v22, v1, 5, 1
    v_lshl_add_u32 v20, v22, 4, v20
    v_mul_u32_u24 v20, 1152, v20
    v_and_b32 v22, 1, v1
    v_lshl_add_u32 v20, v22, 4, v20
    s_mul_i32 s3, s8, 224
    s_sub_u32 s3, 1024, s3
    v_add_u32 v17, s3, v20
    s_lshl_b32 s3, s7, 4
    v_and_b32 v20, 15, v1
    v_add_u32 v20, s3, v20
    v_mul_u32_u24 v20, 1152, v20
    v_lshl_add_u32 v21, v21, 7, s11
    v_add_u32 v31, v20, v21
    v_mov_b32 v22, 1024
    v_cmp_gt_u32 vcc, 32, v1
    s_nop 1
    v_cndmask_b32 v21, v22, v21, vcc
    v_add_u32 v25, v20, v21
    s_add_u32 s3, s8, 0
    s_and_b32 s3, s3, 3
    s_lshl_b32 s3, s3, 1
    s_mul_i32 s76, s3, 147456
    s_mul_i32 s25, s3, 8192
    s_add_u32 s3, s3, 1
    s_mul_i32 s77, s3, 147456
    s_mul_i32 s26, s3, 8192
    s_add_u32 s3, s8, 1
    s_and_b32 s3, s3, 3
    s_lshl_b32 s3, s3, 1
    s_mul_i32 s78, s3, 147456
    s_mul_i32 s27, s3, 8192
    s_add_u32 s3, s3, 1
    s_mul_i32 s79, s3, 147456
    s_mul_i32 s28, s3, 8192
    s_add_u32 s3, s8, 2
    s_and_b32 s3, s3, 3
    s_lshl_b32 s3, s3, 1
    s_mul_i32 s80, s3, 147456
    s_mul_i32 s29, s3, 8192
    s_add_u32 s3, s3, 1
    s_mul_i32 s81, s3, 147456
    s_mul_i32 s30, s3, 8192
    s_add_u32 s3, s8, 3
    s_and_b32 s3, s3, 3
    s_lshl_b32 s3, s3, 1
    s_mul_i32 s82, s3, 147456
    s_mul_i32 s31, s3, 8192
    s_add_u32 s3, s3, 1
    s_mul_i32 s83, s3, 147456
    s_mul_i32 s32, s3, 8192
    s_and_b32 s3, s7, 1
    s_cmp_eq_u32 s3, 1
    s_cbranch_scc1 L_hv1
    s_add_u32 m0, s88, 131072
    s_add_u32 s94, s94, 1
    s_lshl_b32 s15, s94, 7
    s_lshl_b32 s13, s94, 19
    s_and_b32 s94, s94, 7
    buffer_load_dwordx4 v160, s[96:99], s15 offen offset:0  lds
    buffer_load_dwordx4 v161, s[96:99], s15 offen offset:1024  lds
    buffer_load_dwordx4 v162, s[96:99], s15 offen offset:2048  lds
    buffer_load_dwordx4 v163, s[96:99], s15 offen offset:3072  lds
    s_add_u32 m0, s88, 65536
    s_nop 0
    buffer_load_dwordx4 v4, s[56:59], s13 offen offset:0  lds
    buffer_load_dwordx4 v5, s[56:59], s13 offen offset:1024  lds
    buffer_load_dwordx4 v6, s[56:59], s13 offen offset:2048  lds
    buffer_load_dwordx4 v7, s[56:59], s13 offen offset:3072  lds
    s_mov_b32 m0, s24
    s_mov_b32 s11, 20
    buffer_load_dword off, s[20:23], s11 lds
    ds_read_b32 v29, v26
    s_add_u32 m0, s88, 114688
    s_add_u32 s13, s13, 262144
    buffer_load_dwordx4 v4, s[56:59], s13 offen offset:0  lds
    buffer_load_dwordx4 v5, s[56:59], s13 offen offset:1024  lds
    buffer_load_dwordx4 v6, s[56:59], s13 offen offset:2048  lds
    buffer_load_dwordx4 v7, s[56:59], s13 offen offset:3072  lds
    s_mov_b32 m0, s24
    s_mov_b32 s11, 24
    buffer_load_dword off, s[20:23], s11 lds
    s_waitcnt lgkmcnt(0)
    v_cmp_gt_u32 vcc, 2, v29
    s_cbranch_vccnz L_fs1
L_fo1:
    s_add_u32 m0, s88, 16384
    s_add_u32 s94, s94, 1
    s_lshl_b32 s15, s94, 7
    s_lshl_b32 s13, s94, 19
    s_and_b32 s94, s94, 7
    buffer_load_dwordx4 v160, s[96:99], s15 offen offset:0  lds
    buffer_load_dwordx4 v161, s[96:99], s15 offen offset:1024  lds
    buffer_load_dwordx4 v162, s[96:99], s15 offen offset:2048  lds
    buffer_load_dwordx4 v163, s[96:99], s15 offen offset:3072  lds
    s_add_u32 m0, s88, 0
    s_nop 0
    buffer_load_dwordx4 v4, s[56:59], s13 offen offset:0  lds
    buffer_load_dwordx4 v5, s[56:59], s13 offen offset:1024  lds
    buffer_load_dwordx4 v6, s[56:59], s13 offen offset:2048  lds
    buffer_load_dwordx4 v7, s[56:59], s13 offen offset:3072  lds
    s_mov_b32 m0, s24
    s_mov_b32 s11, 28
    buffer_load_dword off, s[20:23], s11 lds
    ds_read_b32 v29, v26
    s_add_u32 m0, s88, 32768
    s_add_u32 s13, s13, 262144
    buffer_load_dwordx4 v4, s[56:59], s13 offen offset:0  lds
    buffer_load_dwordx4 v5, s[56:59], s13 offen offset:1024  lds
    buffer_load_dwordx4 v6, s[56:59], s13 offen offset:2048  lds
    buffer_load_dwordx4 v7, s[56:59], s13 offen offset:3072  lds
    s_mov_b32 m0, s24
    s_mov_b32 s11, 32
    buffer_load_dword off, s[20:23], s11 lds
    s_waitcnt lgkmcnt(0)
    v_cmp_gt_u32 vcc, 4, v29
    s_cbranch_vccnz L_fs2
L_fo2:
    s_add_u32 m0, s88, 98304
    s_add_u32 s94, s94, 1
    s_lshl_b32 s15, s94, 7
    s_lshl_b32 s13, s94, 19
    s_and_b32 s94, s94, 7
    buffer_load_dwordx4 v160, s[96:99], s15 offen offset:0  lds
    buffer_load_dwordx4 v161, s[96:99], s15 offen offset:1024  lds
    buffer_load_dwordx4 v162, s[96:99], s15 offen offset:2048  lds
    buffer_load_dwordx4 v163, s[96:99], s15 offen offset:3072  lds
    s_add_u32 m0, s88, 81920
    s_nop 0
    buffer_load_dwordx4 v4, s[56:59], s13 offen offset:0  lds
    buffer_load_dwordx4 v5, s[56:59], s13 offen offset:1024  lds
    buffer_load_dwordx4 v6, s[56:59], s13 offen offset:2048  lds
    buffer_load_dwordx4 v7, s[56:59], s13 offen offset:3072  lds
    s_mov_b32 m0, s24
    s_mov_b32 s11, 36
    buffer_load_dword off, s[20:23], s11 lds
    s_add_u32 m0, s88, 49152
    s_add_u32 s13, s13, 262144
    buffer_load_dwordx4 v4, s[56:59], s13 offen offset:0  lds
    buffer_load_dwordx4 v5, s[56:59], s13 offen offset:1024  lds
    buffer_load_dwordx4 v6, s[56:59], s13 offen offset:2048  lds
    buffer_load_dwordx4 v7, s[56:59], s13 offen offset:3072  lds
    s_mov_b32 m0, s24
    s_mov_b32 s11, 40
    buffer_load_dword off, s[20:23], s11 lds
    s_mov_b32 s93, 0
    buffer_load_dwordx4 v[32:35], v8, s[60:63], s93 offen offset:0 nt
    buffer_load_dwordx4 v[36:39], v9, s[60:63], s93 offen offset:1024 nt
    buffer_load_dwordx4 v[40:43], v10, s[60:63], s93 offen offset:2048 nt
    buffer_load_dwordx4 v[44:47], v11, s[60:63], s93 offen offset:3072 nt
    s_mov_b32 s93, 4096
    buffer_load_dwordx4 v[48:51], v8, s[60:63], s93 offen offset:0 nt
    buffer_load_dwordx4 v[52:55], v9, s[60:63], s93 offen offset:1024 nt
    buffer_load_dwordx4 v[56:59], v10, s[60:63], s93 offen offset:2048 nt
    buffer_load_dwordx4 v[60:63], v11, s[60:63], s93 offen offset:3072 nt
    ds_read_b32 v29, v26
    s_waitcnt lgkmcnt(0)
    v_cmp_gt_u32 vcc, 6, v29
    s_cbranch_vccnz L_fs3
L_fo3:
    s_add_u32 m0, s88, 131072
    s_add_u32 s94, s94, 1
    s_lshl_b32 s15, s94, 7
    s_lshl_b32 s13, s94, 19
    s_and_b32 s94, s94, 7
    buffer_load_dwordx4 v160, s[96:99], s15 offen offset:0  lds
    buffer_load_dwordx4 v161, s[96:99], s15 offen offset:1024  lds
    buffer_load_dwordx4 v162, s[96:99], s15 offen offset:2048  lds
    buffer_load_dwordx4 v163, s[96:99], s15 offen offset:3072  lds
    s_add_u32 m0, s88, 65536
    s_nop 0
    buffer_load_dwordx4 v4, s[56:59], s13 offen offset:0  lds
    buffer_load_dwordx4 v5, s[56:59], s13 offen offset:1024  lds
    buffer_load_dwordx4 v6, s[56:59], s13 offen offset:2048  lds
    buffer_load_dwordx4 v7, s[56:59], s13 offen offset:3072  lds
    s_mov_b32 m0, s24
    s_mov_b32 s11, 44
    buffer_load_dword off, s[20:23], s11 lds
    ds_read_b32 v29, v26
    s_add_u32 m0, s88, 114688
    s_add_u32 s13, s13, 262144
    buffer_load_dwordx4 v4, s[56:59], s13 offen offset:0  lds
    buffer_load_dwordx4 v5, s[56:59], s13 offen offset:1024  lds
    buffer_load_dwordx4 v6, s[56:59], s13 offen offset:2048  lds
    buffer_load_dwordx4 v7, s[56:59], s13 offen offset:3072  lds
    s_mov_b32 m0, s24
    s_mov_b32 s11, 48
    buffer_load_dword off, s[20:23], s11 lds
    s_waitcnt lgkmcnt(0)
    v_cmp_gt_u32 vcc, 8, v29
    s_cbranch_vccnz L_fs4
L_fo4:
    s_add_u32 m0, s88, 16384
    s_add_u32 s94, s94, 1
    s_lshl_b32 s15, s94, 7
    s_lshl_b32 s13, s94, 19
    s_and_b32 s94, s94, 7
    buffer_load_dwordx4 v160, s[96:99], s15 offen offset:0  lds
    buffer_load_dwordx4 v161, s[96:99], s15 offen offset:1024  lds
    buffer_load_dwordx4 v162, s[96:99], s15 offen offset:2048  lds
    buffer_load_dwordx4 v163, s[96:99], s15 offen offset:3072  lds
    s_add_u32 m0, s88, 0
    s_nop 0
    buffer_load_dwordx4 v4, s[56:59], s13 offen offset:0  lds
    buffer_load_dwordx4 v5, s[56:59], s13 offen offset:1024  lds
    buffer_load_dwordx4 v6, s[56:59], s13 offen offset:2048  lds
    buffer_load_dwordx4 v7, s[56:59], s13 offen offset:3072  lds
    s_mov_b32 m0, s24
    s_mov_b32 s11, 52
    buffer_load_dword off, s[20:23], s11 lds
    s_add_u32 m0, s88, 32768
    s_add_u32 s13, s13, 262144
    buffer_load_dwordx4 v4, s[56:59], s13 offen offset:0  lds
    buffer_load_dwordx4 v5, s[56:59], s13 offen offset:1024  lds
    buffer_load_dwordx4 v6, s[56:59], s13 offen offset:2048  lds
    buffer_load_dwordx4 v7, s[56:59], s13 offen offset:3072  lds
    s_mov_b32 m0, s24
    s_mov_b32 s11, 56
    buffer_load_dword off, s[20:23], s11 lds
    s_mov_b32 s93, 8192
    buffer_load_dwordx4 v[64:67], v8, s[60:63], s93 offen offset:0 nt
    buffer_load_dwordx4 v[68:71], v9, s[60:63], s93 offen offset:1024 nt
    buffer_load_dwordx4 v[72:75], v10, s[60:63], s93 offen offset:2048 nt
    buffer_load_dwordx4 v[76:79], v11, s[60:63], s93 offen offset:3072 nt
    s_mov_b32 s93, 12288
    buffer_load_dwordx4 v[80:83], v8, s[60:63], s93 offen offset:0 nt
    buffer_load_dwordx4 v[84:87], v9, s[60:63], s93 offen offset:1024 nt
    buffer_load_dwordx4 v[88:91], v10, s[60:63], s93 offen offset:2048 nt
    buffer_load_dwordx4 v[92:95], v11, s[60:63], s93 offen offset:3072 nt
    ds_read_b32 v29, v26
    s_waitcnt lgkmcnt(0)
    v_cmp_gt_u32 vcc, 10, v29
    s_cbranch_vccnz L_fs5
L_fo5:
    s_add_u32 m0, s88, 98304
    s_add_u32 s94, s94, 1
    s_lshl_b32 s15, s94, 7
    s_lshl_b32 s13, s94, 19
    s_and_b32 s94, s94, 7
    buffer_load_dwordx4 v160, s[96:99], s15 offen offset:0  lds
    buffer_load_dwordx4 v161, s[96:99], s15 offen offset:1024  lds
    buffer_load_dwordx4 v162, s[96:99], s15 offen offset:2048  lds
    buffer_load_dwordx4 v163, s[96:99], s15 offen offset:3072  lds
    s_add_u32 m0, s88, 81920
    s_nop 0
    buffer_load_dwordx4 v4, s[56:59], s13 offen offset:0  lds
    buffer_load_dwordx4 v5, s[56:59], s13 offen offset:1024  lds
    buffer_load_dwordx4 v6, s[56:59], s13 offen offset:2048  lds
    buffer_load_dwordx4 v7, s[56:59], s13 offen offset:3072  lds
    s_mov_b32 m0, s24
    s_mov_b32 s11, 60
    buffer_load_dword off, s[20:23], s11 lds
    s_add_u32 m0, s88, 49152
    s_add_u32 s13, s13, 262144
    buffer_load_dwordx4 v4, s[56:59], s13 offen offset:0  lds
    buffer_load_dwordx4 v5, s[56:59], s13 offen offset:1024  lds
    buffer_load_dwordx4 v6, s[56:59], s13 offen offset:2048  lds
    buffer_load_dwordx4 v7, s[56:59], s13 offen offset:3072  lds
    s_mov_b32 m0, s24
    s_mov_b32 s11, 64
    buffer_load_dword off, s[20:23], s11 lds
    s_cmp_eq_u32 s4, 7
    s_cbranch_scc0 L_nt6
    buffer_load_dword v24, v25, s[72:75], s76 offen
    buffer_load_dword v24, v25, s[72:75], s77 offen
    buffer_load_dword v24, v31, s[72:75], s78 offen
L_nt6:
    ds_read_b32 v29, v26
    s_waitcnt lgkmcnt(0)
    v_cmp_gt_u32 vcc, 12, v29
    s_cbranch_vccnz L_fs7
L_fo7:
    s_add_u32 m0, s88, 131072
    s_add_u32 s94, s94, 1
    s_lshl_b32 s15, s94, 7
    s_lshl_b32 s13, s94, 19
    s_and_b32 s94, s94, 7
    buffer_load_dwordx4 v160, s[96:99], s15 offen offset:0  lds
    buffer_load_dwordx4 v161, s[96:99], s15 offen offset:1024  lds
    buffer_load_dwordx4 v162, s[96:99], s15 offen offset:2048  lds
    buffer_load_dwordx4 v163, s[96:99], s15 offen offset:3072  lds
    s_add_u32 m0, s88, 65536
    s_nop 0
    buffer_load_dwordx4 v4, s[56:59], s13 offen offset:0  lds
    buffer_load_dwordx4 v5, s[56:59], s13 offen offset:1024  lds
    buffer_load_dwordx4 v6, s[56:59], s13 offen offset:2048  lds
    buffer_load_dwordx4 v7, s[56:59], s13 offen offset:3072  lds
    s_mov_b32 m0, s24
    s_mov_b32 s11, 68
    buffer_load_dword off, s[20:23], s11 lds
    s_add_u32 m0, s88, 114688
    s_add_u32 s13, s13, 262144
    buffer_load_dwordx4 v4, s[56:59], s13 offen offset:0  lds
    buffer_load_dwordx4 v5, s[56:59], s13 offen offset:1024  lds
    buffer_load_dwordx4 v6, s[56:59], s13 offen offset:2048  lds
    buffer_load_dwordx4 v7, s[56:59], s13 offen offset:3072  lds
    s_mov_b32 m0, s24
    s_mov_b32 s11, 72
    buffer_load_dword off, s[20:23], s11 lds
    s_add_u32 s93, s25, 0
    buffer_load_dwordx4 v[96:99], v164, s[64:67], s93 offen offset:0
    buffer_load_dwordx4 v[100:103], v165, s[64:67], s93 offen offset:1024
    buffer_load_dwordx4 v[104:107], v166, s[64:67], s93 offen offset:2048
    buffer_load_dwordx4 v[108:111], v167, s[64:67], s93 offen offset:3072
    s_add_u32 s93, s25, 128
    buffer_load_dwordx4 v[112:115], v164, s[64:67], s93 offen offset:0
    buffer_load_dwordx4 v[116:119], v165, s[64:67], s93 offen offset:1024
    buffer_load_dwordx4 v[120:123], v166, s[64:67], s93 offen offset:2048
    buffer_load_dwordx4 v[124:127], v167, s[64:67], s93 offen offset:3072
    ds_read_b32 v29, v26
    s_waitcnt lgkmcnt(0)
    v_cmp_gt_u32 vcc, 14, v29
    s_cbranch_vccnz L_fs8
L_fo8:
    ds_read_b32 v29, v26 offset:1024
    s_add_u32 m0, s84, 0
    s_nop 0
    buffer_load_dwordx4 v13, s[68:71], s76 offen offset:0  lds
    buffer_load_dwordx4 v14, s[68:71], s76 offen offset:1024  lds
    buffer_load_dwordx4 v15, s[68:71], s76 offen offset:2048  lds
    buffer_load_dwordx4 v16, s[68:71], s76 offen offset:3072  lds
    s_add_u32 m0, s84, 4096
    s_add_u32 s11, s76, 18432
    buffer_load_dwordx4 v13, s[68:71], s11 offen offset:0  lds
    buffer_load_dwordx4 v14, s[68:71], s11 offen offset:1024  lds
    buffer_load_dwordx4 v15, s[68:71], s11 offen offset:2048  lds
    buffer_load_dwordx4 v16, s[68:71], s11 offen offset:3072  lds
    s_add_u32 m0, s85, 150528
    s_nop 0
    buffer_load_dwordx4 v17, s[68:71], s76 offen  lds
    s_waitcnt lgkmcnt(0)
    v_cmp_gt_u32 vcc, 16, v29
    s_cbranch_vccnz L_fs9
L_fo9:
    s_waitcnt vmcnt(63)
    ds_write_b128 v19, v[32:35] offset:0
    ds_write_b128 v19, v[36:39] offset:1024
    ds_write_b128 v19, v[40:43] offset:2048
    ds_write_b128 v19, v[44:47] offset:3072
    ds_write_b128 v19, v[48:51] offset:4096
    ds_write_b128 v19, v[52:55] offset:5120
    ds_write_b128 v19, v[56:59] offset:6144
    ds_write_b128 v19, v[60:63] offset:7168
    s_waitcnt vmcnt(17)
    s_waitcnt lgkmcnt(0)
    v_mov_b32 v28, 19
    ds_max_u32 v27, v28
    s_add_u32 s93, s26, 0
    buffer_load_dwordx4 v[128:131], v164, s[64:67], s93 offen offset:0
    buffer_load_dwordx4 v[132:135], v165, s[64:67], s93 offen offset:1024
    buffer_load_dwordx4 v[136:139], v166, s[64:67], s93 offen offset:2048
    buffer_load_dwordx4 v[140:143], v167, s[64:67], s93 offen offset:3072
    s_add_u32 s93, s26, 128
    buffer_load_dwordx4 v[144:147], v164, s[64:67], s93 offen offset:0
    buffer_load_dwordx4 v[148:151], v165, s[64:67], s93 offen offset:1024
    buffer_load_dwordx4 v[152:155], v166, s[64:67], s93 offen offset:2048
    buffer_load_dwordx4 v[156:159], v167, s[64:67], s93 offen offset:3072
    ds_read_b32 v29, v26 offset:1024
    s_waitcnt lgkmcnt(0)
    v_cmp_gt_u32 vcc, 18, v29
    s_cbranch_vccnz L_fs10
L_fo10:
    ds_write_b128 v19, v[64:67] offset:32768
    ds_write_b128 v19, v[68:71] offset:33792
    ds_write_b128 v19, v[72:75] offset:34816
    ds_write_b128 v19, v[76:79] offset:35840
    ds_write_b128 v19, v[80:83] offset:36864
    ds_write_b128 v19, v[84:87] offset:37888
    ds_write_b128 v19, v[88:91] offset:38912
    ds_write_b128 v19, v[92:95] offset:39936
    s_waitcnt lgkmcnt(0)
    v_mov_b32 v28, 20
    ds_max_u32 v27, v28
    ds_read_b32 v29, v26 offset:1024
    s_add_u32 m0, s84, 32768
    s_nop 0
    buffer_load_dwordx4 v13, s[68:71], s77 offen offset:0  lds
    buffer_load_dwordx4 v14, s[68:71], s77 offen offset:1024  lds
    buffer_load_dwordx4 v15, s[68:71], s77 offen offset:2048  lds
    buffer_load_dwordx4 v16, s[68:71], s77 offen offset:3072  lds
    s_add_u32 m0, s84, 36864
    s_add_u32 s11, s77, 18432
    buffer_load_dwordx4 v13, s[68:71], s11 offen offset:0  lds
    buffer_load_dwordx4 v14, s[68:71], s11 offen offset:1024  lds
    buffer_load_dwordx4 v15, s[68:71], s11 offen offset:2048  lds
    buffer_load_dwordx4 v16, s[68:71], s11 offen offset:3072  lds
    s_add_u32 m0, s85, 154624
    s_nop 0
    buffer_load_dwordx4 v17, s[68:71], s77 offen  lds
    s_waitcnt lgkmcnt(0)
    v_cmp_gt_u32 vcc, 20, v29
    s_cbranch_vccnz L_fs11
L_fo11:
    s_waitcnt vmcnt(26)
    ds_write_b128 v18, v[96:99] offset:16384
    ds_write_b128 v18, v[100:103] offset:17408
    ds_write_b128 v18, v[104:107] offset:18432
    ds_write_b128 v18, v[108:111] offset:19456
    ds_write_b128 v18, v[112:115] offset:32768
    ds_write_b128 v18, v[116:119] offset:33792
    ds_write_b128 v18, v[120:123] offset:34816
    ds_write_b128 v18, v[124:127] offset:35840
    s_waitcnt vmcnt(17)
    s_waitcnt lgkmcnt(0)
    v_mov_b32 v28, 21
    ds_max_u32 v27, v28
    s_waitcnt vmcnt(9)
    ds_write_b128 v18, v[128:131] offset:0
    ds_write_b128 v18, v[132:135] offset:1024
    ds_write_b128 v18, v[136:139] offset:2048
    ds_write_b128 v18, v[140:143] offset:3072
    s_add_u32 m0, s84, 65536
    s_nop 0
    buffer_load_dwordx4 v13, s[68:71], s78 offen offset:0  lds
    buffer_load_dwordx4 v14, s[68:71], s78 offen offset:1024  lds
    buffer_load_dwordx4 v15, s[68:71], s78 offen offset:2048  lds
    buffer_load_dwordx4 v16, s[68:71], s78 offen offset:3072  lds
    s_add_u32 m0, s84, 69632
    s_add_u32 s11, s78, 18432
    buffer_load_dwordx4 v13, s[68:71], s11 offen offset:0  lds
    buffer_load_dwordx4 v14, s[68:71], s11 offen offset:1024  lds
    buffer_load_dwordx4 v15, s[68:71], s11 offen offset:2048  lds
    buffer_load_dwordx4 v16, s[68:71], s11 offen offset:3072  lds
    s_add_u32 m0, s85, 158720
    s_nop 0
    buffer_load_dwordx4 v17, s[68:71], s78 offen  lds
    s_cmp_eq_u32 s4, 7
    s_cbranch_scc0 L_nt12
    buffer_load_dword v24, v31, s[72:75], s79 offen
    buffer_load_dword v24, v31, s[72:75], s80 offen
    buffer_load_dword v24, v31, s[72:75], s81 offen
    buffer_load_dword v24, v31, s[72:75], s82 offen
    buffer_load_dword v24, v31, s[72:75], s83 offen
L_nt12:
    s_barrier
    ds_write_b128 v18, v[144:147] offset:16384
    ds_write_b128 v18, v[148:151] offset:17408
    ds_write_b128 v18, v[152:155] offset:18432
    ds_write_b128 v18, v[156:159] offset:19456
    s_waitcnt vmcnt(9)
    s_waitcnt lgkmcnt(0)
    v_mov_b32 v28, 23
    ds_max_u32 v27, v28
    s_mov_b32 m0, s24
    s_mov_b32 s11, 96
    buffer_load_dword off, s[20:23], s11 lds
    s_add_u32 m0, s88, 131072
    s_add_u32 s11, s27, 0
    buffer_load_dwordx4 v164, s[64:67], s11 offen offset:0  lds
    buffer_load_dwordx4 v165, s[64:67], s11 offen offset:1024  lds
    buffer_load_dwordx4 v166, s[64:67], s11 offen offset:2048  lds
    buffer_load_dwordx4 v167, s[64:67], s11 offen offset:3072  lds
    s_barrier
    s_add_u32 m0, s88, 98304
    s_add_u32 s11, s27, 128
    buffer_load_dwordx4 v164, s[64:67], s11 offen offset:0  lds
    buffer_load_dwordx4 v165, s[64:67], s11 offen offset:1024  lds
    buffer_load_dwordx4 v166, s[64:67], s11 offen offset:2048  lds
    buffer_load_dwordx4 v167, s[64:67], s11 offen offset:3072  lds
    s_mov_b32 m0, s24
    s_mov_b32 s11, 100
    buffer_load_dword off, s[20:23], s11 lds
    s_add_u32 m0, s88, 114688
    s_add_u32 s11, s28, 0
    buffer_load_dwordx4 v164, s[64:67], s11 offen offset:0  lds
    buffer_load_dwordx4 v165, s[64:67], s11 offen offset:1024  lds
    buffer_load_dwordx4 v166, s[64:67], s11 offen offset:2048  lds
    buffer_load_dwordx4 v167, s[64:67], s11 offen offset:3072  lds
    s_add_u32 m0, s84, 0
    s_nop 0
    buffer_load_dwordx4 v13, s[68:71], s79 offen offset:0  lds
    buffer_load_dwordx4 v14, s[68:71], s79 offen offset:1024  lds
    buffer_load_dwordx4 v15, s[68:71], s79 offen offset:2048  lds
    buffer_load_dwordx4 v16, s[68:71], s79 offen offset:3072  lds
    s_add_u32 m0, s84, 4096
    s_add_u32 s11, s79, 18432
    buffer_load_dwordx4 v13, s[68:71], s11 offen offset:0  lds
    buffer_load_dwordx4 v14, s[68:71], s11 offen offset:1024  lds
    buffer_load_dwordx4 v15, s[68:71], s11 offen offset:2048  lds
    buffer_load_dwordx4 v16, s[68:71], s11 offen offset:3072  lds
    s_add_u32 m0, s85, 150528
    s_nop 0
    buffer_load_dwordx4 v17, s[68:71], s79 offen  lds
    s_mov_b32 m0, s24
    s_mov_b32 s11, 104
    buffer_load_dword off, s[20:23], s11 lds
    s_barrier
    s_add_u32 m0, s88, 131072
    s_add_u32 s11, s28, 128
    buffer_load_dwordx4 v164, s[64:67], s11 offen offset:0  lds
    buffer_load_dwordx4 v165, s[64:67], s11 offen offset:1024  lds
    buffer_load_dwordx4 v166, s[64:67], s11 offen offset:2048  lds
    buffer_load_dwordx4 v167, s[64:67], s11 offen offset:3072  lds
    s_mov_b32 m0, s24
    s_mov_b32 s11, 108
    buffer_load_dword off, s[20:23], s11 lds
    s_add_u32 m0, s88, 98304
    s_add_u32 s11, s29, 0
    buffer_load_dwordx4 v164, s[64:67], s11 offen offset:0  lds
    buffer_load_dwordx4 v165, s[64:67], s11 offen offset:1024  lds
    buffer_load_dwordx4 v166, s[64:67], s11 offen offset:2048  lds
    buffer_load_dwordx4 v167, s[64:67], s11 offen offset:3072  lds
    s_add_u32 m0, s84, 32768
    s_nop 0
    buffer_load_dwordx4 v13, s[68:71], s80 offen offset:0  lds
    buffer_load_dwordx4 v14, s[68:71], s80 offen offset:1024  lds
    buffer_load_dwordx4 v15, s[68:71], s80 offen offset:2048  lds
    buffer_load_dwordx4 v16, s[68:71], s80 offen offset:3072  lds
    s_add_u32 m0, s84, 36864
    s_add_u32 s11, s80, 18432
    buffer_load_dwordx4 v13, s[68:71], s11 offen offset:0  lds
    buffer_load_dwordx4 v14, s[68:71], s11 offen offset:1024  lds
    buffer_load_dwordx4 v15, s[68:71], s11 offen offset:2048  lds
    buffer_load_dwordx4 v16, s[68:71], s11 offen offset:3072  lds
    s_add_u32 m0, s85, 154624
    s_nop 0
    buffer_load_dwordx4 v17, s[68:71], s80 offen  lds
    s_mov_b32 m0, s24
    s_mov_b32 s11, 112
    buffer_load_dword off, s[20:23], s11 lds
    s_barrier
    s_add_u32 m0, s88, 114688
    s_add_u32 s11, s29, 128
    buffer_load_dwordx4 v164, s[64:67], s11 offen offset:0  lds
    buffer_load_dwordx4 v165, s[64:67], s11 offen offset:1024  lds
    buffer_load_dwordx4 v166, s[64:67], s11 offen offset:2048  lds
    buffer_load_dwordx4 v167, s[64:67], s11 offen offset:3072  lds
    s_mov_b32 m0, s24
    s_mov_b32 s11, 116
    buffer_load_dword off, s[20:23], s11 lds
    s_add_u32 m0, s88, 131072
    s_add_u32 s11, s30, 0
    buffer_load_dwordx4 v164, s[64:67], s11 offen offset:0  lds
    buffer_load_dwordx4 v165, s[64:67], s11 offen offset:1024  lds
    buffer_load_dwordx4 v166, s[64:67], s11 offen offset:2048  lds
    buffer_load_dwordx4 v167, s[64:67], s11 offen offset:3072  lds
    s_add_u32 m0, s84, 65536
    s_nop 0
    buffer_load_dwordx4 v13, s[68:71], s81 offen offset:0  lds
    buffer_load_dwordx4 v14, s[68:71], s81 offen offset:1024  lds
    buffer_load_dwordx4 v15, s[68:71], s81 offen offset:2048  lds
    buffer_load_dwordx4 v16, s[68:71], s81 offen offset:3072  lds
    s_add_u32 m0, s84, 69632
    s_add_u32 s11, s81, 18432
    buffer_load_dwordx4 v13, s[68:71], s11 offen offset:0  lds
    buffer_load_dwordx4 v14, s[68:71], s11 offen offset:1024  lds
    buffer_load_dwordx4 v15, s[68:71], s11 offen offset:2048  lds
    buffer_load_dwordx4 v16, s[68:71], s11 offen offset:3072  lds
    s_add_u32 m0, s85, 158720
    s_nop 0
    buffer_load_dwordx4 v17, s[68:71], s81 offen  lds
    s_mov_b32 m0, s24
    s_mov_b32 s11, 120
    buffer_load_dword off, s[20:23], s11 lds
    s_barrier
    s_add_u32 m0, s88, 98304
    s_add_u32 s11, s30, 128
    buffer_load_dwordx4 v164, s[64:67], s11 offen offset:0  lds
    buffer_load_dwordx4 v165, s[64:67], s11 offen offset:1024  lds
    buffer_load_dwordx4 v166, s[64:67], s11 offen offset:2048  lds
    buffer_load_dwordx4 v167, s[64:67], s11 offen offset:3072  lds
    s_mov_b32 m0, s24
    s_mov_b32 s11, 124
    buffer_load_dword off, s[20:23], s11 lds
    s_add_u32 m0, s88, 114688
    s_add_u32 s11, s31, 0
    buffer_load_dwordx4 v164, s[64:67], s11 offen offset:0  lds
    buffer_load_dwordx4 v165, s[64:67], s11 offen offset:1024  lds
    buffer_load_dwordx4 v166, s[64:67], s11 offen offset:2048  lds
    buffer_load_dwordx4 v167, s[64:67], s11 offen offset:3072  lds
    s_add_u32 m0, s84, 0
    s_nop 0
    buffer_load_dwordx4 v13, s[68:71], s82 offen offset:0  lds
    buffer_load_dwordx4 v14, s[68:71], s82 offen offset:1024  lds
    buffer_load_dwordx4 v15, s[68:71], s82 offen offset:2048  lds
    buffer_load_dwordx4 v16, s[68:71], s82 offen offset:3072  lds
    s_add_u32 m0, s84, 4096
    s_add_u32 s11, s82, 18432
    buffer_load_dwordx4 v13, s[68:71], s11 offen offset:0  lds
    buffer_load_dwordx4 v14, s[68:71], s11 offen offset:1024  lds
    buffer_load_dwordx4 v15, s[68:71], s11 offen offset:2048  lds
    buffer_load_dwordx4 v16, s[68:71], s11 offen offset:3072  lds
    s_add_u32 m0, s85, 150528
    s_nop 0
    buffer_load_dwordx4 v17, s[68:71], s82 offen  lds
    s_mov_b32 m0, s24
    s_mov_b32 s11, 128
    buffer_load_dword off, s[20:23], s11 lds
    s_barrier
    s_add_u32 m0, s88, 131072
    s_add_u32 s11, s31, 128
    buffer_load_dwordx4 v164, s[64:67], s11 offen offset:0  lds
    buffer_load_dwordx4 v165, s[64:67], s11 offen offset:1024  lds
    buffer_load_dwordx4 v166, s[64:67], s11 offen offset:2048  lds
    buffer_load_dwordx4 v167, s[64:67], s11 offen offset:3072  lds
    s_mov_b32 m0, s24
    s_mov_b32 s11, 132
    buffer_load_dword off, s[20:23], s11 lds
    s_add_u32 m0, s88, 98304
    s_add_u32 s11, s32, 0
    buffer_load_dwordx4 v164, s[64:67], s11 offen offset:0  lds
    buffer_load_dwordx4 v165, s[64:67], s11 offen offset:1024  lds
    buffer_load_dwordx4 v166, s[64:67], s11 offen offset:2048  lds
    buffer_load_dwordx4 v167, s[64:67], s11 offen offset:3072  lds
    s_add_u32 m0, s84, 32768
    s_nop 0
    buffer_load_dwordx4 v13, s[68:71], s83 offen offset:0  lds
    buffer_load_dwordx4 v14, s[68:71], s83 offen offset:1024  lds
    buffer_load_dwordx4 v15, s[68:71], s83 offen offset:2048  lds
    buffer_load_dwordx4 v16, s[68:71], s83 offen offset:3072  lds
    s_add_u32 m0, s84, 36864
    s_add_u32 s11, s83, 18432
    buffer_load_dwordx4 v13, s[68:71], s11 offen offset:0  lds
    buffer_load_dwordx4 v14, s[68:71], s11 offen offset:1024  lds
    buffer_load_dwordx4 v15, s[68:71], s11 offen offset:2048  lds
    buffer_load_dwordx4 v16, s[68:71], s11 offen offset:3072  lds
    s_add_u32 m0, s85, 154624
    s_nop 0
    buffer_load_dwordx4 v17, s[68:71], s83 offen  lds
    s_mov_b32 m0, s24
    s_mov_b32 s11, 136
    buffer_load_dword off, s[20:23], s11 lds
    s_barrier
    s_add_u32 m0, s88, 114688
    s_add_u32 s11, s32, 128
    buffer_load_dwordx4 v164, s[64:67], s11 offen offset:0  lds
    buffer_load_dwordx4 v165, s[64:67], s11 offen offset:1024  lds
    buffer_load_dwordx4 v166, s[64:67], s11 offen offset:2048  lds
    buffer_load_dwordx4 v167, s[64:67], s11 offen offset:3072  lds
    s_mov_b32 m0, s24
    s_mov_b32 s11, 140
    buffer_load_dword off, s[20:23], s11 lds
    s_endpgm
L_fs1:
    s_mov_b32 s87, 0
L_fl1:
    s_sleep 1
    ds_read_b32 v29, v26
    s_add_u32 s87, s87, 1
    s_cmp_lt_u32 s87, 0x100000
    s_waitcnt lgkmcnt(0)
    s_cbranch_scc0 L_fo1
    v_cmp_gt_u32 vcc, 2, v29
    s_cbranch_vccnz L_fl1
    s_branch L_fo1
L_fs2:
    s_mov_b32 s87, 0
L_fl2:
    s_sleep 1
    ds_read_b32 v29, v26
    s_add_u32 s87, s87, 1
    s_cmp_lt_u32 s87, 0x100000
    s_waitcnt lgkmcnt(0)
    s_cbranch_scc0 L_fo2
    v_cmp_gt_u32 vcc, 4, v29
    s_cbranch_vccnz L_fl2
    s_branch L_fo2
L_fs3:
    s_mov_b32 s87, 0
L_fl3:
    s_sleep 1
    ds_read_b32 v29, v26
    s_add_u32 s87, s87, 1
    s_cmp_lt_u32 s87, 0x100000
    s_waitcnt lgkmcnt(0)
    s_cbranch_scc0 L_fo3
    v_cmp_gt_u32 vcc, 6, v29
    s_cbranch_vccnz L_fl3
    s_branch L_fo3
L_fs4:
    s_mov_b32 s87, 0
L_fl4:
    s_sleep 1
    ds_read_b32 v29, v26
    s_add_u32 s87, s87, 1
    s_cmp_lt_u32 s87, 0x100000
    s_waitcnt lgkmcnt(0)
    s_cbranch_scc0 L_fo4
    v_cmp_gt_u32 vcc, 8, v29
    s_cbranch_vccnz L_fl4
    s_branch L_fo4
L_fs5:
    s_mov_b32 s87, 0
L_fl5:
    s_sleep 1
    ds_read_b32 v29, v26
    s_add_u32 s87, s87, 1
    s_cmp_lt_u32 s87, 0x100000
    s_waitcnt lgkmcnt(0)
    s_cbranch_scc0 L_fo5
    v_cmp_gt_u32 vcc, 10, v29
    s_cbranch_vccnz L_fl5
    s_branch L_fo5
L_fs7:
    s_mov_b32 s87, 0
L_fl7:
    s_sleep 1
    ds_read_b32 v29, v26
    s_add_u32 s87, s87, 1
    s_cmp_lt_u32 s87, 0x100000
    s_waitcnt lgkmcnt(0)
    s_cbranch_scc0 L_fo7
    v_cmp_gt_u32 vcc, 12, v29
    s_cbranch_vccnz L_fl7
    s_branch L_fo7
L_fs8:
    s_mov_b32 s87, 0
L_fl8:
    s_sleep 1
    ds_read_b32 v29, v26
    s_add_u32 s87, s87, 1
    s_cmp_lt_u32 s87, 0x100000
    s_waitcnt lgkmcnt(0)
    s_cbranch_scc0 L_fo8
    v_cmp_gt_u32 vcc, 14, v29
    s_cbranch_vccnz L_fl8
    s_branch L_fo8
L_fs9:
    s_mov_b32 s87, 0
L_fl9:
    s_sleep 1
    ds_read_b32 v29, v26 offset:1024
    s_add_u32 s87, s87, 1
    s_cmp_lt_u32 s87, 0x100000
    s_waitcnt lgkmcnt(0)
    s_cbranch_scc0 L_fo9
    v_cmp_gt_u32 vcc, 16, v29
    s_cbranch_vccnz L_fl9
    s_branch L_fo9
L_fs10:
    s_mov_b32 s87, 0
L_fl10:
    s_sleep 1
    ds_read_b32 v29, v26 offset:1024
    s_add_u32 s87, s87, 1
    s_cmp_lt_u32 s87, 0x100000
    s_waitcnt lgkmcnt(0)
    s_cbranch_scc0 L_fo10
    v_cmp_gt_u32 vcc, 18, v29
    s_cbranch_vccnz L_fl10
    s_branch L_fo10
L_fs11:
    s_mov_b32 s87, 0
L_fl11:
    s_sleep 1
    ds_read_b32 v29, v26 offset:1024
    s_add_u32 s87, s87, 1
    s_cmp_lt_u32 s87, 0x100000
    s_waitcnt lgkmcnt(0)
    s_cbranch_scc0 L_fo11
    v_cmp_gt_u32 vcc, 20, v29
    s_cbranch_vccnz L_fl11
    s_branch L_fo11
L_hv1:
    s_add_u32 m0, s88, 131072
    s_add_u32 s94, s94, 1
    s_lshl_b32 s15, s94, 7
    s_lshl_b32 s13, s94, 19
    s_and_b32 s94, s94, 7
    buffer_load_dwordx4 v160, s[96:99], s15 offen offset:0  lds
    buffer_load_dwordx4 v161, s[96:99], s15 offen offset:1024  lds
    buffer_load_dwordx4 v162, s[96:99], s15 offen offset:2048  lds
    buffer_load_dwordx4 v163, s[96:99], s15 offen offset:3072  lds
    s_add_u32 m0, s88, 65536
    s_nop 0
    buffer_load_dwordx4 v4, s[56:59], s13 offen offset:0  lds
    buffer_load_dwordx4 v5, s[56:59], s13 offen offset:1024  lds
    buffer_load_dwordx4 v6, s[56:59], s13 offen offset:2048  lds
    buffer_load_dwordx4 v7, s[56:59], s13 offen offset:3072  lds
    s_mov_b32 m0, s24
    s_mov_b32 s11, 20
    buffer_load_dword off, s[20:23], s11 lds
    ds_read_b32 v29, v26
    s_add_u32 m0, s88, 114688
    s_add_u32 s13, s13, 262144
    buffer_load_dwordx4 v4, s[56:59], s13 offen offset:0  lds
    buffer_load_dwordx4 v5, s[56:59], s13 offen offset:1024  lds
    buffer_load_dwordx4 v6, s[56:59], s13 offen offset:2048  lds
    buffer_load_dwordx4 v7, s[56:59], s13 offen offset:3072  lds
    s_mov_b32 m0, s24
    s_mov_b32 s11, 24
    buffer_load_dword off, s[20:23], s11 lds
    s_waitcnt lgkmcnt(0)
    v_cmp_gt_u32 vcc, 2, v29
    s_cbranch_vccnz L_fs13
L_fo13:
    s_add_u32 m0, s88, 16384
    s_add_u32 s94, s94, 1
    s_lshl_b32 s15, s94, 7
    s_lshl_b32 s13, s94, 19
    s_and_b32 s94, s94, 7
    buffer_load_dwordx4 v160, s[96:99], s15 offen offset:0  lds
    buffer_load_dwordx4 v161, s[96:99], s15 offen offset:1024  lds
    buffer_load_dwordx4 v162, s[96:99], s15 offen offset:2048  lds
    buffer_load_dwordx4 v163, s[96:99], s15 offen offset:3072  lds
    s_add_u32 m0, s88, 0
    s_nop 0
    buffer_load_dwordx4 v4, s[56:59], s13 offen offset:0  lds
    buffer_load_dwordx4 v5, s[56:59], s13 offen offset:1024  lds
    buffer_load_dwordx4 v6, s[56:59], s13 offen offset:2048  lds
    buffer_load_dwordx4 v7, s[56:59], s13 offen offset:3072  lds
    s_mov_b32 m0, s24
    s_mov_b32 s11, 28
    buffer_load_dword off, s[20:23], s11 lds
    ds_read_b32 v29, v26
    s_add_u32 m0, s88, 32768
    s_add_u32 s13, s13, 262144
    buffer_load_dwordx4 v4, s[56:59], s13 offen offset:0  lds
    buffer_load_dwordx4 v5, s[56:59], s13 offen offset:1024  lds
    buffer_load_dwordx4 v6, s[56:59], s13 offen offset:2048  lds
    buffer_load_dwordx4 v7, s[56:59], s13 offen offset:3072  lds
    s_mov_b32 m0, s24
    s_mov_b32 s11, 32
    buffer_load_dword off, s[20:23], s11 lds
    s_waitcnt lgkmcnt(0)
    v_cmp_gt_u32 vcc, 4, v29
    s_cbranch_vccnz L_fs14
L_fo14:
    s_add_u32 m0, s88, 98304
    s_add_u32 s94, s94, 1
    s_lshl_b32 s15, s94, 7
    s_lshl_b32 s13, s94, 19
    s_and_b32 s94, s94, 7
    buffer_load_dwordx4 v160, s[96:99], s15 offen offset:0  lds
    buffer_load_dwordx4 v161, s[96:99], s15 offen offset:1024  lds
    buffer_load_dwordx4 v162, s[96:99], s15 offen offset:2048  lds
    buffer_load_dwordx4 v163, s[96:99], s15 offen offset:3072  lds
    s_add_u32 m0, s88, 81920
    s_nop 0
    buffer_load_dwordx4 v4, s[56:59], s13 offen offset:0  lds
    buffer_load_dwordx4 v5, s[56:59], s13 offen offset:1024  lds
    buffer_load_dwordx4 v6, s[56:59], s13 offen offset:2048  lds
    buffer_load_dwordx4 v7, s[56:59], s13 offen offset:3072  lds
    s_mov_b32 m0, s24
    s_mov_b32 s11, 36
    buffer_load_dword off, s[20:23], s11 lds
    ds_read_b32 v29, v26
    s_add_u32 m0, s88, 49152
    s_add_u32 s13, s13, 262144
    buffer_load_dwordx4 v4, s[56:59], s13 offen offset:0  lds
    buffer_load_dwordx4 v5, s[56:59], s13 offen offset:1024  lds
    buffer_load_dwordx4 v6, s[56:59], s13 offen offset:2048  lds
    buffer_load_dwordx4 v7, s[56:59], s13 offen offset:3072  lds
    s_mov_b32 m0, s24
    s_mov_b32 s11, 40
    buffer_load_dword off, s[20:23], s11 lds
    s_waitcnt lgkmcnt(0)
    v_cmp_gt_u32 vcc, 6, v29
    s_cbranch_vccnz L_fs15
L_fo15:
    s_add_u32 m0, s88, 131072
    s_add_u32 s94, s94, 1
    s_lshl_b32 s15, s94, 7
    s_lshl_b32 s13, s94, 19
    s_and_b32 s94, s94, 7
    buffer_load_dwordx4 v160, s[96:99], s15 offen offset:0  lds
    buffer_load_dwordx4 v161, s[96:99], s15 offen offset:1024  lds
    buffer_load_dwordx4 v162, s[96:99], s15 offen offset:2048  lds
    buffer_load_dwordx4 v163, s[96:99], s15 offen offset:3072  lds
    s_add_u32 m0, s88, 65536
    s_nop 0
    buffer_load_dwordx4 v4, s[56:59], s13 offen offset:0  lds
    buffer_load_dwordx4 v5, s[56:59], s13 offen offset:1024  lds
    buffer_load_dwordx4 v6, s[56:59], s13 offen offset:2048  lds
    buffer_load_dwordx4 v7, s[56:59], s13 offen offset:3072  lds
    s_mov_b32 m0, s24
    s_mov_b32 s11, 44
    buffer_load_dword off, s[20:23], s11 lds
    s_add_u32 m0, s88, 114688
    s_add_u32 s13, s13, 262144
    buffer_load_dwordx4 v4, s[56:59], s13 offen offset:0  lds
    buffer_load_dwordx4 v5, s[56:59], s13 offen offset:1024  lds
    buffer_load_dwordx4 v6, s[56:59], s13 offen offset:2048  lds
    buffer_load_dwordx4 v7, s[56:59], s13 offen offset:3072  lds
    s_mov_b32 m0, s24
    s_mov_b32 s11, 48
    buffer_load_dword off, s[20:23], s11 lds
    s_mov_b32 s93, 0
    buffer_load_dwordx4 v[32:35], v8, s[60:63], s93 offen offset:0 nt
    buffer_load_dwordx4 v[36:39], v9, s[60:63], s93 offen offset:1024 nt
    buffer_load_dwordx4 v[40:43], v10, s[60:63], s93 offen offset:2048 nt
    buffer_load_dwordx4 v[44:47], v11, s[60:63], s93 offen offset:3072 nt
    s_mov_b32 s93, 4096
    buffer_load_dwordx4 v[48:51], v8, s[60:63], s93 offen offset:0 nt
    buffer_load_dwordx4 v[52:55], v9, s[60:63], s93 offen offset:1024 nt
    buffer_load_dwordx4 v[56:59], v10, s[60:63], s93 offen offset:2048 nt
    buffer_load_dwordx4 v[60:63], v11, s[60:63], s93 offen offset:3072 nt
    ds_read_b32 v29, v26
    s_waitcnt lgkmcnt(0)
    v_cmp_gt_u32 vcc, 8, v29
    s_cbranch_vccnz L_fs16
L_fo16:
    s_add_u32 m0, s88, 16384
    s_add_u32 s94, s94, 1
    s_lshl_b32 s15, s94, 7
    s_lshl_b32 s13, s94, 19
    s_and_b32 s94, s94, 7
    buffer_load_dwordx4 v160, s[96:99], s15 offen offset:0  lds
    buffer_load_dwordx4 v161, s[96:99], s15 offen offset:1024  lds
    buffer_load_dwordx4 v162, s[96:99], s15 offen offset:2048  lds
    buffer_load_dwordx4 v163, s[96:99], s15 offen offset:3072  lds
    s_add_u32 m0, s88, 0
    s_nop 0
    buffer_load_dwordx4 v4, s[56:59], s13 offen offset:0  lds
    buffer_load_dwordx4 v5, s[56:59], s13 offen offset:1024  lds
    buffer_load_dwordx4 v6, s[56:59], s13 offen offset:2048  lds
    buffer_load_dwordx4 v7, s[56:59], s13 offen offset:3072  lds
    s_mov_b32 m0, s24
    s_mov_b32 s11, 52
    buffer_load_dword off, s[20:23], s11 lds
    ds_read_b32 v29, v26
    s_add_u32 m0, s88, 32768
    s_add_u32 s13, s13, 262144
    buffer_load_dwordx4 v4, s[56:59], s13 offen offset:0  lds
    buffer_load_dwordx4 v5, s[56:59], s13 offen offset:1024  lds
    buffer_load_dwordx4 v6, s[56:59], s13 offen offset:2048  lds
    buffer_load_dwordx4 v7, s[56:59], s13 offen offset:3072  lds
    s_mov_b32 m0, s24
    s_mov_b32 s11, 56
    buffer_load_dword off, s[20:23], s11 lds
    s_waitcnt lgkmcnt(0)
    v_cmp_gt_u32 vcc, 10, v29
    s_cbranch_vccnz L_fs17
L_fo17:
    s_add_u32 m0, s88, 98304
    s_add_u32 s94, s94, 1
    s_lshl_b32 s15, s94, 7
    s_lshl_b32 s13, s94, 19
    s_and_b32 s94, s94, 7
    buffer_load_dwordx4 v160, s[96:99], s15 offen offset:0  lds
    buffer_load_dwordx4 v161, s[96:99], s15 offen offset:1024  lds
    buffer_load_dwordx4 v162, s[96:99], s15 offen offset:2048  lds
    buffer_load_dwordx4 v163, s[96:99], s15 offen offset:3072  lds
    s_add_u32 m0, s88, 81920
    s_nop 0
    buffer_load_dwordx4 v4, s[56:59], s13 offen offset:0  lds
    buffer_load_dwordx4 v5, s[56:59], s13 offen offset:1024  lds
    buffer_load_dwordx4 v6, s[56:59], s13 offen offset:2048  lds
    buffer_load_dwordx4 v7, s[56:59], s13 offen offset:3072  lds
    s_mov_b32 m0, s24
    s_mov_b32 s11, 60
    buffer_load_dword off, s[20:23], s11 lds
    s_add_u32 m0, s88, 49152
    s_add_u32 s13, s13, 262144
    buffer_load_dwordx4 v4, s[56:59], s13 offen offset:0  lds
    buffer_load_dwordx4 v5, s[56:59], s13 offen offset:1024  lds
    buffer_load_dwordx4 v6, s[56:59], s13 offen offset:2048  lds
    buffer_load_dwordx4 v7, s[56:59], s13 offen offset:3072  lds
    s_mov_b32 m0, s24
    s_mov_b32 s11, 64
    buffer_load_dword off, s[20:23], s11 lds
    s_mov_b32 s93, 8192
    buffer_load_dwordx4 v[64:67], v8, s[60:63], s93 offen offset:0 nt
    buffer_load_dwordx4 v[68:71], v9, s[60:63], s93 offen offset:1024 nt
    buffer_load_dwordx4 v[72:75], v10, s[60:63], s93 offen offset:2048 nt
    buffer_load_dwordx4 v[76:79], v11, s[60:63], s93 offen offset:3072 nt
    s_mov_b32 s93, 12288
    buffer_load_dwordx4 v[80:83], v8, s[60:63], s93 offen offset:0 nt
    buffer_load_dwordx4 v[84:87], v9, s[60:63], s93 offen offset:1024 nt
    buffer_load_dwordx4 v[88:91], v10, s[60:63], s93 offen offset:2048 nt
    buffer_load_dwordx4 v[92:95], v11, s[60:63], s93 offen offset:3072 nt
    ds_read_b32 v29, v26
    s_waitcnt lgkmcnt(0)
    v_cmp_gt_u32 vcc, 12, v29
    s_cbranch_vccnz L_fs18
L_fo18:
    s_add_u32 m0, s88, 131072
    s_add_u32 s94, s94, 1
    s_lshl_b32 s15, s94, 7
    s_lshl_b32 s13, s94, 19
    s_and_b32 s94, s94, 7
    buffer_load_dwordx4 v160, s[96:99], s15 offen offset:0  lds
    buffer_load_dwordx4 v161, s[96:99], s15 offen offset:1024  lds
    buffer_load_dwordx4 v162, s[96:99], s15 offen offset:2048  lds
    buffer_load_dwordx4 v163, s[96:99], s15 offen offset:3072  lds
    s_add_u32 m0, s88, 65536
    s_nop 0
    buffer_load_dwordx4 v4, s[56:59], s13 offen offset:0  lds
    buffer_load_dwordx4 v5, s[56:59], s13 offen offset:1024  lds
    buffer_load_dwordx4 v6, s[56:59], s13 offen offset:2048  lds
    buffer_load_dwordx4 v7, s[56:59], s13 offen offset:3072  lds
    s_mov_b32 m0, s24
    s_mov_b32 s11, 68
    buffer_load_dword off, s[20:23], s11 lds
    s_add_u32 m0, s88, 114688
    s_add_u32 s13, s13, 262144
    buffer_load_dwordx4 v4, s[56:59], s13 offen offset:0  lds
    buffer_load_dwordx4 v5, s[56:59], s13 offen offset:1024  lds
    buffer_load_dwordx4 v6, s[56:59], s13 offen offset:2048  lds
    buffer_load_dwordx4 v7, s[56:59], s13 offen offset:3072  lds
    s_mov_b32 m0, s24
    s_mov_b32 s11, 72
    buffer_load_dword off, s[20:23], s11 lds
    s_cmp_eq_u32 s4, 7
    s_cbranch_scc0 L_nt19
    buffer_load_dword v24, v25, s[72:75], s76 offen
    buffer_load_dword v24, v25, s[72:75], s77 offen
    buffer_load_dword v24, v31, s[72:75], s78 offen
L_nt19:
    ds_read_b32 v29, v26
    s_waitcnt lgkmcnt(0)
    v_cmp_gt_u32 vcc, 14, v29
    s_cbranch_vccnz L_fs20
L_fo20:
    s_add_u32 s93, s25, 0
    buffer_load_dwordx4 v[96:99], v164, s[64:67], s93 offen offset:0
    buffer_load_dwordx4 v[100:103], v165, s[64:67], s93 offen offset:1024
    buffer_load_dwordx4 v[104:107], v166, s[64:67], s93 offen offset:2048
    buffer_load_dwordx4 v[108:111], v167, s[64:67], s93 offen offset:3072
    s_add_u32 s93, s25, 128
    buffer_load_dwordx4 v[112:115], v164, s[64:67], s93 offen offset:0
    buffer_load_dwordx4 v[116:119], v165, s[64:67], s93 offen offset:1024
    buffer_load_dwordx4 v[120:123], v166, s[64:67], s93 offen offset:2048
    buffer_load_dwordx4 v[124:127], v167, s[64:67], s93 offen offset:3072
    ds_read_b32 v29, v26 offset:1024
    s_add_u32 m0, s84, 0
    s_nop 0
    buffer_load_dwordx4 v13, s[68:71], s76 offen offset:0  lds
    buffer_load_dwordx4 v14, s[68:71], s76 offen offset:1024  lds
    buffer_load_dwordx4 v15, s[68:71], s76 offen offset:2048  lds
    buffer_load_dwordx4 v16, s[68:71], s76 offen offset:3072  lds
    s_add_u32 m0, s84, 4096
    s_add_u32 s11, s76, 18432
    buffer_load_dwordx4 v13, s[68:71], s11 offen offset:0  lds
    buffer_load_dwordx4 v14, s[68:71], s11 offen offset:1024  lds
    buffer_load_dwordx4 v15, s[68:71], s11 offen offset:2048  lds
    buffer_load_dwordx4 v16, s[68:71], s11 offen offset:3072  lds
    s_add_u32 m0, s85, 150528
    s_nop 0
    buffer_load_dwordx4 v17, s[68:71], s76 offen  lds
    s_waitcnt lgkmcnt(0)
    v_cmp_gt_u32 vcc, 16, v29
    s_cbranch_vccnz L_fs21
L_fo21:
    s_waitcnt vmcnt(63)
    ds_write_b128 v19, v[32:35] offset:0
    ds_write_b128 v19, v[36:39] offset:1024
    ds_write_b128 v19, v[40:43] offset:2048
    ds_write_b128 v19, v[44:47] offset:3072
    ds_write_b128 v19, v[48:51] offset:4096
    ds_write_b128 v19, v[52:55] offset:5120
    ds_write_b128 v19, v[56:59] offset:6144
    ds_write_b128 v19, v[60:63] offset:7168
    s_waitcnt vmcnt(17)
    s_waitcnt lgkmcnt(0)
    v_mov_b32 v28, 19
    ds_max_u32 v27, v28
    s_add_u32 s93, s26, 0
    buffer_load_dwordx4 v[128:131], v164, s[64:67], s93 offen offset:0
    buffer_load_dwordx4 v[132:135], v165, s[64:67], s93 offen offset:1024
    buffer_load_dwordx4 v[136:139], v166, s[64:67], s93 offen offset:2048
    buffer_load_dwordx4 v[140:143], v167, s[64:67], s93 offen offset:3072
    s_add_u32 s93, s26, 128
    buffer_load_dwordx4 v[144:147], v164, s[64:67], s93 offen offset:0
    buffer_load_dwordx4 v[148:151], v165, s[64:67], s93 offen offset:1024
    buffer_load_dwordx4 v[152:155], v166, s[64:67], s93 offen offset:2048
    buffer_load_dwordx4 v[156:159], v167, s[64:67], s93 offen offset:3072
    ds_read_b32 v29, v26 offset:1024
    s_waitcnt lgkmcnt(0)
    v_cmp_gt_u32 vcc, 18, v29
    s_cbranch_vccnz L_fs22
L_fo22:
    ds_write_b128 v19, v[64:67] offset:32768
    ds_write_b128 v19, v[68:71] offset:33792
    ds_write_b128 v19, v[72:75] offset:34816
    ds_write_b128 v19, v[76:79] offset:35840
    ds_write_b128 v19, v[80:83] offset:36864
    ds_write_b128 v19, v[84:87] offset:37888
    ds_write_b128 v19, v[88:91] offset:38912
    ds_write_b128 v19, v[92:95] offset:39936
    s_waitcnt lgkmcnt(0)
    v_mov_b32 v28, 20
    ds_max_u32 v27, v28
    ds_read_b32 v29, v26 offset:1024
    s_add_u32 m0, s84, 32768
    s_nop 0
    buffer_load_dwordx4 v13, s[68:71], s77 offen offset:0  lds
    buffer_load_dwordx4 v14, s[68:71], s77 offen offset:1024  lds
    buffer_load_dwordx4 v15, s[68:71], s77 offen offset:2048  lds
    buffer_load_dwordx4 v16, s[68:71], s77 offen offset:3072  lds
    s_add_u32 m0, s84, 36864
    s_add_u32 s11, s77, 18432
    buffer_load_dwordx4 v13, s[68:71], s11 offen offset:0  lds
    buffer_load_dwordx4 v14, s[68:71], s11 offen offset:1024  lds
    buffer_load_dwordx4 v15, s[68:71], s11 offen offset:2048  lds
    buffer_load_dwordx4 v16, s[68:71], s11 offen offset:3072  lds
    s_add_u32 m0, s85, 154624
    s_nop 0
    buffer_load_dwordx4 v17, s[68:71], s77 offen  lds
    s_waitcnt lgkmcnt(0)
    v_cmp_gt_u32 vcc, 20, v29
    s_cbranch_vccnz L_fs23
L_fo23:
    s_waitcnt vmcnt(26)
    ds_write_b128 v18, v[96:99] offset:16384
    ds_write_b128 v18, v[100:103] offset:17408
    ds_write_b128 v18, v[104:107] offset:18432
    ds_write_b128 v18, v[108:111] offset:19456
    ds_write_b128 v18, v[112:115] offset:32768
    ds_write_b128 v18, v[116:119] offset:33792
    ds_write_b128 v18, v[120:123] offset:34816
    ds_write_b128 v18, v[124:127] offset:35840
    s_waitcnt vmcnt(17)
    s_waitcnt lgkmcnt(0)
    v_mov_b32 v28, 21
    ds_max_u32 v27, v28
    s_waitcnt vmcnt(9)
    ds_write_b128 v18, v[128:131] offset:0
    ds_write_b128 v18, v[132:135] offset:1024
    ds_write_b128 v18, v[136:139] offset:2048
    ds_write_b128 v18, v[140:143] offset:3072
    s_add_u32 m0, s84, 65536
    s_nop 0
    buffer_load_dwordx4 v13, s[68:71], s78 offen offset:0  lds
    buffer_load_dwordx4 v14, s[68:71], s78 offen offset:1024  lds
    buffer_load_dwordx4 v15, s[68:71], s78 offen offset:2048  lds
    buffer_load_dwordx4 v16, s[68:71], s78 offen offset:3072  lds
    s_add_u32 m0, s84, 69632
    s_add_u32 s11, s78, 18432
    buffer_load_dwordx4 v13, s[68:71], s11 offen offset:0  lds
    buffer_load_dwordx4 v14, s[68:71], s11 offen offset:1024  lds
    buffer_load_dwordx4 v15, s[68:71], s11 offen offset:2048  lds
    buffer_load_dwordx4 v16, s[68:71], s11 offen offset:3072  lds
    s_add_u32 m0, s85, 158720
    s_nop 0
    buffer_load_dwordx4 v17, s[68:71], s78 offen  lds
    s_cmp_eq_u32 s4, 7
    s_cbranch_scc0 L_nt24
    buffer_load_dword v24, v31, s[72:75], s79 offen
    buffer_load_dword v24, v31, s[72:75], s80 offen
    buffer_load_dword v24, v31, s[72:75], s81 offen
    buffer_load_dword v24, v31, s[72:75], s82 offen
    buffer_load_dword v24, v31, s[72:75], s83 offen
L_nt24:
    s_barrier
    ds_write_b128 v18, v[144:147] offset:16384
    ds_write_b128 v18, v[148:151] offset:17408
    ds_write_b128 v18, v[152:155] offset:18432
    ds_write_b128 v18, v[156:159] offset:19456
    s_waitcnt vmcnt(9)
    s_waitcnt lgkmcnt(0)
    v_mov_b32 v28, 23
    ds_max_u32 v27, v28
    s_mov_b32 m0, s24
    s_mov_b32 s11, 96
    buffer_load_dword off, s[20:23], s11 lds
    s_add_u32 m0, s88, 131072
    s_add_u32 s11, s27, 0
    buffer_load_dwordx4 v164, s[64:67], s11 offen offset:0  lds
    buffer_load_dwordx4 v165, s[64:67], s11 offen offset:1024  lds
    buffer_load_dwordx4 v166, s[64:67], s11 offen offset:2048  lds
    buffer_load_dwordx4 v167, s[64:67], s11 offen offset:3072  lds
    s_barrier
    s_add_u32 m0, s88, 98304
    s_add_u32 s11, s27, 128
    buffer_load_dwordx4 v164, s[64:67], s11 offen offset:0  lds
    buffer_load_dwordx4 v165, s[64:67], s11 offen offset:1024  lds
    buffer_load_dwordx4 v166, s[64:67], s11 offen offset:2048  lds
    buffer_load_dwordx4 v167, s[64:67], s11 offen offset:3072  lds
    s_mov_b32 m0, s24
    s_mov_b32 s11, 100
    buffer_load_dword off, s[20:23], s11 lds
    s_add_u32 m0, s88, 114688
    s_add_u32 s11, s28, 0
    buffer_load_dwordx4 v164, s[64:67], s11 offen offset:0  lds
    buffer_load_dwordx4 v165, s[64:67], s11 offen offset:1024  lds
    buffer_load_dwordx4 v166, s[64:67], s11 offen offset:2048  lds
    buffer_load_dwordx4 v167, s[64:67], s11 offen offset:3072  lds
    s_add_u32 m0, s84, 0
    s_nop 0
    buffer_load_dwordx4 v13, s[68:71], s79 offen offset:0  lds
    buffer_load_dwordx4 v14, s[68:71], s79 offen offset:1024  lds
    buffer_load_dwordx4 v15, s[68:71], s79 offen offset:2048  lds
    buffer_load_dwordx4 v16, s[68:71], s79 offen offset:3072  lds
    s_add_u32 m0, s84, 4096
    s_add_u32 s11, s79, 18432
    buffer_load_dwordx4 v13, s[68:71], s11 offen offset:0  lds
    buffer_load_dwordx4 v14, s[68:71], s11 offen offset:1024  lds
    buffer_load_dwordx4 v15, s[68:71], s11 offen offset:2048  lds
    buffer_load_dwordx4 v16, s[68:71], s11 offen offset:3072  lds
    s_add_u32 m0, s85, 150528
    s_nop 0
    buffer_load_dwordx4 v17, s[68:71], s79 offen  lds
    s_mov_b32 m0, s24
    s_mov_b32 s11, 104
    buffer_load_dword off, s[20:23], s11 lds
    s_barrier
    s_add_u32 m0, s88, 131072
    s_add_u32 s11, s28, 128
    buffer_load_dwordx4 v164, s[64:67], s11 offen offset:0  lds
    buffer_load_dwordx4 v165, s[64:67], s11 offen offset:1024  lds
    buffer_load_dwordx4 v166, s[64:67], s11 offen offset:2048  lds
    buffer_load_dwordx4 v167, s[64:67], s11 offen offset:3072  lds
    s_mov_b32 m0, s24
    s_mov_b32 s11, 108
    buffer_load_dword off, s[20:23], s11 lds
    s_add_u32 m0, s88, 98304
    s_add_u32 s11, s29, 0
    buffer_load_dwordx4 v164, s[64:67], s11 offen offset:0  lds
    buffer_load_dwordx4 v165, s[64:67], s11 offen offset:1024  lds
    buffer_load_dwordx4 v166, s[64:67], s11 offen offset:2048  lds
    buffer_load_dwordx4 v167, s[64:67], s11 offen offset:3072  lds
    s_add_u32 m0, s84, 32768
    s_nop 0
    buffer_load_dwordx4 v13, s[68:71], s80 offen offset:0  lds
    buffer_load_dwordx4 v14, s[68:71], s80 offen offset:1024  lds
    buffer_load_dwordx4 v15, s[68:71], s80 offen offset:2048  lds
    buffer_load_dwordx4 v16, s[68:71], s80 offen offset:3072  lds
    s_add_u32 m0, s84, 36864
    s_add_u32 s11, s80, 18432
    buffer_load_dwordx4 v13, s[68:71], s11 offen offset:0  lds
    buffer_load_dwordx4 v14, s[68:71], s11 offen offset:1024  lds
    buffer_load_dwordx4 v15, s[68:71], s11 offen offset:2048  lds
    buffer_load_dwordx4 v16, s[68:71], s11 offen offset:3072  lds
    s_add_u32 m0, s85, 154624
    s_nop 0
    buffer_load_dwordx4 v17, s[68:71], s80 offen  lds
    s_mov_b32 m0, s24
    s_mov_b32 s11, 112
    buffer_load_dword off, s[20:23], s11 lds
    s_barrier
    s_add_u32 m0, s88, 114688
    s_add_u32 s11, s29, 128
    buffer_load_dwordx4 v164, s[64:67], s11 offen offset:0  lds
    buffer_load_dwordx4 v165, s[64:67], s11 offen offset:1024  lds
    buffer_load_dwordx4 v166, s[64:67], s11 offen offset:2048  lds
    buffer_load_dwordx4 v167, s[64:67], s11 offen offset:3072  lds
    s_mov_b32 m0, s24
    s_mov_b32 s11, 116
    buffer_load_dword off, s[20:23], s11 lds
    s_add_u32 m0, s88, 131072
    s_add_u32 s11, s30, 0
    buffer_load_dwordx4 v164, s[64:67], s11 offen offset:0  lds
    buffer_load_dwordx4 v165, s[64:67], s11 offen offset:1024  lds
    buffer_load_dwordx4 v166, s[64:67], s11 offen offset:2048  lds
    buffer_load_dwordx4 v167, s[64:67], s11 offen offset:3072  lds
    s_add_u32 m0, s84, 65536
    s_nop 0
    buffer_load_dwordx4 v13, s[68:71], s81 offen offset:0  lds
    buffer_load_dwordx4 v14, s[68:71], s81 offen offset:1024  lds
    buffer_load_dwordx4 v15, s[68:71], s81 offen offset:2048  lds
    buffer_load_dwordx4 v16, s[68:71], s81 offen offset:3072  lds
    s_add_u32 m0, s84, 69632
    s_add_u32 s11, s81, 18432
    buffer_load_dwordx4 v13, s[68:71], s11 offen offset:0  lds
    buffer_load_dwordx4 v14, s[68:71], s11 offen offset:1024  lds
    buffer_load_dwordx4 v15, s[68:71], s11 offen offset:2048  lds
    buffer_load_dwordx4 v16, s[68:71], s11 offen offset:3072  lds
    s_add_u32 m0, s85, 158720
    s_nop 0
    buffer_load_dwordx4 v17, s[68:71], s81 offen  lds
    s_mov_b32 m0, s24
    s_mov_b32 s11, 120
    buffer_load_dword off, s[20:23], s11 lds
    s_barrier
    s_add_u32 m0, s88, 98304
    s_add_u32 s11, s30, 128
    buffer_load_dwordx4 v164, s[64:67], s11 offen offset:0  lds
    buffer_load_dwordx4 v165, s[64:67], s11 offen offset:1024  lds
    buffer_load_dwordx4 v166, s[64:67], s11 offen offset:2048  lds
    buffer_load_dwordx4 v167, s[64:67], s11 offen offset:3072  lds
    s_mov_b32 m0, s24
    s_mov_b32 s11, 124
    buffer_load_dword off, s[20:23], s11 lds
    s_add_u32 m0, s88, 114688
    s_add_u32 s11, s31, 0
    buffer_load_dwordx4 v164, s[64:67], s11 offen offset:0  lds
    buffer_load_dwordx4 v165, s[64:67], s11 offen offset:1024  lds
    buffer_load_dwordx4 v166, s[64:67], s11 offen offset:2048  lds
    buffer_load_dwordx4 v167, s[64:67], s11 offen offset:3072  lds
    s_add_u32 m0, s84, 0
    s_nop 0
    buffer_load_dwordx4 v13, s[68:71], s82 offen offset:0  lds
    buffer_load_dwordx4 v14, s[68:71], s82 offen offset:1024  lds
    buffer_load_dwordx4 v15, s[68:71], s82 offen offset:2048  lds
    buffer_load_dwordx4 v16, s[68:71], s82 offen offset:3072  lds
    s_add_u32 m0, s84, 4096
    s_add_u32 s11, s82, 18432
    buffer_load_dwordx4 v13, s[68:71], s11 offen offset:0  lds
    buffer_load_dwordx4 v14, s[68:71], s11 offen offset:1024  lds
    buffer_load_dwordx4 v15, s[68:71], s11 offen offset:2048  lds
    buffer_load_dwordx4 v16, s[68:71], s11 offen offset:3072  lds
    s_add_u32 m0, s85, 150528
    s_nop 0
    buffer_load_dwordx4 v17, s[68:71], s82 offen  lds
    s_mov_b32 m0, s24
    s_mov_b32 s11, 128
    buffer_load_dword off, s[20:23], s11 lds
    s_barrier
    s_add_u32 m0, s88, 131072
    s_add_u32 s11, s31, 128
    buffer_load_dwordx4 v164, s[64:67], s11 offen offset:0  lds
    buffer_load_dwordx4 v165, s[64:67], s11 offen offset:1024  lds
    buffer_load_dwordx4 v166, s[64:67], s11 offen offset:2048  lds
    buffer_load_dwordx4 v167, s[64:67], s11 offen offset:3072  lds
    s_mov_b32 m0, s24
    s_mov_b32 s11, 132
    buffer_load_dword off, s[20:23], s11 lds
    s_add_u32 m0, s88, 98304
    s_add_u32 s11, s32, 0
    buffer_load_dwordx4 v164, s[64:67], s11 offen offset:0  lds
    buffer_load_dwordx4 v165, s[64:67], s11 offen offset:1024  lds
    buffer_load_dwordx4 v166, s[64:67], s11 offen offset:2048  lds
    buffer_load_dwordx4 v167, s[64:67], s11 offen offset:3072  lds
    s_add_u32 m0, s84, 32768
    s_nop 0
    buffer_load_dwordx4 v13, s[68:71], s83 offen offset:0  lds
    buffer_load_dwordx4 v14, s[68:71], s83 offen offset:1024  lds
    buffer_load_dwordx4 v15, s[68:71], s83 offen offset:2048  lds
    buffer_load_dwordx4 v16, s[68:71], s83 offen offset:3072  lds
    s_add_u32 m0, s84, 36864
    s_add_u32 s11, s83, 18432
    buffer_load_dwordx4 v13, s[68:71], s11 offen offset:0  lds
    buffer_load_dwordx4 v14, s[68:71], s11 offen offset:1024  lds
    buffer_load_dwordx4 v15, s[68:71], s11 offen offset:2048  lds
    buffer_load_dwordx4 v16, s[68:71], s11 offen offset:3072  lds
    s_add_u32 m0, s85, 154624
    s_nop 0
    buffer_load_dwordx4 v17, s[68:71], s83 offen  lds
    s_mov_b32 m0, s24
    s_mov_b32 s11, 136
    buffer_load_dword off, s[20:23], s11 lds
    s_barrier
    s_add_u32 m0, s88, 114688
    s_add_u32 s11, s32, 128
    buffer_load_dwordx4 v164, s[64:67], s11 offen offset:0  lds
    buffer_load_dwordx4 v165, s[64:67], s11 offen offset:1024  lds
    buffer_load_dwordx4 v166, s[64:67], s11 offen offset:2048  lds
    buffer_load_dwordx4 v167, s[64:67], s11 offen offset:3072  lds
    s_mov_b32 m0, s24
    s_mov_b32 s11, 140
    buffer_load_dword off, s[20:23], s11 lds
    s_endpgm
L_fs13:
    s_mov_b32 s87, 0
L_fl13:
    s_sleep 1
    ds_read_b32 v29, v26
    s_add_u32 s87, s87, 1
    s_cmp_lt_u32 s87, 0x100000
    s_waitcnt lgkmcnt(0)
    s_cbranch_scc0 L_fo13
    v_cmp_gt_u32 vcc, 2, v29
    s_cbranch_vccnz L_fl13
    s_branch L_fo13
L_fs14:
    s_mov_b32 s87, 0
L_fl14:
    s_sleep 1
    ds_read_b32 v29, v26
    s_add_u32 s87, s87, 1
    s_cmp_lt_u32 s87, 0x100000
    s_waitcnt lgkmcnt(0)
    s_cbranch_scc0 L_fo14
    v_cmp_gt_u32 vcc, 4, v29
    s_cbranch_vccnz L_fl14
    s_branch L_fo14
L_fs15:
    s_mov_b32 s87, 0
L_fl15:
    s_sleep 1
    ds_read_b32 v29, v26
    s_add_u32 s87, s87, 1
    s_cmp_lt_u32 s87, 0x100000
    s_waitcnt lgkmcnt(0)
    s_cbranch_scc0 L_fo15
    v_cmp_gt_u32 vcc, 6, v29
    s_cbranch_vccnz L_fl15
    s_branch L_fo15
L_fs16:
    s_mov_b32 s87, 0
L_fl16:
    s_sleep 1
    ds_read_b32 v29, v26
    s_add_u32 s87, s87, 1
    s_cmp_lt_u32 s87, 0x100000
    s_waitcnt lgkmcnt(0)
    s_cbranch_scc0 L_fo16
    v_cmp_gt_u32 vcc, 8, v29
    s_cbranch_vccnz L_fl16
    s_branch L_fo16
L_fs17:
    s_mov_b32 s87, 0
L_fl17:
    s_sleep 1
    ds_read_b32 v29, v26
    s_add_u32 s87, s87, 1
    s_cmp_lt_u32 s87, 0x100000
    s_waitcnt lgkmcnt(0)
    s_cbranch_scc0 L_fo17
    v_cmp_gt_u32 vcc, 10, v29
    s_cbranch_vccnz L_fl17
    s_branch L_fo17
L_fs18:
    s_mov_b32 s87, 0
L_fl18:
    s_sleep 1
    ds_read_b32 v29, v26
    s_add_u32 s87, s87, 1
    s_cmp_lt_u32 s87, 0x100000
    s_waitcnt lgkmcnt(0)
    s_cbranch_scc0 L_fo18
    v_cmp_gt_u32 vcc, 12, v29
    s_cbranch_vccnz L_fl18
    s_branch L_fo18
L_fs20:
    s_mov_b32 s87, 0
L_fl20:
    s_sleep 1
    ds_read_b32 v29, v26
    s_add_u32 s87, s87, 1
    s_cmp_lt_u32 s87, 0x100000
    s_waitcnt lgkmcnt(0)
    s_cbranch_scc0 L_fo20
    v_cmp_gt_u32 vcc, 14, v29
    s_cbranch_vccnz L_fl20
    s_branch L_fo20
L_fs21:
    s_mov_b32 s87, 0
L_fl21:
    s_sleep 1
    ds_read_b32 v29, v26 offset:1024
    s_add_u32 s87, s87, 1
    s_cmp_lt_u32 s87, 0x100000
    s_waitcnt lgkmcnt(0)
    s_cbranch_scc0 L_fo21
    v_cmp_gt_u32 vcc, 16, v29
    s_cbranch_vccnz L_fl21
    s_branch L_fo21
L_fs22:
    s_mov_b32 s87, 0
L_fl22:
    s_sleep 1
    ds_read_b32 v29, v26 offset:1024
    s_add_u32 s87, s87, 1
    s_cmp_lt_u32 s87, 0x100000
    s_waitcnt lgkmcnt(0)
    s_cbranch_scc0 L_fo22
    v_cmp_gt_u32 vcc, 18, v29
    s_cbranch_vccnz L_fl22
    s_branch L_fo22
L_fs23:
    s_mov_b32 s87, 0
L_fl23:
    s_sleep 1
    ds_read_b32 v29, v26 offset:1024
    s_add_u32 s87, s87, 1
    s_cmp_lt_u32 s87, 0x100000
    s_waitcnt lgkmcnt(0)
    s_cbranch_scc0 L_fo23
    v_cmp_gt_u32 vcc, 20, v29
    s_cbranch_vccnz L_fl23
    s_branch L_fo23
L_compute:
    v_lshlrev_b32 v2, 2, v0
    v_add_u32 v2, 147456, v2
    v_mov_b32 v3, 0
    ds_write_b32 v2, v3
    ds_write_b32 v2, v3 offset:1024
    ds_write_b32 v2, v3 offset:2048
    s_waitcnt lgkmcnt(0)
    s_barrier
    s_lshl_b32 s3, s2, 8
    s_add_u32 s3, s3, 42991616
    s_add_u32 s96, s40, s3
    s_addc_u32 s97, s41, 0
    s_mov_b32 s98, 256
    s_mov_b32 s99, 0x00020000
    v_and_b32 v16, 31, v1
    v_lshlrev_b32 v13, 2, v16
    s_lshl_b32 s3, s5, 5
    s_add_u32 s12, s3, s10
    s_lshl_b32 s3, s12, 7
    s_add_u32 s3, s3, 41943040
    s_add_u32 s64, s40, s3
    s_addc_u32 s65, s41, 0
    s_mov_b32 s66, 128
    s_mov_b32 s67, 0x00020000
    s_getpc_b64 s[90:91]
L_pc:
    s_lshr_b32 s3, s2, 3
    s_lshl_b32 s3, s3, 2
    s_add_u32 s3, s3, s9
    s_lshl_b32 s3, s3, 9
    v_and_b32 v17, 3, v1
    v_lshl_add_u32 v17, v17, 7, s3
    v_min_u32 v17, L_end - concat_heads__mha_block_cached__mha_block_cached__near_ridge_kernel, v17
    s_sub_u32 s90, s90, L_pc - concat_heads__mha_block_cached__mha_block_cached__near_ridge_kernel
    s_subb_u32 s91, s91, 0
    v_mov_b32 v19, s91
    v_add_co_u32 v18, vcc, s90, v17
    s_nop 1
    v_addc_co_u32 v19, vcc, 0, v19, vcc
    global_load_dword v28, v[18:19], off
    v_and_b32 v21, 3, v1
    v_mul_u32_u24 v22, 260, v21
    v_add_u32 v22, 147456, v22
    s_lshl_b32 s3, s9, 8
    s_add_u32 s3, s3, 148480
    v_lshl_add_u32 v23, v1, 2, s3
    s_mov_b32 m0, s3
    v_add_u32 v23, 1024, v23
    s_lshl_b32 s88, s6, 2
    s_add_u32 s88, s88, s8
    s_lshl_b32 s88, s88, 7
    s_lshl_b32 s3, s12, 17
    s_lshl_b32 s11, s6, 15
    s_add_u32 s3, s3, s11
    s_add_u32 s3, s3, 0
    s_add_u32 s56, s40, s3
    s_addc_u32 s57, s41, 0
    s_mov_b32 s58, 32768
    s_mov_b32 s59, 0x00020000
    s_lshl_b32 s3, s12, 2
    s_add_u32 s3, s3, s8
    s_lshl_b32 s3, s3, 16
    s_add_u32 s3, s3, 16777216
    s_add_u32 s68, s40, s3
    s_addc_u32 s69, s41, 0
    s_mov_b32 s70, 65536
    s_mov_b32 s71, 0x00020000
    s_mul_i32 s3, s10, 73728
    s_mul_i32 s11, s5, 1152
    s_add_u32 s3, s3, s11
    s_sub_u32 s11, 2359296, s3
    s_add_u32 s72, s36, s3
    s_addc_u32 s73, s37, 0
    s_mov_b32 s74, s11
    s_mov_b32 s75, 0x00020000
    buffer_load_dword v14, off, s[64:67], 0 sc1
    v_lshrrev_b32 v17, 4, v1
    v_and_b32 v18, 15, v1
    v_bfe_u32 v19, v1, 2, 2
    v_lshlrev_b32 v19, 6, v19
    v_and_b32 v20, 1, v17
    v_lshl_add_u32 v19, v20, 5, v19
    v_lshl_add_u32 v19, v21, 3, v19
    v_lshl_add_u32 v2, v17, 11, v19
    v_lshrrev_b32 v19, 5, v1
    v_lshlrev_b32 v19, 9, v19
    v_lshl_add_u32 v3, v16, 3, v19
    v_lshrrev_b32 v19, 1, v18
    v_xor_b32 v19, v19, v17
    v_lshlrev_b32 v19, 4, v19
    v_lshl_add_u32 v19, v18, 7, v19
    s_lshl_b32 s3, s9, 12
    v_add_u32 v6, s3, v19
    v_lshrrev_b32 v19, 1, v17
    v_xor_b32 v19, v19, v18
    v_lshlrev_b32 v19, 4, v19
    v_lshl_add_u32 v19, v18, 8, v19
    v_lshl_add_u32 v19, v20, 3, v19
    s_lshl_b32 s3, s9, 13
    s_add_u32 s84, s3, 81920
    s_add_u32 s85, s3, 114688
    v_add_u32 v9, s84, v19
    v_add_u32 v12, 98304, v6
    v_lshlrev_b32 v10, 4, v1
    v_lshlrev_b32 v11, 2, v1
    v_add_u32 v11, 4096, v11
    s_mov_b32 s86, 0x3e0293ee
    s_add_u32 s3, s8, 0
    s_and_b32 s3, s3, 3
    s_lshl_b32 s76, s3, 13
    s_add_u32 s3, s8, 1
    s_and_b32 s3, s3, 3
    s_lshl_b32 s77, s3, 13
    s_add_u32 s3, s8, 2
    s_and_b32 s3, s3, 3
    s_lshl_b32 s78, s3, 13
    s_add_u32 s3, s8, 3
    s_and_b32 s3, s3, 3
    s_lshl_b32 s79, s3, 13
    v_mov_b32 v4, v2
    v_xor_b32 v5, 32, v2
    v_add_u32 v16, 65536, v4
    v_add_u32 v17, 65536, v5
    s_and_b32 s3, s6, 1
    s_lshl_b32 s3, s3, 11
    v_xor_b32 v7, s3, v6
    v_xor_b32 v8, 64, v7
    v_add_u32 v18, 98304, v7
    v_add_u32 v19, 98304, v8
    v_xor_b32 v24, 0x800, v7
    v_xor_b32 v25, 0x800, v8
    v_xor_b32 v26, 0x800, v18
    v_xor_b32 v27, 0x800, v19
    ds_read_b32 v21, v22
    s_waitcnt lgkmcnt(0)
    v_cmp_gt_u32 vcc, 1, v21
    s_cbranch_vccnz L_cs25
L_co25:
    ds_read_b128 v[192:195], v7 offset:16384
    ds_read_b128 v[196:199], v24 offset:16384
    ds_read_b64_tr_b16 v[160:161], v4 offset:0
    ds_read_b64_tr_b16 v[162:163], v4 offset:1024
    ds_read_b64_tr_b16 v[164:165], v5 offset:0
    ds_read_b64_tr_b16 v[166:167], v5 offset:1024
    ds_read_b64_tr_b16 v[168:169], v4 offset:256
    ds_read_b64_tr_b16 v[170:171], v4 offset:1280
    ds_read_b64_tr_b16 v[172:173], v5 offset:256
    ds_read_b64_tr_b16 v[174:175], v5 offset:1280
    ds_read_b64_tr_b16 v[176:177], v4 offset:512
    ds_read_b64_tr_b16 v[178:179], v4 offset:1536
    ds_read_b64_tr_b16 v[180:181], v5 offset:512
    ds_read_b64_tr_b16 v[182:183], v5 offset:1536
    s_waitcnt lgkmcnt(12)
    s_waitcnt lgkmcnt(8)
    v_mfma_f32_16x16x32_bf16 v[32:35], v[160:163], v[192:195], 0
    ds_read_b64_tr_b16 v[184:185], v4 offset:768
    v_mfma_f32_16x16x32_bf16 v[36:39], v[160:163], v[196:199], 0
    ds_read_b64_tr_b16 v[186:187], v4 offset:1792
    v_mfma_f32_16x16x32_bf16 v[40:43], v[164:167], v[192:195], 0
    ds_read_b64_tr_b16 v[188:189], v5 offset:768
    v_mfma_f32_16x16x32_bf16 v[44:47], v[164:167], v[196:199], 0
    ds_read_b64_tr_b16 v[190:191], v5 offset:1792
    s_waitcnt lgkmcnt(8)
    v_mfma_f32_16x16x32_bf16 v[48:51], v[168:171], v[192:195], 0
    ds_read_b32 v21, v22
    ds_read_b64_tr_b16 v[160:161], v4 offset:8192
    v_mfma_f32_16x16x32_bf16 v[52:55], v[168:171], v[196:199], 0
    ds_read_b64_tr_b16 v[162:163], v4 offset:9216
    v_mfma_f32_16x16x32_bf16 v[56:59], v[172:175], v[192:195], 0
    ds_read_b64_tr_b16 v[164:165], v5 offset:8192
    v_mfma_f32_16x16x32_bf16 v[60:63], v[172:175], v[196:199], 0
    ds_read_b64_tr_b16 v[166:167], v5 offset:9216
    s_waitcnt lgkmcnt(9)
    v_mfma_f32_16x16x32_bf16 v[64:67], v[176:179], v[192:195], 0
    ds_read_b64_tr_b16 v[168:169], v4 offset:8448
    v_mfma_f32_16x16x32_bf16 v[68:71], v[176:179], v[196:199], 0
    ds_read_b64_tr_b16 v[170:171], v4 offset:9472
    v_mfma_f32_16x16x32_bf16 v[72:75], v[180:183], v[192:195], 0
    ds_read_b64_tr_b16 v[172:173], v5 offset:8448
    v_mfma_f32_16x16x32_bf16 v[76:79], v[180:183], v[196:199], 0
    ds_read_b64_tr_b16 v[174:175], v5 offset:9472
    s_waitcnt lgkmcnt(9)
    v_mfma_f32_16x16x32_bf16 v[80:83], v[184:187], v[192:195], 0
    ds_read_b64_tr_b16 v[176:177], v4 offset:8704
    v_mfma_f32_16x16x32_bf16 v[84:87], v[184:187], v[196:199], 0
    ds_read_b64_tr_b16 v[178:179], v4 offset:9728
    v_mfma_f32_16x16x32_bf16 v[88:91], v[188:191], v[192:195], 0
    ds_read_b64_tr_b16 v[180:181], v5 offset:8704
    v_mfma_f32_16x16x32_bf16 v[92:95], v[188:191], v[196:199], 0
    ds_read_b64_tr_b16 v[182:183], v5 offset:9728
    s_waitcnt lgkmcnt(8)
    v_mfma_f32_16x16x32_bf16 v[96:99], v[160:163], v[192:195], 0
    ds_read_b64_tr_b16 v[184:185], v4 offset:8960
    v_mfma_f32_16x16x32_bf16 v[100:103], v[160:163], v[196:199], 0
    ds_read_b64_tr_b16 v[186:187], v4 offset:9984
    v_mfma_f32_16x16x32_bf16 v[104:107], v[164:167], v[192:195], 0
    v_cmp_gt_u32 vcc, 2, v21
    ds_read_b64_tr_b16 v[188:189], v5 offset:8960
    v_mfma_f32_16x16x32_bf16 v[108:111], v[164:167], v[196:199], 0
    ds_read_b64_tr_b16 v[190:191], v5 offset:9984
    s_waitcnt lgkmcnt(8)
    v_mfma_f32_16x16x32_bf16 v[112:115], v[168:171], v[192:195], 0
    s_cbranch_vccnz L_cs26
L_co26:
    ds_read_b64_tr_b16 v[160:161], v4 offset:32768
    v_mfma_f32_16x16x32_bf16 v[116:119], v[168:171], v[196:199], 0
    ds_read_b64_tr_b16 v[162:163], v4 offset:33792
    v_mfma_f32_16x16x32_bf16 v[120:123], v[172:175], v[192:195], 0
    ds_read_b64_tr_b16 v[164:165], v5 offset:32768
    v_mfma_f32_16x16x32_bf16 v[124:127], v[172:175], v[196:199], 0
    ds_read_b64_tr_b16 v[166:167], v5 offset:33792
    s_waitcnt lgkmcnt(8)
    v_mfma_f32_16x16x32_bf16 v[128:131], v[176:179], v[192:195], 0
    ds_read_b128 v[200:203], v8 offset:16384
    ds_read_b64_tr_b16 v[168:169], v4 offset:33024
    v_mfma_f32_16x16x32_bf16 v[132:135], v[176:179], v[196:199], 0
    ds_read_b64_tr_b16 v[170:171], v4 offset:34048
    v_mfma_f32_16x16x32_bf16 v[136:139], v[180:183], v[192:195], 0
    ds_read_b128 v[204:207], v25 offset:16384
    ds_read_b64_tr_b16 v[172:173], v5 offset:33024
    v_mfma_f32_16x16x32_bf16 v[140:143], v[180:183], v[196:199], 0
    ds_read_b64_tr_b16 v[174:175], v5 offset:34048
    s_waitcnt lgkmcnt(10)
    v_mfma_f32_16x16x32_bf16 v[144:147], v[184:187], v[192:195], 0
    ds_read_b64_tr_b16 v[176:177], v4 offset:33280
    v_mfma_f32_16x16x32_bf16 v[148:151], v[184:187], v[196:199], 0
    ds_read_b64_tr_b16 v[178:179], v4 offset:34304
    v_mfma_f32_16x16x32_bf16 v[152:155], v[188:191], v[192:195], 0
    ds_read_b64_tr_b16 v[180:181], v5 offset:33280
    v_mfma_f32_16x16x32_bf16 v[156:159], v[188:191], v[196:199], 0
    ds_read_b64_tr_b16 v[182:183], v5 offset:34304
    s_waitcnt lgkmcnt(6)
    v_mfma_f32_16x16x32_bf16 v[32:35], v[160:163], v[200:203], v[32:35]
    ds_read_b64_tr_b16 v[184:185], v4 offset:33536
    v_mfma_f32_16x16x32_bf16 v[36:39], v[160:163], v[204:207], v[36:39]
    ds_read_b64_tr_b16 v[186:187], v4 offset:34560
    v_mfma_f32_16x16x32_bf16 v[40:43], v[164:167], v[200:203], v[40:43]
    ds_read_b64_tr_b16 v[188:189], v5 offset:33536
    v_mfma_f32_16x16x32_bf16 v[44:47], v[164:167], v[204:207], v[44:47]
    ds_read_b64_tr_b16 v[190:191], v5 offset:34560
    s_waitcnt lgkmcnt(8)
    v_mfma_f32_16x16x32_bf16 v[48:51], v[168:171], v[200:203], v[48:51]
    ds_read_b32 v21, v22
    ds_read_b64_tr_b16 v[160:161], v4 offset:40960
    v_mfma_f32_16x16x32_bf16 v[52:55], v[168:171], v[204:207], v[52:55]
    ds_read_b64_tr_b16 v[162:163], v4 offset:41984
    v_mfma_f32_16x16x32_bf16 v[56:59], v[172:175], v[200:203], v[56:59]
    ds_read_b64_tr_b16 v[164:165], v5 offset:40960
    v_mfma_f32_16x16x32_bf16 v[60:63], v[172:175], v[204:207], v[60:63]
    ds_read_b64_tr_b16 v[166:167], v5 offset:41984
    s_waitcnt lgkmcnt(9)
    v_mfma_f32_16x16x32_bf16 v[64:67], v[176:179], v[200:203], v[64:67]
    ds_read_b64_tr_b16 v[168:169], v4 offset:41216
    v_mfma_f32_16x16x32_bf16 v[68:71], v[176:179], v[204:207], v[68:71]
    s_waitcnt vmcnt(0)
    v_readfirstlane_b32 s14, v14
    ds_read_b64_tr_b16 v[170:171], v4 offset:42240
    v_mfma_f32_16x16x32_bf16 v[72:75], v[180:183], v[200:203], v[72:75]
    ds_read_b64_tr_b16 v[172:173], v5 offset:41216
    v_mfma_f32_16x16x32_bf16 v[76:79], v[180:183], v[204:207], v[76:79]
    ds_read_b64_tr_b16 v[174:175], v5 offset:42240
    s_waitcnt lgkmcnt(9)
    v_mfma_f32_16x16x32_bf16 v[80:83], v[184:187], v[200:203], v[80:83]
    s_mov_b32 s15, 8
    ds_read_b64_tr_b16 v[176:177], v4 offset:41472
    v_mfma_f32_16x16x32_bf16 v[84:87], v[184:187], v[204:207], v[84:87]
    ds_read_b64_tr_b16 v[178:179], v4 offset:42496
    v_mfma_f32_16x16x32_bf16 v[88:91], v[188:191], v[200:203], v[88:91]
    ds_read_b64_tr_b16 v[180:181], v5 offset:41472
    v_mfma_f32_16x16x32_bf16 v[92:95], v[188:191], v[204:207], v[92:95]
    ds_read_b64_tr_b16 v[182:183], v5 offset:42496
    s_waitcnt lgkmcnt(8)
    v_mfma_f32_16x16x32_bf16 v[96:99], v[160:163], v[200:203], v[96:99]
    ds_read_b64_tr_b16 v[184:185], v4 offset:41728
    v_mfma_f32_16x16x32_bf16 v[100:103], v[160:163], v[204:207], v[100:103]
    ds_read_b64_tr_b16 v[186:187], v4 offset:42752
    v_mfma_f32_16x16x32_bf16 v[104:107], v[164:167], v[200:203], v[104:107]
    v_cmp_gt_u32 vcc, 3, v21
    ds_read_b64_tr_b16 v[188:189], v5 offset:41728
    v_mfma_f32_16x16x32_bf16 v[108:111], v[164:167], v[204:207], v[108:111]
    ds_read_b64_tr_b16 v[190:191], v5 offset:42752
    s_waitcnt lgkmcnt(8)
    v_mfma_f32_16x16x32_bf16 v[112:115], v[168:171], v[200:203], v[112:115]
    s_cbranch_vccnz L_cs27
L_co27:
    ds_read_b64_tr_b16 v[160:161], v16 offset:16384
    v_mfma_f32_16x16x32_bf16 v[116:119], v[168:171], v[204:207], v[116:119]
    ds_read_b64_tr_b16 v[162:163], v16 offset:17408
    v_mfma_f32_16x16x32_bf16 v[120:123], v[172:175], v[200:203], v[120:123]
    ds_read_b64_tr_b16 v[164:165], v17 offset:16384
    v_mfma_f32_16x16x32_bf16 v[124:127], v[172:175], v[204:207], v[124:127]
    ds_read_b64_tr_b16 v[166:167], v17 offset:17408
    s_waitcnt lgkmcnt(8)
    v_mfma_f32_16x16x32_bf16 v[128:131], v[176:179], v[200:203], v[128:131]
    ds_read_b128 v[192:195], v18 offset:0
    ds_read_b64_tr_b16 v[168:169], v16 offset:16640
    v_mfma_f32_16x16x32_bf16 v[132:135], v[176:179], v[204:207], v[132:135]
    ds_read_b64_tr_b16 v[170:171], v16 offset:17664
    v_mfma_f32_16x16x32_bf16 v[136:139], v[180:183], v[200:203], v[136:139]
    ds_read_b128 v[196:199], v26 offset:0
    ds_read_b64_tr_b16 v[172:173], v17 offset:16640
    v_mfma_f32_16x16x32_bf16 v[140:143], v[180:183], v[204:207], v[140:143]
    ds_read_b64_tr_b16 v[174:175], v17 offset:17664
    s_waitcnt lgkmcnt(10)
    v_mfma_f32_16x16x32_bf16 v[144:147], v[184:187], v[200:203], v[144:147]
    buffer_load_dword off, s[96:99], s15 lds
    ds_read_b64_tr_b16 v[176:177], v16 offset:16896
    v_mfma_f32_16x16x32_bf16 v[148:151], v[184:187], v[204:207], v[148:151]
    ds_read_b64_tr_b16 v[178:179], v16 offset:17920
    v_mfma_f32_16x16x32_bf16 v[152:155], v[188:191], v[200:203], v[152:155]
    ds_read_b64_tr_b16 v[180:181], v17 offset:16896
    v_mfma_f32_16x16x32_bf16 v[156:159], v[188:191], v[204:207], v[156:159]
    ds_read_b64_tr_b16 v[182:183], v17 offset:17920
    s_waitcnt lgkmcnt(6)
    v_mfma_f32_16x16x32_bf16 v[32:35], v[160:163], v[192:195], v[32:35]
    ds_read_b64_tr_b16 v[184:185], v16 offset:17152
    v_mfma_f32_16x16x32_bf16 v[36:39], v[160:163], v[196:199], v[36:39]
    ds_read_b64_tr_b16 v[186:187], v16 offset:18176
    v_mfma_f32_16x16x32_bf16 v[40:43], v[164:167], v[192:195], v[40:43]
    ds_read_b64_tr_b16 v[188:189], v17 offset:17152
    v_mfma_f32_16x16x32_bf16 v[44:47], v[164:167], v[196:199], v[44:47]
    ds_read_b64_tr_b16 v[190:191], v17 offset:18176
    s_waitcnt lgkmcnt(8)
    v_mfma_f32_16x16x32_bf16 v[48:51], v[168:171], v[192:195], v[48:51]
    ds_read_b32 v21, v22
    ds_read_b64_tr_b16 v[160:161], v16 offset:24576
    v_mfma_f32_16x16x32_bf16 v[52:55], v[168:171], v[196:199], v[52:55]
    ds_read_b64_tr_b16 v[162:163], v16 offset:25600
    v_mfma_f32_16x16x32_bf16 v[56:59], v[172:175], v[192:195], v[56:59]
    ds_read_b64_tr_b16 v[164:165], v17 offset:24576
    v_mfma_f32_16x16x32_bf16 v[60:63], v[172:175], v[196:199], v[60:63]
    ds_read_b64_tr_b16 v[166:167], v17 offset:25600
    s_waitcnt lgkmcnt(9)
    v_mfma_f32_16x16x32_bf16 v[64:67], v[176:179], v[192:195], v[64:67]
    ds_read_b64_tr_b16 v[168:169], v16 offset:24832
    v_mfma_f32_16x16x32_bf16 v[68:71], v[176:179], v[196:199], v[68:71]
    ds_read_b64_tr_b16 v[170:171], v16 offset:25856
    v_mfma_f32_16x16x32_bf16 v[72:75], v[180:183], v[192:195], v[72:75]
    ds_read_b64_tr_b16 v[172:173], v17 offset:24832
    v_mfma_f32_16x16x32_bf16 v[76:79], v[180:183], v[196:199], v[76:79]
    ds_read_b64_tr_b16 v[174:175], v17 offset:25856
    s_waitcnt lgkmcnt(9)
    v_mfma_f32_16x16x32_bf16 v[80:83], v[184:187], v[192:195], v[80:83]
    ds_read_b64_tr_b16 v[176:177], v16 offset:25088
    v_mfma_f32_16x16x32_bf16 v[84:87], v[184:187], v[196:199], v[84:87]
    ds_read_b64_tr_b16 v[178:179], v16 offset:26112
    v_mfma_f32_16x16x32_bf16 v[88:91], v[188:191], v[192:195], v[88:91]
    ds_read_b64_tr_b16 v[180:181], v17 offset:25088
    v_mfma_f32_16x16x32_bf16 v[92:95], v[188:191], v[196:199], v[92:95]
    ds_read_b64_tr_b16 v[182:183], v17 offset:26112
    s_waitcnt lgkmcnt(8)
    v_mfma_f32_16x16x32_bf16 v[96:99], v[160:163], v[192:195], v[96:99]
    ds_read_b64_tr_b16 v[184:185], v16 offset:25344
    v_mfma_f32_16x16x32_bf16 v[100:103], v[160:163], v[196:199], v[100:103]
    ds_read_b64_tr_b16 v[186:187], v16 offset:26368
    v_mfma_f32_16x16x32_bf16 v[104:107], v[164:167], v[192:195], v[104:107]
    v_cmp_gt_u32 vcc, 4, v21
    ds_read_b64_tr_b16 v[188:189], v17 offset:25344
    v_mfma_f32_16x16x32_bf16 v[108:111], v[164:167], v[196:199], v[108:111]
    ds_read_b64_tr_b16 v[190:191], v17 offset:26368
    s_waitcnt lgkmcnt(8)
    v_mfma_f32_16x16x32_bf16 v[112:115], v[168:171], v[192:195], v[112:115]
    s_cbranch_vccnz L_cs28
L_co28:
    ds_read_b64_tr_b16 v[160:161], v4 offset:49152
    v_mfma_f32_16x16x32_bf16 v[116:119], v[168:171], v[196:199], v[116:119]
    ds_read_b64_tr_b16 v[162:163], v4 offset:50176
    v_mfma_f32_16x16x32_bf16 v[120:123], v[172:175], v[192:195], v[120:123]
    ds_read_b64_tr_b16 v[164:165], v5 offset:49152
    v_mfma_f32_16x16x32_bf16 v[124:127], v[172:175], v[196:199], v[124:127]
    ds_read_b64_tr_b16 v[166:167], v5 offset:50176
    s_waitcnt lgkmcnt(8)
    v_mfma_f32_16x16x32_bf16 v[128:131], v[176:179], v[192:195], v[128:131]
    ds_read_b128 v[200:203], v19 offset:0
    ds_read_b64_tr_b16 v[168:169], v4 offset:49408
    v_mfma_f32_16x16x32_bf16 v[132:135], v[176:179], v[196:199], v[132:135]
    ds_read_b64_tr_b16 v[170:171], v4 offset:50432
    v_mfma_f32_16x16x32_bf16 v[136:139], v[180:183], v[192:195], v[136:139]
    ds_read_b128 v[204:207], v27 offset:0
    ds_read_b64_tr_b16 v[172:173], v5 offset:49408
    v_mfma_f32_16x16x32_bf16 v[140:143], v[180:183], v[196:199], v[140:143]
    ds_read_b64_tr_b16 v[174:175], v5 offset:50432
    s_waitcnt lgkmcnt(10)
    v_mfma_f32_16x16x32_bf16 v[144:147], v[184:187], v[192:195], v[144:147]
    ds_read_b64_tr_b16 v[176:177], v4 offset:49664
    v_mfma_f32_16x16x32_bf16 v[148:151], v[184:187], v[196:199], v[148:151]
    ds_read_b64_tr_b16 v[178:179], v4 offset:50688
    v_mfma_f32_16x16x32_bf16 v[152:155], v[188:191], v[192:195], v[152:155]
    ds_read_b64_tr_b16 v[180:181], v5 offset:49664
    v_mfma_f32_16x16x32_bf16 v[156:159], v[188:191], v[196:199], v[156:159]
    ds_read_b64_tr_b16 v[182:183], v5 offset:50688
    s_waitcnt lgkmcnt(6)
    v_mfma_f32_16x16x32_bf16 v[32:35], v[160:163], v[200:203], v[32:35]
    ds_read_b64_tr_b16 v[184:185], v4 offset:49920
    v_mfma_f32_16x16x32_bf16 v[36:39], v[160:163], v[204:207], v[36:39]
    ds_read_b64_tr_b16 v[186:187], v4 offset:50944
    v_mfma_f32_16x16x32_bf16 v[40:43], v[164:167], v[200:203], v[40:43]
    ds_read_b64_tr_b16 v[188:189], v5 offset:49920
    v_mfma_f32_16x16x32_bf16 v[44:47], v[164:167], v[204:207], v[44:47]
    ds_read_b64_tr_b16 v[190:191], v5 offset:50944
    s_waitcnt lgkmcnt(8)
    v_mfma_f32_16x16x32_bf16 v[48:51], v[168:171], v[200:203], v[48:51]
    ds_read_b32 v21, v22
    ds_read_b64_tr_b16 v[160:161], v4 offset:57344
    v_mfma_f32_16x16x32_bf16 v[52:55], v[168:171], v[204:207], v[52:55]
    ds_read_b64_tr_b16 v[162:163], v4 offset:58368
    v_mfma_f32_16x16x32_bf16 v[56:59], v[172:175], v[200:203], v[56:59]
    ds_read_b64_tr_b16 v[164:165], v5 offset:57344
    v_mfma_f32_16x16x32_bf16 v[60:63], v[172:175], v[204:207], v[60:63]
    ds_read_b64_tr_b16 v[166:167], v5 offset:58368
    s_waitcnt lgkmcnt(9)
    v_mfma_f32_16x16x32_bf16 v[64:67], v[176:179], v[200:203], v[64:67]
    ds_read_b64_tr_b16 v[168:169], v4 offset:57600
    v_mfma_f32_16x16x32_bf16 v[68:71], v[176:179], v[204:207], v[68:71]
    ds_read_b64_tr_b16 v[170:171], v4 offset:58624
    v_mfma_f32_16x16x32_bf16 v[72:75], v[180:183], v[200:203], v[72:75]
    ds_read_b64_tr_b16 v[172:173], v5 offset:57600
    v_mfma_f32_16x16x32_bf16 v[76:79], v[180:183], v[204:207], v[76:79]
    ds_read_b64_tr_b16 v[174:175], v5 offset:58624
    s_waitcnt lgkmcnt(9)
    v_mfma_f32_16x16x32_bf16 v[80:83], v[184:187], v[200:203], v[80:83]
    s_mov_b32 s15, 16
    ds_read_b64_tr_b16 v[176:177], v4 offset:57856
    v_mfma_f32_16x16x32_bf16 v[84:87], v[184:187], v[204:207], v[84:87]
    ds_read_b64_tr_b16 v[178:179], v4 offset:58880
    v_mfma_f32_16x16x32_bf16 v[88:91], v[188:191], v[200:203], v[88:91]
    ds_read_b64_tr_b16 v[180:181], v5 offset:57856
    v_mfma_f32_16x16x32_bf16 v[92:95], v[188:191], v[204:207], v[92:95]
    ds_read_b64_tr_b16 v[182:183], v5 offset:58880
    s_waitcnt lgkmcnt(8)
    v_mfma_f32_16x16x32_bf16 v[96:99], v[160:163], v[200:203], v[96:99]
    ds_read_b64_tr_b16 v[184:185], v4 offset:58112
    v_mfma_f32_16x16x32_bf16 v[100:103], v[160:163], v[204:207], v[100:103]
    ds_read_b64_tr_b16 v[186:187], v4 offset:59136
    v_mfma_f32_16x16x32_bf16 v[104:107], v[164:167], v[200:203], v[104:107]
    v_cmp_gt_u32 vcc, 5, v21
    ds_read_b64_tr_b16 v[188:189], v5 offset:58112
    v_mfma_f32_16x16x32_bf16 v[108:111], v[164:167], v[204:207], v[108:111]
    ds_read_b64_tr_b16 v[190:191], v5 offset:59136
    s_waitcnt lgkmcnt(8)
    v_mfma_f32_16x16x32_bf16 v[112:115], v[168:171], v[200:203], v[112:115]
    s_cbranch_vccnz L_cs29
L_co29:
    ds_read_b64_tr_b16 v[160:161], v16 offset:0
    v_mfma_f32_16x16x32_bf16 v[116:119], v[168:171], v[204:207], v[116:119]
    ds_read_b64_tr_b16 v[162:163], v16 offset:1024
    v_mfma_f32_16x16x32_bf16 v[120:123], v[172:175], v[200:203], v[120:123]
    ds_read_b64_tr_b16 v[164:165], v17 offset:0
    v_mfma_f32_16x16x32_bf16 v[124:127], v[172:175], v[204:207], v[124:127]
    ds_read_b64_tr_b16 v[166:167], v17 offset:1024
    s_waitcnt lgkmcnt(8)
    v_mfma_f32_16x16x32_bf16 v[128:131], v[176:179], v[200:203], v[128:131]
    ds_read_b128 v[192:195], v18 offset:32768
    ds_read_b64_tr_b16 v[168:169], v16 offset:256
    v_mfma_f32_16x16x32_bf16 v[132:135], v[176:179], v[204:207], v[132:135]
    ds_read_b64_tr_b16 v[170:171], v16 offset:1280
    v_mfma_f32_16x16x32_bf16 v[136:139], v[180:183], v[200:203], v[136:139]
    ds_read_b128 v[196:199], v26 offset:32768
    ds_read_b64_tr_b16 v[172:173], v17 offset:256
    v_mfma_f32_16x16x32_bf16 v[140:143], v[180:183], v[204:207], v[140:143]
    ds_read_b64_tr_b16 v[174:175], v17 offset:1280
    s_waitcnt lgkmcnt(10)
    v_mfma_f32_16x16x32_bf16 v[144:147], v[184:187], v[200:203], v[144:147]
    buffer_load_dword off, s[96:99], s15 lds
    ds_read_b64_tr_b16 v[176:177], v16 offset:512
    v_mfma_f32_16x16x32_bf16 v[148:151], v[184:187], v[204:207], v[148:151]
    ds_read_b64_tr_b16 v[178:179], v16 offset:1536
    v_mfma_f32_16x16x32_bf16 v[152:155], v[188:191], v[200:203], v[152:155]
    ds_read_b64_tr_b16 v[180:181], v17 offset:512
    v_mfma_f32_16x16x32_bf16 v[156:159], v[188:191], v[204:207], v[156:159]
    ds_read_b64_tr_b16 v[182:183], v17 offset:1536
    s_waitcnt lgkmcnt(6)
    v_mfma_f32_16x16x32_bf16 v[32:35], v[160:163], v[192:195], v[32:35]
    ds_read_b64_tr_b16 v[184:185], v16 offset:768
    v_mfma_f32_16x16x32_bf16 v[36:39], v[160:163], v[196:199], v[36:39]
    ds_read_b64_tr_b16 v[186:187], v16 offset:1792
    v_mfma_f32_16x16x32_bf16 v[40:43], v[164:167], v[192:195], v[40:43]
    ds_read_b64_tr_b16 v[188:189], v17 offset:768
    v_mfma_f32_16x16x32_bf16 v[44:47], v[164:167], v[196:199], v[44:47]
    ds_read_b64_tr_b16 v[190:191], v17 offset:1792
    s_waitcnt lgkmcnt(8)
    v_mfma_f32_16x16x32_bf16 v[48:51], v[168:171], v[192:195], v[48:51]
    ds_read_b32 v21, v22
    ds_read_b64_tr_b16 v[160:161], v16 offset:8192
    v_mfma_f32_16x16x32_bf16 v[52:55], v[168:171], v[196:199], v[52:55]
    ds_read_b64_tr_b16 v[162:163], v16 offset:9216
    v_mfma_f32_16x16x32_bf16 v[56:59], v[172:175], v[192:195], v[56:59]
    ds_read_b64_tr_b16 v[164:165], v17 offset:8192
    v_mfma_f32_16x16x32_bf16 v[60:63], v[172:175], v[196:199], v[60:63]
    ds_read_b64_tr_b16 v[166:167], v17 offset:9216
    s_waitcnt lgkmcnt(9)
    v_mfma_f32_16x16x32_bf16 v[64:67], v[176:179], v[192:195], v[64:67]
    ds_read_b64_tr_b16 v[168:169], v16 offset:8448
    v_mfma_f32_16x16x32_bf16 v[68:71], v[176:179], v[196:199], v[68:71]
    ds_read_b64_tr_b16 v[170:171], v16 offset:9472
    v_mfma_f32_16x16x32_bf16 v[72:75], v[180:183], v[192:195], v[72:75]
    ds_read_b64_tr_b16 v[172:173], v17 offset:8448
    v_mfma_f32_16x16x32_bf16 v[76:79], v[180:183], v[196:199], v[76:79]
    ds_read_b64_tr_b16 v[174:175], v17 offset:9472
    s_waitcnt lgkmcnt(9)
    v_mfma_f32_16x16x32_bf16 v[80:83], v[184:187], v[192:195], v[80:83]
    ds_read_b64_tr_b16 v[176:177], v16 offset:8704
    v_mfma_f32_16x16x32_bf16 v[84:87], v[184:187], v[196:199], v[84:87]
    ds_read_b64_tr_b16 v[178:179], v16 offset:9728
    v_mfma_f32_16x16x32_bf16 v[88:91], v[188:191], v[192:195], v[88:91]
    ds_read_b64_tr_b16 v[180:181], v17 offset:8704
    v_mfma_f32_16x16x32_bf16 v[92:95], v[188:191], v[196:199], v[92:95]
    ds_read_b64_tr_b16 v[182:183], v17 offset:9728
    s_waitcnt lgkmcnt(8)
    v_mfma_f32_16x16x32_bf16 v[96:99], v[160:163], v[192:195], v[96:99]
    ds_read_b64_tr_b16 v[184:185], v16 offset:8960
    v_mfma_f32_16x16x32_bf16 v[100:103], v[160:163], v[196:199], v[100:103]
    ds_read_b64_tr_b16 v[186:187], v16 offset:9984
    v_mfma_f32_16x16x32_bf16 v[104:107], v[164:167], v[192:195], v[104:107]
    v_cmp_gt_u32 vcc, 6, v21
    ds_read_b64_tr_b16 v[188:189], v17 offset:8960
    v_mfma_f32_16x16x32_bf16 v[108:111], v[164:167], v[196:199], v[108:111]
    ds_read_b64_tr_b16 v[190:191], v17 offset:9984
    s_waitcnt lgkmcnt(8)
    v_mfma_f32_16x16x32_bf16 v[112:115], v[168:171], v[192:195], v[112:115]
    s_cbranch_vccnz L_cs30
L_co30:
    ds_read_b64_tr_b16 v[160:161], v16 offset:49152
    v_mfma_f32_16x16x32_bf16 v[116:119], v[168:171], v[196:199], v[116:119]
    ds_read_b64_tr_b16 v[162:163], v16 offset:50176
    v_mfma_f32_16x16x32_bf16 v[120:123], v[172:175], v[192:195], v[120:123]
    ds_read_b64_tr_b16 v[164:165], v17 offset:49152
    v_mfma_f32_16x16x32_bf16 v[124:127], v[172:175], v[196:199], v[124:127]
    ds_read_b64_tr_b16 v[166:167], v17 offset:50176
    s_waitcnt lgkmcnt(8)
    v_mfma_f32_16x16x32_bf16 v[128:131], v[176:179], v[192:195], v[128:131]
    ds_read_b128 v[200:203], v19 offset:32768
    ds_read_b64_tr_b16 v[168:169], v16 offset:49408
    v_mfma_f32_16x16x32_bf16 v[132:135], v[176:179], v[196:199], v[132:135]
    ds_read_b64_tr_b16 v[170:171], v16 offset:50432
    v_mfma_f32_16x16x32_bf16 v[136:139], v[180:183], v[192:195], v[136:139]
    ds_read_b128 v[204:207], v27 offset:32768
    ds_read_b64_tr_b16 v[172:173], v17 offset:49408
    v_mfma_f32_16x16x32_bf16 v[140:143], v[180:183], v[196:199], v[140:143]
    ds_read_b64_tr_b16 v[174:175], v17 offset:50432
    s_waitcnt lgkmcnt(10)
    v_mfma_f32_16x16x32_bf16 v[144:147], v[184:187], v[192:195], v[144:147]
    ds_read_b64_tr_b16 v[176:177], v16 offset:49664
    v_mfma_f32_16x16x32_bf16 v[148:151], v[184:187], v[196:199], v[148:151]
    ds_read_b64_tr_b16 v[178:179], v16 offset:50688
    v_mfma_f32_16x16x32_bf16 v[152:155], v[188:191], v[192:195], v[152:155]
    ds_read_b64_tr_b16 v[180:181], v17 offset:49664
    v_mfma_f32_16x16x32_bf16 v[156:159], v[188:191], v[196:199], v[156:159]
    ds_read_b64_tr_b16 v[182:183], v17 offset:50688
    s_waitcnt lgkmcnt(6)
    v_mfma_f32_16x16x32_bf16 v[32:35], v[160:163], v[200:203], v[32:35]
    ds_read_b64_tr_b16 v[184:185], v16 offset:49920
    v_mfma_f32_16x16x32_bf16 v[36:39], v[160:163], v[204:207], v[36:39]
    ds_read_b64_tr_b16 v[186:187], v16 offset:50944
    v_mfma_f32_16x16x32_bf16 v[40:43], v[164:167], v[200:203], v[40:43]
    ds_read_b64_tr_b16 v[188:189], v17 offset:49920
    v_mfma_f32_16x16x32_bf16 v[44:47], v[164:167], v[204:207], v[44:47]
    ds_read_b64_tr_b16 v[190:191], v17 offset:50944
    s_waitcnt lgkmcnt(8)
    v_mfma_f32_16x16x32_bf16 v[48:51], v[168:171], v[200:203], v[48:51]
    ds_read_b32 v21, v22
    ds_read_b64_tr_b16 v[160:161], v16 offset:57344
    v_mfma_f32_16x16x32_bf16 v[52:55], v[168:171], v[204:207], v[52:55]
    ds_read_b64_tr_b16 v[162:163], v16 offset:58368
    v_mfma_f32_16x16x32_bf16 v[56:59], v[172:175], v[200:203], v[56:59]
    ds_read_b64_tr_b16 v[164:165], v17 offset:57344
    v_mfma_f32_16x16x32_bf16 v[60:63], v[172:175], v[204:207], v[60:63]
    ds_read_b64_tr_b16 v[166:167], v17 offset:58368
    s_waitcnt lgkmcnt(9)
    v_mfma_f32_16x16x32_bf16 v[64:67], v[176:179], v[200:203], v[64:67]
    ds_read_b64_tr_b16 v[168:169], v16 offset:57600
    v_mfma_f32_16x16x32_bf16 v[68:71], v[176:179], v[204:207], v[68:71]
    ds_read_b64_tr_b16 v[170:171], v16 offset:58624
    v_mfma_f32_16x16x32_bf16 v[72:75], v[180:183], v[200:203], v[72:75]
    ds_read_b64_tr_b16 v[172:173], v17 offset:57600
    v_mfma_f32_16x16x32_bf16 v[76:79], v[180:183], v[204:207], v[76:79]
    ds_read_b64_tr_b16 v[174:175], v17 offset:58624
    s_waitcnt lgkmcnt(9)
    v_mfma_f32_16x16x32_bf16 v[80:83], v[184:187], v[200:203], v[80:83]
    s_mov_b32 s15, 24
    ds_read_b64_tr_b16 v[176:177], v16 offset:57856
    v_mfma_f32_16x16x32_bf16 v[84:87], v[184:187], v[204:207], v[84:87]
    ds_read_b64_tr_b16 v[178:179], v16 offset:58880
    v_mfma_f32_16x16x32_bf16 v[88:91], v[188:191], v[200:203], v[88:91]
    ds_read_b64_tr_b16 v[180:181], v17 offset:57856
    v_mfma_f32_16x16x32_bf16 v[92:95], v[188:191], v[204:207], v[92:95]
    ds_read_b64_tr_b16 v[182:183], v17 offset:58880
    s_waitcnt lgkmcnt(8)
    v_mfma_f32_16x16x32_bf16 v[96:99], v[160:163], v[200:203], v[96:99]
    ds_read_b64_tr_b16 v[184:185], v16 offset:58112
    v_mfma_f32_16x16x32_bf16 v[100:103], v[160:163], v[204:207], v[100:103]
    ds_read_b64_tr_b16 v[186:187], v16 offset:59136
    v_mfma_f32_16x16x32_bf16 v[104:107], v[164:167], v[200:203], v[104:107]
    v_cmp_gt_u32 vcc, 7, v21
    ds_read_b64_tr_b16 v[188:189], v17 offset:58112
    v_mfma_f32_16x16x32_bf16 v[108:111], v[164:167], v[204:207], v[108:111]
    ds_read_b64_tr_b16 v[190:191], v17 offset:59136
    s_waitcnt lgkmcnt(8)
    v_mfma_f32_16x16x32_bf16 v[112:115], v[168:171], v[200:203], v[112:115]
    s_cbranch_vccnz L_cs31
L_co31:
    ds_read_b64_tr_b16 v[160:161], v4 offset:0
    v_mfma_f32_16x16x32_bf16 v[116:119], v[168:171], v[204:207], v[116:119]
    ds_read_b64_tr_b16 v[162:163], v4 offset:1024
    v_mfma_f32_16x16x32_bf16 v[120:123], v[172:175], v[200:203], v[120:123]
    ds_read_b64_tr_b16 v[164:165], v5 offset:0
    v_mfma_f32_16x16x32_bf16 v[124:127], v[172:175], v[204:207], v[124:127]
    ds_read_b64_tr_b16 v[166:167], v5 offset:1024
    s_waitcnt lgkmcnt(8)
    v_mfma_f32_16x16x32_bf16 v[128:131], v[176:179], v[200:203], v[128:131]
    ds_read_b128 v[192:195], v7 offset:16384
    ds_read_b64_tr_b16 v[168:169], v4 offset:256
    v_mfma_f32_16x16x32_bf16 v[132:135], v[176:179], v[204:207], v[132:135]
    ds_read_b64_tr_b16 v[170:171], v4 offset:1280
    v_mfma_f32_16x16x32_bf16 v[136:139], v[180:183], v[200:203], v[136:139]
    ds_read_b128 v[196:199], v24 offset:16384
    ds_read_b64_tr_b16 v[172:173], v5 offset:256
    v_mfma_f32_16x16x32_bf16 v[140:143], v[180:183], v[204:207], v[140:143]
    ds_read_b64_tr_b16 v[174:175], v5 offset:1280
    s_waitcnt lgkmcnt(10)
    v_mfma_f32_16x16x32_bf16 v[144:147], v[184:187], v[200:203], v[144:147]
    buffer_load_dword off, s[96:99], s15 lds
    ds_read_b64_tr_b16 v[176:177], v4 offset:512
    v_mfma_f32_16x16x32_bf16 v[148:151], v[184:187], v[204:207], v[148:151]
    ds_read_b64_tr_b16 v[178:179], v4 offset:1536
    v_mfma_f32_16x16x32_bf16 v[152:155], v[188:191], v[200:203], v[152:155]
    ds_read_b64_tr_b16 v[180:181], v5 offset:512
    v_mfma_f32_16x16x32_bf16 v[156:159], v[188:191], v[204:207], v[156:159]
    ds_read_b64_tr_b16 v[182:183], v5 offset:1536
    s_waitcnt lgkmcnt(6)
    v_mfma_f32_16x16x32_bf16 v[32:35], v[160:163], v[192:195], v[32:35]
    ds_read_b64_tr_b16 v[184:185], v4 offset:768
    v_mfma_f32_16x16x32_bf16 v[36:39], v[160:163], v[196:199], v[36:39]
    ds_read_b64_tr_b16 v[186:187], v4 offset:1792
    v_mfma_f32_16x16x32_bf16 v[40:43], v[164:167], v[192:195], v[40:43]
    ds_read_b64_tr_b16 v[188:189], v5 offset:768
    v_mfma_f32_16x16x32_bf16 v[44:47], v[164:167], v[196:199], v[44:47]
    ds_read_b64_tr_b16 v[190:191], v5 offset:1792
    s_waitcnt lgkmcnt(8)
    v_mfma_f32_16x16x32_bf16 v[48:51], v[168:171], v[192:195], v[48:51]
    ds_read_b32 v21, v22
    ds_read_b64_tr_b16 v[160:161], v4 offset:8192
    v_mfma_f32_16x16x32_bf16 v[52:55], v[168:171], v[196:199], v[52:55]
    ds_read_b64_tr_b16 v[162:163], v4 offset:9216
    v_mfma_f32_16x16x32_bf16 v[56:59], v[172:175], v[192:195], v[56:59]
    ds_read_b64_tr_b16 v[164:165], v5 offset:8192
    v_mfma_f32_16x16x32_bf16 v[60:63], v[172:175], v[196:199], v[60:63]
    ds_read_b64_tr_b16 v[166:167], v5 offset:9216
    s_waitcnt lgkmcnt(9)
    v_mfma_f32_16x16x32_bf16 v[64:67], v[176:179], v[192:195], v[64:67]
    ds_read_b64_tr_b16 v[168:169], v4 offset:8448
    v_mfma_f32_16x16x32_bf16 v[68:71], v[176:179], v[196:199], v[68:71]
    ds_read_b64_tr_b16 v[170:171], v4 offset:9472
    v_mfma_f32_16x16x32_bf16 v[72:75], v[180:183], v[192:195], v[72:75]
    ds_read_b64_tr_b16 v[172:173], v5 offset:8448
    v_mfma_f32_16x16x32_bf16 v[76:79], v[180:183], v[196:199], v[76:79]
    ds_read_b64_tr_b16 v[174:175], v5 offset:9472
    s_waitcnt lgkmcnt(9)
    v_mfma_f32_16x16x32_bf16 v[80:83], v[184:187], v[192:195], v[80:83]
    ds_read_b64_tr_b16 v[176:177], v4 offset:8704
    v_mfma_f32_16x16x32_bf16 v[84:87], v[184:187], v[196:199], v[84:87]
    ds_read_b64_tr_b16 v[178:179], v4 offset:9728
    v_mfma_f32_16x16x32_bf16 v[88:91], v[188:191], v[192:195], v[88:91]
    ds_read_b64_tr_b16 v[180:181], v5 offset:8704
    v_mfma_f32_16x16x32_bf16 v[92:95], v[188:191], v[196:199], v[92:95]
    ds_read_b64_tr_b16 v[182:183], v5 offset:9728
    s_waitcnt lgkmcnt(8)
    v_mfma_f32_16x16x32_bf16 v[96:99], v[160:163], v[192:195], v[96:99]
    ds_read_b64_tr_b16 v[184:185], v4 offset:8960
    v_mfma_f32_16x16x32_bf16 v[100:103], v[160:163], v[196:199], v[100:103]
    ds_read_b64_tr_b16 v[186:187], v4 offset:9984
    v_mfma_f32_16x16x32_bf16 v[104:107], v[164:167], v[192:195], v[104:107]
    v_cmp_gt_u32 vcc, 8, v21
    ds_read_b64_tr_b16 v[188:189], v5 offset:8960
    v_mfma_f32_16x16x32_bf16 v[108:111], v[164:167], v[196:199], v[108:111]
    ds_read_b64_tr_b16 v[190:191], v5 offset:9984
    s_waitcnt lgkmcnt(8)
    v_mfma_f32_16x16x32_bf16 v[112:115], v[168:171], v[192:195], v[112:115]
    s_cbranch_vccnz L_cs32
L_co32:
    ds_read_b64_tr_b16 v[160:161], v4 offset:32768
    v_mfma_f32_16x16x32_bf16 v[116:119], v[168:171], v[196:199], v[116:119]
    ds_read_b64_tr_b16 v[162:163], v4 offset:33792
    v_mfma_f32_16x16x32_bf16 v[120:123], v[172:175], v[192:195], v[120:123]
    ds_read_b64_tr_b16 v[164:165], v5 offset:32768
    v_mfma_f32_16x16x32_bf16 v[124:127], v[172:175], v[196:199], v[124:127]
    ds_read_b64_tr_b16 v[166:167], v5 offset:33792
    s_waitcnt lgkmcnt(8)
    v_mfma_f32_16x16x32_bf16 v[128:131], v[176:179], v[192:195], v[128:131]
    ds_read_b128 v[200:203], v8 offset:16384
    ds_read_b64_tr_b16 v[168:169], v4 offset:33024
    v_mfma_f32_16x16x32_bf16 v[132:135], v[176:179], v[196:199], v[132:135]
    ds_read_b64_tr_b16 v[170:171], v4 offset:34048
    v_mfma_f32_16x16x32_bf16 v[136:139], v[180:183], v[192:195], v[136:139]
    ds_read_b128 v[204:207], v25 offset:16384
    ds_read_b64_tr_b16 v[172:173], v5 offset:33024
    v_mfma_f32_16x16x32_bf16 v[140:143], v[180:183], v[196:199], v[140:143]
    ds_read_b64_tr_b16 v[174:175], v5 offset:34048
    s_waitcnt lgkmcnt(10)
    v_mfma_f32_16x16x32_bf16 v[144:147], v[184:187], v[192:195], v[144:147]
    ds_read_b64_tr_b16 v[176:177], v4 offset:33280
    v_mfma_f32_16x16x32_bf16 v[148:151], v[184:187], v[196:199], v[148:151]
    ds_read_b64_tr_b16 v[178:179], v4 offset:34304
    v_mfma_f32_16x16x32_bf16 v[152:155], v[188:191], v[192:195], v[152:155]
    ds_read_b64_tr_b16 v[180:181], v5 offset:33280
    v_mfma_f32_16x16x32_bf16 v[156:159], v[188:191], v[196:199], v[156:159]
    ds_read_b64_tr_b16 v[182:183], v5 offset:34304
    s_waitcnt lgkmcnt(6)
    v_mfma_f32_16x16x32_bf16 v[32:35], v[160:163], v[200:203], v[32:35]
    ds_read_b64_tr_b16 v[184:185], v4 offset:33536
    v_mfma_f32_16x16x32_bf16 v[36:39], v[160:163], v[204:207], v[36:39]
    ds_read_b64_tr_b16 v[186:187], v4 offset:34560
    v_mfma_f32_16x16x32_bf16 v[40:43], v[164:167], v[200:203], v[40:43]
    ds_read_b64_tr_b16 v[188:189], v5 offset:33536
    v_mfma_f32_16x16x32_bf16 v[44:47], v[164:167], v[204:207], v[44:47]
    ds_read_b64_tr_b16 v[190:191], v5 offset:34560
    s_waitcnt lgkmcnt(8)
    v_mfma_f32_16x16x32_bf16 v[48:51], v[168:171], v[200:203], v[48:51]
    ds_read_b32 v21, v22
    ds_read_b64_tr_b16 v[160:161], v4 offset:40960
    v_mfma_f32_16x16x32_bf16 v[52:55], v[168:171], v[204:207], v[52:55]
    ds_read_b64_tr_b16 v[162:163], v4 offset:41984
    v_mfma_f32_16x16x32_bf16 v[56:59], v[172:175], v[200:203], v[56:59]
    ds_read_b64_tr_b16 v[164:165], v5 offset:40960
    v_mfma_f32_16x16x32_bf16 v[60:63], v[172:175], v[204:207], v[60:63]
    ds_read_b64_tr_b16 v[166:167], v5 offset:41984
    s_waitcnt lgkmcnt(9)
    v_mfma_f32_16x16x32_bf16 v[64:67], v[176:179], v[200:203], v[64:67]
    ds_read_b64_tr_b16 v[168:169], v4 offset:41216
    v_mfma_f32_16x16x32_bf16 v[68:71], v[176:179], v[204:207], v[68:71]
    ds_read_b64_tr_b16 v[170:171], v4 offset:42240
    v_mfma_f32_16x16x32_bf16 v[72:75], v[180:183], v[200:203], v[72:75]
    ds_read_b64_tr_b16 v[172:173], v5 offset:41216
    v_mfma_f32_16x16x32_bf16 v[76:79], v[180:183], v[204:207], v[76:79]
    ds_read_b64_tr_b16 v[174:175], v5 offset:42240
    s_waitcnt lgkmcnt(9)
    v_mfma_f32_16x16x32_bf16 v[80:83], v[184:187], v[200:203], v[80:83]
    s_mov_b32 s15, 32
    ds_read_b64_tr_b16 v[176:177], v4 offset:41472
    v_mfma_f32_16x16x32_bf16 v[84:87], v[184:187], v[204:207], v[84:87]
    ds_read_b64_tr_b16 v[178:179], v4 offset:42496
    v_mfma_f32_16x16x32_bf16 v[88:91], v[188:191], v[200:203], v[88:91]
    ds_read_b64_tr_b16 v[180:181], v5 offset:41472
    v_mfma_f32_16x16x32_bf16 v[92:95], v[188:191], v[204:207], v[92:95]
    ds_read_b64_tr_b16 v[182:183], v5 offset:42496
    s_waitcnt lgkmcnt(8)
    v_mfma_f32_16x16x32_bf16 v[96:99], v[160:163], v[200:203], v[96:99]
    ds_read_b64_tr_b16 v[184:185], v4 offset:41728
    v_mfma_f32_16x16x32_bf16 v[100:103], v[160:163], v[204:207], v[100:103]
    ds_read_b64_tr_b16 v[186:187], v4 offset:42752
    v_mfma_f32_16x16x32_bf16 v[104:107], v[164:167], v[200:203], v[104:107]
    v_cmp_gt_u32 vcc, 9, v21
    ds_read_b64_tr_b16 v[188:189], v5 offset:41728
    v_mfma_f32_16x16x32_bf16 v[108:111], v[164:167], v[204:207], v[108:111]
    ds_read_b64_tr_b16 v[190:191], v5 offset:42752
    s_waitcnt lgkmcnt(8)
    v_mfma_f32_16x16x32_bf16 v[112:115], v[168:171], v[200:203], v[112:115]
    s_cbranch_vccnz L_cs33
L_co33:
    ds_read_b64_tr_b16 v[160:161], v16 offset:16384
    v_mfma_f32_16x16x32_bf16 v[116:119], v[168:171], v[204:207], v[116:119]
    ds_read_b64_tr_b16 v[162:163], v16 offset:17408
    v_mfma_f32_16x16x32_bf16 v[120:123], v[172:175], v[200:203], v[120:123]
    ds_read_b64_tr_b16 v[164:165], v17 offset:16384
    v_mfma_f32_16x16x32_bf16 v[124:127], v[172:175], v[204:207], v[124:127]
    ds_read_b64_tr_b16 v[166:167], v17 offset:17408
    s_waitcnt lgkmcnt(8)
    v_mfma_f32_16x16x32_bf16 v[128:131], v[176:179], v[200:203], v[128:131]
    ds_read_b128 v[192:195], v18 offset:0
    ds_read_b64_tr_b16 v[168:169], v16 offset:16640
    v_mfma_f32_16x16x32_bf16 v[132:135], v[176:179], v[204:207], v[132:135]
    ds_read_b64_tr_b16 v[170:171], v16 offset:17664
    v_mfma_f32_16x16x32_bf16 v[136:139], v[180:183], v[200:203], v[136:139]
    ds_read_b128 v[196:199], v26 offset:0
    ds_read_b64_tr_b16 v[172:173], v17 offset:16640
    v_mfma_f32_16x16x32_bf16 v[140:143], v[180:183], v[204:207], v[140:143]
    ds_read_b64_tr_b16 v[174:175], v17 offset:17664
    s_waitcnt lgkmcnt(10)
    v_mfma_f32_16x16x32_bf16 v[144:147], v[184:187], v[200:203], v[144:147]
    buffer_load_dword off, s[96:99], s15 lds
    ds_read_b64_tr_b16 v[176:177], v16 offset:16896
    v_mfma_f32_16x16x32_bf16 v[148:151], v[184:187], v[204:207], v[148:151]
    ds_read_b64_tr_b16 v[178:179], v16 offset:17920
    v_mfma_f32_16x16x32_bf16 v[152:155], v[188:191], v[200:203], v[152:155]
    ds_read_b64_tr_b16 v[180:181], v17 offset:16896
    v_mfma_f32_16x16x32_bf16 v[156:159], v[188:191], v[204:207], v[156:159]
    ds_read_b64_tr_b16 v[182:183], v17 offset:17920
    s_waitcnt lgkmcnt(6)
    v_mfma_f32_16x16x32_bf16 v[32:35], v[160:163], v[192:195], v[32:35]
    ds_read_b64_tr_b16 v[184:185], v16 offset:17152
    v_mfma_f32_16x16x32_bf16 v[36:39], v[160:163], v[196:199], v[36:39]
    ds_read_b64_tr_b16 v[186:187], v16 offset:18176
    v_mfma_f32_16x16x32_bf16 v[40:43], v[164:167], v[192:195], v[40:43]
    ds_read_b64_tr_b16 v[188:189], v17 offset:17152
    v_mfma_f32_16x16x32_bf16 v[44:47], v[164:167], v[196:199], v[44:47]
    ds_read_b64_tr_b16 v[190:191], v17 offset:18176
    s_waitcnt lgkmcnt(8)
    v_mfma_f32_16x16x32_bf16 v[48:51], v[168:171], v[192:195], v[48:51]
    ds_read_b32 v21, v22
    ds_read_b64_tr_b16 v[160:161], v16 offset:24576
    v_mfma_f32_16x16x32_bf16 v[52:55], v[168:171], v[196:199], v[52:55]
    ds_read_b64_tr_b16 v[162:163], v16 offset:25600
    v_mfma_f32_16x16x32_bf16 v[56:59], v[172:175], v[192:195], v[56:59]
    ds_read_b64_tr_b16 v[164:165], v17 offset:24576
    v_mfma_f32_16x16x32_bf16 v[60:63], v[172:175], v[196:199], v[60:63]
    ds_read_b64_tr_b16 v[166:167], v17 offset:25600
    s_waitcnt lgkmcnt(9)
    v_mfma_f32_16x16x32_bf16 v[64:67], v[176:179], v[192:195], v[64:67]
    ds_read_b64_tr_b16 v[168:169], v16 offset:24832
    v_mfma_f32_16x16x32_bf16 v[68:71], v[176:179], v[196:199], v[68:71]
    ds_read_b64_tr_b16 v[170:171], v16 offset:25856
    v_mfma_f32_16x16x32_bf16 v[72:75], v[180:183], v[192:195], v[72:75]
    ds_read_b64_tr_b16 v[172:173], v17 offset:24832
    v_mfma_f32_16x16x32_bf16 v[76:79], v[180:183], v[196:199], v[76:79]
    ds_read_b64_tr_b16 v[174:175], v17 offset:25856
    s_waitcnt lgkmcnt(9)
    v_mfma_f32_16x16x32_bf16 v[80:83], v[184:187], v[192:195], v[80:83]
    ds_read_b64_tr_b16 v[176:177], v16 offset:25088
    v_mfma_f32_16x16x32_bf16 v[84:87], v[184:187], v[196:199], v[84:87]
    ds_read_b64_tr_b16 v[178:179], v16 offset:26112
    v_mfma_f32_16x16x32_bf16 v[88:91], v[188:191], v[192:195], v[88:91]
    ds_read_b64_tr_b16 v[180:181], v17 offset:25088
    v_mfma_f32_16x16x32_bf16 v[92:95], v[188:191], v[196:199], v[92:95]
    ds_read_b64_tr_b16 v[182:183], v17 offset:26112
    s_waitcnt lgkmcnt(8)
    v_mfma_f32_16x16x32_bf16 v[96:99], v[160:163], v[192:195], v[96:99]
    ds_read_b64_tr_b16 v[184:185], v16 offset:25344
    v_mfma_f32_16x16x32_bf16 v[100:103], v[160:163], v[196:199], v[100:103]
    ds_read_b64_tr_b16 v[186:187], v16 offset:26368
    v_mfma_f32_16x16x32_bf16 v[104:107], v[164:167], v[192:195], v[104:107]
    v_cmp_gt_u32 vcc, 10, v21
    ds_read_b64_tr_b16 v[188:189], v17 offset:25344
    v_mfma_f32_16x16x32_bf16 v[108:111], v[164:167], v[196:199], v[108:111]
    ds_read_b64_tr_b16 v[190:191], v17 offset:26368
    s_waitcnt lgkmcnt(8)
    v_mfma_f32_16x16x32_bf16 v[112:115], v[168:171], v[192:195], v[112:115]
    s_cbranch_vccnz L_cs34
L_co34:
    ds_read_b64_tr_b16 v[160:161], v4 offset:49152
    v_mfma_f32_16x16x32_bf16 v[116:119], v[168:171], v[196:199], v[116:119]
    ds_read_b64_tr_b16 v[162:163], v4 offset:50176
    v_mfma_f32_16x16x32_bf16 v[120:123], v[172:175], v[192:195], v[120:123]
    ds_read_b64_tr_b16 v[164:165], v5 offset:49152
    v_mfma_f32_16x16x32_bf16 v[124:127], v[172:175], v[196:199], v[124:127]
    ds_read_b64_tr_b16 v[166:167], v5 offset:50176
    s_waitcnt lgkmcnt(8)
    v_mfma_f32_16x16x32_bf16 v[128:131], v[176:179], v[192:195], v[128:131]
    ds_read_b128 v[200:203], v19 offset:0
    ds_read_b64_tr_b16 v[168:169], v4 offset:49408
    v_mfma_f32_16x16x32_bf16 v[132:135], v[176:179], v[196:199], v[132:135]
    ds_read_b64_tr_b16 v[170:171], v4 offset:50432
    v_mfma_f32_16x16x32_bf16 v[136:139], v[180:183], v[192:195], v[136:139]
    ds_read_b128 v[204:207], v27 offset:0
    ds_read_b64_tr_b16 v[172:173], v5 offset:49408
    v_mfma_f32_16x16x32_bf16 v[140:143], v[180:183], v[196:199], v[140:143]
    ds_read_b64_tr_b16 v[174:175], v5 offset:50432
    s_waitcnt lgkmcnt(10)
    v_mfma_f32_16x16x32_bf16 v[144:147], v[184:187], v[192:195], v[144:147]
    ds_read_b64_tr_b16 v[176:177], v4 offset:49664
    v_mfma_f32_16x16x32_bf16 v[148:151], v[184:187], v[196:199], v[148:151]
    ds_read_b64_tr_b16 v[178:179], v4 offset:50688
    v_mfma_f32_16x16x32_bf16 v[152:155], v[188:191], v[192:195], v[152:155]
    ds_read_b64_tr_b16 v[180:181], v5 offset:49664
    v_mfma_f32_16x16x32_bf16 v[156:159], v[188:191], v[196:199], v[156:159]
    ds_read_b64_tr_b16 v[182:183], v5 offset:50688
    s_waitcnt lgkmcnt(6)
    v_mfma_f32_16x16x32_bf16 v[32:35], v[160:163], v[200:203], v[32:35]
    ds_read_b64_tr_b16 v[184:185], v4 offset:49920
    v_mfma_f32_16x16x32_bf16 v[36:39], v[160:163], v[204:207], v[36:39]
    ds_read_b64_tr_b16 v[186:187], v4 offset:50944
    v_mfma_f32_16x16x32_bf16 v[40:43], v[164:167], v[200:203], v[40:43]
    ds_read_b64_tr_b16 v[188:189], v5 offset:49920
    v_mfma_f32_16x16x32_bf16 v[44:47], v[164:167], v[204:207], v[44:47]
    ds_read_b64_tr_b16 v[190:191], v5 offset:50944
    s_waitcnt lgkmcnt(8)
    v_mfma_f32_16x16x32_bf16 v[48:51], v[168:171], v[200:203], v[48:51]
    ds_read_b32 v21, v22
    ds_read_b64_tr_b16 v[160:161], v4 offset:57344
    v_mfma_f32_16x16x32_bf16 v[52:55], v[168:171], v[204:207], v[52:55]
    ds_read_b64_tr_b16 v[162:163], v4 offset:58368
    v_mfma_f32_16x16x32_bf16 v[56:59], v[172:175], v[200:203], v[56:59]
    ds_read_b64_tr_b16 v[164:165], v5 offset:57344
    v_mfma_f32_16x16x32_bf16 v[60:63], v[172:175], v[204:207], v[60:63]
    ds_read_b64_tr_b16 v[166:167], v5 offset:58368
    s_waitcnt lgkmcnt(9)
    v_mfma_f32_16x16x32_bf16 v[64:67], v[176:179], v[200:203], v[64:67]
    ds_read_b64_tr_b16 v[168:169], v4 offset:57600
    v_mfma_f32_16x16x32_bf16 v[68:71], v[176:179], v[204:207], v[68:71]
    ds_read_b64_tr_b16 v[170:171], v4 offset:58624
    v_mfma_f32_16x16x32_bf16 v[72:75], v[180:183], v[200:203], v[72:75]
    ds_read_b64_tr_b16 v[172:173], v5 offset:57600
    v_mfma_f32_16x16x32_bf16 v[76:79], v[180:183], v[204:207], v[76:79]
    ds_read_b64_tr_b16 v[174:175], v5 offset:58624
    s_waitcnt lgkmcnt(9)
    v_mfma_f32_16x16x32_bf16 v[80:83], v[184:187], v[200:203], v[80:83]
    s_mov_b32 s15, 40
    ds_read_b64_tr_b16 v[176:177], v4 offset:57856
    v_mfma_f32_16x16x32_bf16 v[84:87], v[184:187], v[204:207], v[84:87]
    ds_read_b64_tr_b16 v[178:179], v4 offset:58880
    v_mfma_f32_16x16x32_bf16 v[88:91], v[188:191], v[200:203], v[88:91]
    ds_read_b64_tr_b16 v[180:181], v5 offset:57856
    v_mfma_f32_16x16x32_bf16 v[92:95], v[188:191], v[204:207], v[92:95]
    ds_read_b64_tr_b16 v[182:183], v5 offset:58880
    s_waitcnt lgkmcnt(8)
    v_mfma_f32_16x16x32_bf16 v[96:99], v[160:163], v[200:203], v[96:99]
    ds_read_b64_tr_b16 v[184:185], v4 offset:58112
    v_mfma_f32_16x16x32_bf16 v[100:103], v[160:163], v[204:207], v[100:103]
    ds_read_b64_tr_b16 v[186:187], v4 offset:59136
    v_mfma_f32_16x16x32_bf16 v[104:107], v[164:167], v[200:203], v[104:107]
    v_cmp_gt_u32 vcc, 11, v21
    ds_read_b64_tr_b16 v[188:189], v5 offset:58112
    v_mfma_f32_16x16x32_bf16 v[108:111], v[164:167], v[204:207], v[108:111]
    ds_read_b64_tr_b16 v[190:191], v5 offset:59136
    s_waitcnt lgkmcnt(8)
    v_mfma_f32_16x16x32_bf16 v[112:115], v[168:171], v[200:203], v[112:115]
    s_cbranch_vccnz L_cs35
L_co35:
    ds_read_b64_tr_b16 v[160:161], v16 offset:0
    v_mfma_f32_16x16x32_bf16 v[116:119], v[168:171], v[204:207], v[116:119]
    ds_read_b64_tr_b16 v[162:163], v16 offset:1024
    v_mfma_f32_16x16x32_bf16 v[120:123], v[172:175], v[200:203], v[120:123]
    ds_read_b64_tr_b16 v[164:165], v17 offset:0
    v_mfma_f32_16x16x32_bf16 v[124:127], v[172:175], v[204:207], v[124:127]
    ds_read_b64_tr_b16 v[166:167], v17 offset:1024
    s_waitcnt lgkmcnt(8)
    v_mfma_f32_16x16x32_bf16 v[128:131], v[176:179], v[200:203], v[128:131]
    ds_read_b128 v[192:195], v18 offset:32768
    ds_read_b64_tr_b16 v[168:169], v16 offset:256
    v_mfma_f32_16x16x32_bf16 v[132:135], v[176:179], v[204:207], v[132:135]
    ds_read_b64_tr_b16 v[170:171], v16 offset:1280
    v_mfma_f32_16x16x32_bf16 v[136:139], v[180:183], v[200:203], v[136:139]
    ds_read_b128 v[196:199], v26 offset:32768
    ds_read_b64_tr_b16 v[172:173], v17 offset:256
    v_mfma_f32_16x16x32_bf16 v[140:143], v[180:183], v[204:207], v[140:143]
    ds_read_b64_tr_b16 v[174:175], v17 offset:1280
    s_waitcnt lgkmcnt(10)
    v_mfma_f32_16x16x32_bf16 v[144:147], v[184:187], v[200:203], v[144:147]
    buffer_load_dword off, s[96:99], s15 lds
    ds_read_b64_tr_b16 v[176:177], v16 offset:512
    v_mfma_f32_16x16x32_bf16 v[148:151], v[184:187], v[204:207], v[148:151]
    ds_read_b64_tr_b16 v[178:179], v16 offset:1536
    v_mfma_f32_16x16x32_bf16 v[152:155], v[188:191], v[200:203], v[152:155]
    ds_read_b64_tr_b16 v[180:181], v17 offset:512
    v_mfma_f32_16x16x32_bf16 v[156:159], v[188:191], v[204:207], v[156:159]
    ds_read_b64_tr_b16 v[182:183], v17 offset:1536
    s_waitcnt lgkmcnt(6)
    v_mfma_f32_16x16x32_bf16 v[32:35], v[160:163], v[192:195], v[32:35]
    ds_read_b64_tr_b16 v[184:185], v16 offset:768
    v_mfma_f32_16x16x32_bf16 v[36:39], v[160:163], v[196:199], v[36:39]
    ds_read_b64_tr_b16 v[186:187], v16 offset:1792
    v_mfma_f32_16x16x32_bf16 v[40:43], v[164:167], v[192:195], v[40:43]
    ds_read_b64_tr_b16 v[188:189], v17 offset:768
    v_mfma_f32_16x16x32_bf16 v[44:47], v[164:167], v[196:199], v[44:47]
    ds_read_b64_tr_b16 v[190:191], v17 offset:1792
    s_waitcnt lgkmcnt(8)
    v_mfma_f32_16x16x32_bf16 v[48:51], v[168:171], v[192:195], v[48:51]
    ds_read_b32 v21, v22
    ds_read_b64_tr_b16 v[160:161], v16 offset:8192
    v_mfma_f32_16x16x32_bf16 v[52:55], v[168:171], v[196:199], v[52:55]
    ds_read_b64_tr_b16 v[162:163], v16 offset:9216
    v_mfma_f32_16x16x32_bf16 v[56:59], v[172:175], v[192:195], v[56:59]
    ds_read_b64_tr_b16 v[164:165], v17 offset:8192
    v_mfma_f32_16x16x32_bf16 v[60:63], v[172:175], v[196:199], v[60:63]
    ds_read_b64_tr_b16 v[166:167], v17 offset:9216
    s_waitcnt lgkmcnt(9)
    v_mfma_f32_16x16x32_bf16 v[64:67], v[176:179], v[192:195], v[64:67]
    ds_read_b64_tr_b16 v[168:169], v16 offset:8448
    v_mfma_f32_16x16x32_bf16 v[68:71], v[176:179], v[196:199], v[68:71]
    ds_read_b64_tr_b16 v[170:171], v16 offset:9472
    v_mfma_f32_16x16x32_bf16 v[72:75], v[180:183], v[192:195], v[72:75]
    ds_read_b64_tr_b16 v[172:173], v17 offset:8448
    v_mfma_f32_16x16x32_bf16 v[76:79], v[180:183], v[196:199], v[76:79]
    ds_read_b64_tr_b16 v[174:175], v17 offset:9472
    s_waitcnt lgkmcnt(9)
    v_mfma_f32_16x16x32_bf16 v[80:83], v[184:187], v[192:195], v[80:83]
    ds_read_b64_tr_b16 v[176:177], v16 offset:8704
    v_mfma_f32_16x16x32_bf16 v[84:87], v[184:187], v[196:199], v[84:87]
    ds_read_b64_tr_b16 v[178:179], v16 offset:9728
    v_mfma_f32_16x16x32_bf16 v[88:91], v[188:191], v[192:195], v[88:91]
    ds_read_b64_tr_b16 v[180:181], v17 offset:8704
    v_mfma_f32_16x16x32_bf16 v[92:95], v[188:191], v[196:199], v[92:95]
    ds_read_b64_tr_b16 v[182:183], v17 offset:9728
    s_waitcnt lgkmcnt(8)
    v_mfma_f32_16x16x32_bf16 v[96:99], v[160:163], v[192:195], v[96:99]
    ds_read_b64_tr_b16 v[184:185], v16 offset:8960
    v_mfma_f32_16x16x32_bf16 v[100:103], v[160:163], v[196:199], v[100:103]
    ds_read_b64_tr_b16 v[186:187], v16 offset:9984
    v_mfma_f32_16x16x32_bf16 v[104:107], v[164:167], v[192:195], v[104:107]
    v_cmp_gt_u32 vcc, 12, v21
    ds_read_b64_tr_b16 v[188:189], v17 offset:8960
    v_mfma_f32_16x16x32_bf16 v[108:111], v[164:167], v[196:199], v[108:111]
    ds_read_b64_tr_b16 v[190:191], v17 offset:9984
    s_waitcnt lgkmcnt(8)
    v_mfma_f32_16x16x32_bf16 v[112:115], v[168:171], v[192:195], v[112:115]
    s_cbranch_vccnz L_cs36
L_co36:
    ds_read_b64_tr_b16 v[160:161], v16 offset:49152
    v_mfma_f32_16x16x32_bf16 v[116:119], v[168:171], v[196:199], v[116:119]
    ds_read_b64_tr_b16 v[162:163], v16 offset:50176
    v_mfma_f32_16x16x32_bf16 v[120:123], v[172:175], v[192:195], v[120:123]
    ds_read_b64_tr_b16 v[164:165], v17 offset:49152
    v_mfma_f32_16x16x32_bf16 v[124:127], v[172:175], v[196:199], v[124:127]
    ds_read_b64_tr_b16 v[166:167], v17 offset:50176
    s_waitcnt lgkmcnt(8)
    v_mfma_f32_16x16x32_bf16 v[128:131], v[176:179], v[192:195], v[128:131]
    ds_read_b128 v[200:203], v19 offset:32768
    ds_read_b64_tr_b16 v[168:169], v16 offset:49408
    v_mfma_f32_16x16x32_bf16 v[132:135], v[176:179], v[196:199], v[132:135]
    ds_read_b64_tr_b16 v[170:171], v16 offset:50432
    v_mfma_f32_16x16x32_bf16 v[136:139], v[180:183], v[192:195], v[136:139]
    ds_read_b128 v[204:207], v27 offset:32768
    ds_read_b64_tr_b16 v[172:173], v17 offset:49408
    v_mfma_f32_16x16x32_bf16 v[140:143], v[180:183], v[196:199], v[140:143]
    ds_read_b64_tr_b16 v[174:175], v17 offset:50432
    s_waitcnt lgkmcnt(10)
    v_mfma_f32_16x16x32_bf16 v[144:147], v[184:187], v[192:195], v[144:147]
    ds_read_b64_tr_b16 v[176:177], v16 offset:49664
    v_mfma_f32_16x16x32_bf16 v[148:151], v[184:187], v[196:199], v[148:151]
    ds_read_b64_tr_b16 v[178:179], v16 offset:50688
    v_mfma_f32_16x16x32_bf16 v[152:155], v[188:191], v[192:195], v[152:155]
    ds_read_b64_tr_b16 v[180:181], v17 offset:49664
    v_mfma_f32_16x16x32_bf16 v[156:159], v[188:191], v[196:199], v[156:159]
    ds_read_b64_tr_b16 v[182:183], v17 offset:50688
    s_waitcnt lgkmcnt(6)
    v_mfma_f32_16x16x32_bf16 v[32:35], v[160:163], v[200:203], v[32:35]
    ds_read_b64_tr_b16 v[184:185], v16 offset:49920
    v_mfma_f32_16x16x32_bf16 v[36:39], v[160:163], v[204:207], v[36:39]
    ds_read_b64_tr_b16 v[186:187], v16 offset:50944
    v_mfma_f32_16x16x32_bf16 v[40:43], v[164:167], v[200:203], v[40:43]
    ds_read_b64_tr_b16 v[188:189], v17 offset:49920
    v_mfma_f32_16x16x32_bf16 v[44:47], v[164:167], v[204:207], v[44:47]
    ds_read_b64_tr_b16 v[190:191], v17 offset:50944
    s_waitcnt lgkmcnt(8)
    v_mfma_f32_16x16x32_bf16 v[48:51], v[168:171], v[200:203], v[48:51]
    ds_read_b32 v21, v22
    ds_read_b64_tr_b16 v[160:161], v16 offset:57344
    v_mfma_f32_16x16x32_bf16 v[52:55], v[168:171], v[204:207], v[52:55]
    ds_read_b64_tr_b16 v[162:163], v16 offset:58368
    v_mfma_f32_16x16x32_bf16 v[56:59], v[172:175], v[200:203], v[56:59]
    ds_read_b64_tr_b16 v[164:165], v17 offset:57344
    v_mfma_f32_16x16x32_bf16 v[60:63], v[172:175], v[204:207], v[60:63]
    ds_read_b64_tr_b16 v[166:167], v17 offset:58368
    s_waitcnt lgkmcnt(9)
    v_mfma_f32_16x16x32_bf16 v[64:67], v[176:179], v[200:203], v[64:67]
    ds_read_b64_tr_b16 v[168:169], v16 offset:57600
    v_mfma_f32_16x16x32_bf16 v[68:71], v[176:179], v[204:207], v[68:71]
    ds_read_b64_tr_b16 v[170:171], v16 offset:58624
    v_mfma_f32_16x16x32_bf16 v[72:75], v[180:183], v[200:203], v[72:75]
    ds_read_b64_tr_b16 v[172:173], v17 offset:57600
    v_mfma_f32_16x16x32_bf16 v[76:79], v[180:183], v[204:207], v[76:79]
    ds_read_b64_tr_b16 v[174:175], v17 offset:58624
    s_waitcnt lgkmcnt(9)
    v_mfma_f32_16x16x32_bf16 v[80:83], v[184:187], v[200:203], v[80:83]
    s_mov_b32 s15, 48
    ds_read_b64_tr_b16 v[176:177], v16 offset:57856
    v_mfma_f32_16x16x32_bf16 v[84:87], v[184:187], v[204:207], v[84:87]
    ds_read_b64_tr_b16 v[178:179], v16 offset:58880
    v_mfma_f32_16x16x32_bf16 v[88:91], v[188:191], v[200:203], v[88:91]
    ds_read_b64_tr_b16 v[180:181], v17 offset:57856
    v_mfma_f32_16x16x32_bf16 v[92:95], v[188:191], v[204:207], v[92:95]
    ds_read_b64_tr_b16 v[182:183], v17 offset:58880
    s_waitcnt lgkmcnt(8)
    v_mfma_f32_16x16x32_bf16 v[96:99], v[160:163], v[200:203], v[96:99]
    ds_read_b64_tr_b16 v[184:185], v16 offset:58112
    v_mfma_f32_16x16x32_bf16 v[100:103], v[160:163], v[204:207], v[100:103]
    ds_read_b64_tr_b16 v[186:187], v16 offset:59136
    v_mfma_f32_16x16x32_bf16 v[104:107], v[164:167], v[200:203], v[104:107]
    v_cmp_gt_u32 vcc, 13, v21
    ds_read_b64_tr_b16 v[188:189], v17 offset:58112
    v_mfma_f32_16x16x32_bf16 v[108:111], v[164:167], v[204:207], v[108:111]
    ds_read_b64_tr_b16 v[190:191], v17 offset:59136
    s_waitcnt lgkmcnt(8)
    v_mfma_f32_16x16x32_bf16 v[112:115], v[168:171], v[200:203], v[112:115]
    s_cbranch_vccnz L_cs37
L_co37:
    ds_read_b64_tr_b16 v[160:161], v4 offset:0
    v_mfma_f32_16x16x32_bf16 v[116:119], v[168:171], v[204:207], v[116:119]
    ds_read_b64_tr_b16 v[162:163], v4 offset:1024
    v_mfma_f32_16x16x32_bf16 v[120:123], v[172:175], v[200:203], v[120:123]
    ds_read_b64_tr_b16 v[164:165], v5 offset:0
    v_mfma_f32_16x16x32_bf16 v[124:127], v[172:175], v[204:207], v[124:127]
    ds_read_b64_tr_b16 v[166:167], v5 offset:1024
    s_waitcnt lgkmcnt(8)
    v_mfma_f32_16x16x32_bf16 v[128:131], v[176:179], v[200:203], v[128:131]
    ds_read_b128 v[192:195], v7 offset:16384
    ds_read_b64_tr_b16 v[168:169], v4 offset:256
    v_mfma_f32_16x16x32_bf16 v[132:135], v[176:179], v[204:207], v[132:135]
    ds_read_b64_tr_b16 v[170:171], v4 offset:1280
    v_mfma_f32_16x16x32_bf16 v[136:139], v[180:183], v[200:203], v[136:139]
    ds_read_b128 v[196:199], v24 offset:16384
    ds_read_b64_tr_b16 v[172:173], v5 offset:256
    v_mfma_f32_16x16x32_bf16 v[140:143], v[180:183], v[204:207], v[140:143]
    ds_read_b64_tr_b16 v[174:175], v5 offset:1280
    s_waitcnt lgkmcnt(10)
    v_mfma_f32_16x16x32_bf16 v[144:147], v[184:187], v[200:203], v[144:147]
    buffer_load_dword off, s[96:99], s15 lds
    ds_read_b64_tr_b16 v[176:177], v4 offset:512
    v_mfma_f32_16x16x32_bf16 v[148:151], v[184:187], v[204:207], v[148:151]
    ds_read_b64_tr_b16 v[178:179], v4 offset:1536
    v_mfma_f32_16x16x32_bf16 v[152:155], v[188:191], v[200:203], v[152:155]
    ds_read_b64_tr_b16 v[180:181], v5 offset:512
    v_mfma_f32_16x16x32_bf16 v[156:159], v[188:191], v[204:207], v[156:159]
    ds_read_b64_tr_b16 v[182:183], v5 offset:1536
    s_waitcnt lgkmcnt(6)
    v_mfma_f32_16x16x32_bf16 v[32:35], v[160:163], v[192:195], v[32:35]
    ds_read_b64_tr_b16 v[184:185], v4 offset:768
    v_mfma_f32_16x16x32_bf16 v[36:39], v[160:163], v[196:199], v[36:39]
    ds_read_b64_tr_b16 v[186:187], v4 offset:1792
    v_mfma_f32_16x16x32_bf16 v[40:43], v[164:167], v[192:195], v[40:43]
    ds_read_b64_tr_b16 v[188:189], v5 offset:768
    v_mfma_f32_16x16x32_bf16 v[44:47], v[164:167], v[196:199], v[44:47]
    ds_read_b64_tr_b16 v[190:191], v5 offset:1792
    s_waitcnt lgkmcnt(8)
    v_mfma_f32_16x16x32_bf16 v[48:51], v[168:171], v[192:195], v[48:51]
    ds_read_b32 v21, v22
    ds_read_b64_tr_b16 v[160:161], v4 offset:8192
    v_mfma_f32_16x16x32_bf16 v[52:55], v[168:171], v[196:199], v[52:55]
    ds_read_b64_tr_b16 v[162:163], v4 offset:9216
    v_mfma_f32_16x16x32_bf16 v[56:59], v[172:175], v[192:195], v[56:59]
    ds_read_b64_tr_b16 v[164:165], v5 offset:8192
    v_mfma_f32_16x16x32_bf16 v[60:63], v[172:175], v[196:199], v[60:63]
    ds_read_b64_tr_b16 v[166:167], v5 offset:9216
    s_waitcnt lgkmcnt(9)
    v_mfma_f32_16x16x32_bf16 v[64:67], v[176:179], v[192:195], v[64:67]
    ds_read_b64_tr_b16 v[168:169], v4 offset:8448
    v_mfma_f32_16x16x32_bf16 v[68:71], v[176:179], v[196:199], v[68:71]
    ds_read_b64_tr_b16 v[170:171], v4 offset:9472
    v_mfma_f32_16x16x32_bf16 v[72:75], v[180:183], v[192:195], v[72:75]
    ds_read_b64_tr_b16 v[172:173], v5 offset:8448
    v_mfma_f32_16x16x32_bf16 v[76:79], v[180:183], v[196:199], v[76:79]
    ds_read_b64_tr_b16 v[174:175], v5 offset:9472
    s_waitcnt lgkmcnt(9)
    v_mfma_f32_16x16x32_bf16 v[80:83], v[184:187], v[192:195], v[80:83]
    ds_read_b64_tr_b16 v[176:177], v4 offset:8704
    v_mfma_f32_16x16x32_bf16 v[84:87], v[184:187], v[196:199], v[84:87]
    ds_read_b64_tr_b16 v[178:179], v4 offset:9728
    v_mfma_f32_16x16x32_bf16 v[88:91], v[188:191], v[192:195], v[88:91]
    ds_read_b64_tr_b16 v[180:181], v5 offset:8704
    v_mfma_f32_16x16x32_bf16 v[92:95], v[188:191], v[196:199], v[92:95]
    ds_read_b64_tr_b16 v[182:183], v5 offset:9728
    s_waitcnt lgkmcnt(8)
    v_mfma_f32_16x16x32_bf16 v[96:99], v[160:163], v[192:195], v[96:99]
    ds_read_b64_tr_b16 v[184:185], v4 offset:8960
    v_mfma_f32_16x16x32_bf16 v[100:103], v[160:163], v[196:199], v[100:103]
    ds_read_b64_tr_b16 v[186:187], v4 offset:9984
    v_mfma_f32_16x16x32_bf16 v[104:107], v[164:167], v[192:195], v[104:107]
    v_cmp_gt_u32 vcc, 14, v21
    ds_read_b64_tr_b16 v[188:189], v5 offset:8960
    v_mfma_f32_16x16x32_bf16 v[108:111], v[164:167], v[196:199], v[108:111]
    ds_read_b64_tr_b16 v[190:191], v5 offset:9984
    s_waitcnt lgkmcnt(8)
    v_mfma_f32_16x16x32_bf16 v[112:115], v[168:171], v[192:195], v[112:115]
    s_cbranch_vccnz L_cs38
L_co38:
    ds_read_b64_tr_b16 v[160:161], v4 offset:32768
    v_mfma_f32_16x16x32_bf16 v[116:119], v[168:171], v[196:199], v[116:119]
    ds_read_b64_tr_b16 v[162:163], v4 offset:33792
    v_mfma_f32_16x16x32_bf16 v[120:123], v[172:175], v[192:195], v[120:123]
    ds_read_b64_tr_b16 v[164:165], v5 offset:32768
    v_mfma_f32_16x16x32_bf16 v[124:127], v[172:175], v[196:199], v[124:127]
    ds_read_b64_tr_b16 v[166:167], v5 offset:33792
    s_waitcnt lgkmcnt(8)
    v_mfma_f32_16x16x32_bf16 v[128:131], v[176:179], v[192:195], v[128:131]
    ds_read_b128 v[200:203], v8 offset:16384
    ds_read_b64_tr_b16 v[168:169], v4 offset:33024
    v_mfma_f32_16x16x32_bf16 v[132:135], v[176:179], v[196:199], v[132:135]
    ds_read_b64_tr_b16 v[170:171], v4 offset:34048
    v_mfma_f32_16x16x32_bf16 v[136:139], v[180:183], v[192:195], v[136:139]
    ds_read_b128 v[204:207], v25 offset:16384
    ds_read_b64_tr_b16 v[172:173], v5 offset:33024
    v_mfma_f32_16x16x32_bf16 v[140:143], v[180:183], v[196:199], v[140:143]
    ds_read_b64_tr_b16 v[174:175], v5 offset:34048
    s_waitcnt lgkmcnt(10)
    v_mfma_f32_16x16x32_bf16 v[144:147], v[184:187], v[192:195], v[144:147]
    ds_read_b64_tr_b16 v[176:177], v4 offset:33280
    v_mfma_f32_16x16x32_bf16 v[148:151], v[184:187], v[196:199], v[148:151]
    ds_read_b64_tr_b16 v[178:179], v4 offset:34304
    v_mfma_f32_16x16x32_bf16 v[152:155], v[188:191], v[192:195], v[152:155]
    ds_read_b64_tr_b16 v[180:181], v5 offset:33280
    v_mfma_f32_16x16x32_bf16 v[156:159], v[188:191], v[196:199], v[156:159]
    ds_read_b64_tr_b16 v[182:183], v5 offset:34304
    s_waitcnt lgkmcnt(6)
    v_mfma_f32_16x16x32_bf16 v[32:35], v[160:163], v[200:203], v[32:35]
    ds_read_b64_tr_b16 v[184:185], v4 offset:33536
    v_mfma_f32_16x16x32_bf16 v[36:39], v[160:163], v[204:207], v[36:39]
    ds_read_b64_tr_b16 v[186:187], v4 offset:34560
    v_mfma_f32_16x16x32_bf16 v[40:43], v[164:167], v[200:203], v[40:43]
    ds_read_b64_tr_b16 v[188:189], v5 offset:33536
    v_mfma_f32_16x16x32_bf16 v[44:47], v[164:167], v[204:207], v[44:47]
    ds_read_b64_tr_b16 v[190:191], v5 offset:34560
    s_waitcnt lgkmcnt(8)
    v_mfma_f32_16x16x32_bf16 v[48:51], v[168:171], v[200:203], v[48:51]
    ds_read_b32 v21, v22
    ds_read_b64_tr_b16 v[160:161], v4 offset:40960
    v_mfma_f32_16x16x32_bf16 v[52:55], v[168:171], v[204:207], v[52:55]
    ds_read_b64_tr_b16 v[162:163], v4 offset:41984
    v_mfma_f32_16x16x32_bf16 v[56:59], v[172:175], v[200:203], v[56:59]
    ds_read_b64_tr_b16 v[164:165], v5 offset:40960
    v_mfma_f32_16x16x32_bf16 v[60:63], v[172:175], v[204:207], v[60:63]
    ds_read_b64_tr_b16 v[166:167], v5 offset:41984
    s_waitcnt lgkmcnt(9)
    v_mfma_f32_16x16x32_bf16 v[64:67], v[176:179], v[200:203], v[64:67]
    ds_read_b64_tr_b16 v[168:169], v4 offset:41216
    v_mfma_f32_16x16x32_bf16 v[68:71], v[176:179], v[204:207], v[68:71]
    ds_read_b64_tr_b16 v[170:171], v4 offset:42240
    v_mfma_f32_16x16x32_bf16 v[72:75], v[180:183], v[200:203], v[72:75]
    ds_read_b64_tr_b16 v[172:173], v5 offset:41216
    v_mfma_f32_16x16x32_bf16 v[76:79], v[180:183], v[204:207], v[76:79]
    ds_read_b64_tr_b16 v[174:175], v5 offset:42240
    s_waitcnt lgkmcnt(9)
    v_mfma_f32_16x16x32_bf16 v[80:83], v[184:187], v[200:203], v[80:83]
    s_mov_b32 s15, 56
    ds_read_b64_tr_b16 v[176:177], v4 offset:41472
    v_mfma_f32_16x16x32_bf16 v[84:87], v[184:187], v[204:207], v[84:87]
    ds_read_b64_tr_b16 v[178:179], v4 offset:42496
    v_mfma_f32_16x16x32_bf16 v[88:91], v[188:191], v[200:203], v[88:91]
    ds_read_b64_tr_b16 v[180:181], v5 offset:41472
    v_mfma_f32_16x16x32_bf16 v[92:95], v[188:191], v[204:207], v[92:95]
    ds_read_b64_tr_b16 v[182:183], v5 offset:42496
    s_waitcnt lgkmcnt(8)
    v_mfma_f32_16x16x32_bf16 v[96:99], v[160:163], v[200:203], v[96:99]
    ds_read_b64_tr_b16 v[184:185], v4 offset:41728
    v_mfma_f32_16x16x32_bf16 v[100:103], v[160:163], v[204:207], v[100:103]
    ds_read_b64_tr_b16 v[186:187], v4 offset:42752
    v_mfma_f32_16x16x32_bf16 v[104:107], v[164:167], v[200:203], v[104:107]
    v_cmp_gt_u32 vcc, 15, v21
    ds_read_b64_tr_b16 v[188:189], v5 offset:41728
    v_mfma_f32_16x16x32_bf16 v[108:111], v[164:167], v[204:207], v[108:111]
    ds_read_b64_tr_b16 v[190:191], v5 offset:42752
    s_waitcnt lgkmcnt(8)
    v_mfma_f32_16x16x32_bf16 v[112:115], v[168:171], v[200:203], v[112:115]
    s_cbranch_vccnz L_cs39
L_co39:
    ds_read_b64_tr_b16 v[160:161], v16 offset:16384
    v_mfma_f32_16x16x32_bf16 v[116:119], v[168:171], v[204:207], v[116:119]
    ds_read_b64_tr_b16 v[162:163], v16 offset:17408
    v_mfma_f32_16x16x32_bf16 v[120:123], v[172:175], v[200:203], v[120:123]
    ds_read_b64_tr_b16 v[164:165], v17 offset:16384
    v_mfma_f32_16x16x32_bf16 v[124:127], v[172:175], v[204:207], v[124:127]
    ds_read_b64_tr_b16 v[166:167], v17 offset:17408
    s_waitcnt lgkmcnt(8)
    v_mfma_f32_16x16x32_bf16 v[128:131], v[176:179], v[200:203], v[128:131]
    ds_read_b128 v[192:195], v18 offset:0
    ds_read_b64_tr_b16 v[168:169], v16 offset:16640
    v_mfma_f32_16x16x32_bf16 v[132:135], v[176:179], v[204:207], v[132:135]
    ds_read_b64_tr_b16 v[170:171], v16 offset:17664
    v_mfma_f32_16x16x32_bf16 v[136:139], v[180:183], v[200:203], v[136:139]
    ds_read_b128 v[196:199], v26 offset:0
    ds_read_b64_tr_b16 v[172:173], v17 offset:16640
    v_mfma_f32_16x16x32_bf16 v[140:143], v[180:183], v[204:207], v[140:143]
    ds_read_b64_tr_b16 v[174:175], v17 offset:17664
    s_waitcnt lgkmcnt(10)
    v_mfma_f32_16x16x32_bf16 v[144:147], v[184:187], v[200:203], v[144:147]
    buffer_load_dword off, s[96:99], s15 lds
    ds_read_b64_tr_b16 v[176:177], v16 offset:16896
    v_mfma_f32_16x16x32_bf16 v[148:151], v[184:187], v[204:207], v[148:151]
    ds_read_b64_tr_b16 v[178:179], v16 offset:17920
    v_mfma_f32_16x16x32_bf16 v[152:155], v[188:191], v[200:203], v[152:155]
    ds_read_b64_tr_b16 v[180:181], v17 offset:16896
    v_mfma_f32_16x16x32_bf16 v[156:159], v[188:191], v[204:207], v[156:159]
    ds_read_b64_tr_b16 v[182:183], v17 offset:17920
    s_waitcnt lgkmcnt(6)
    v_mfma_f32_16x16x32_bf16 v[32:35], v[160:163], v[192:195], v[32:35]
    ds_read_b64_tr_b16 v[184:185], v16 offset:17152
    v_mfma_f32_16x16x32_bf16 v[36:39], v[160:163], v[196:199], v[36:39]
    ds_read_b64_tr_b16 v[186:187], v16 offset:18176
    v_mfma_f32_16x16x32_bf16 v[40:43], v[164:167], v[192:195], v[40:43]
    ds_read_b64_tr_b16 v[188:189], v17 offset:17152
    v_mfma_f32_16x16x32_bf16 v[44:47], v[164:167], v[196:199], v[44:47]
    ds_read_b64_tr_b16 v[190:191], v17 offset:18176
    s_waitcnt lgkmcnt(8)
    v_mfma_f32_16x16x32_bf16 v[48:51], v[168:171], v[192:195], v[48:51]
    ds_read_b32 v21, v22
    ds_read_b64_tr_b16 v[160:161], v16 offset:24576
    v_mfma_f32_16x16x32_bf16 v[52:55], v[168:171], v[196:199], v[52:55]
    ds_read_b64_tr_b16 v[162:163], v16 offset:25600
    v_mfma_f32_16x16x32_bf16 v[56:59], v[172:175], v[192:195], v[56:59]
    ds_read_b64_tr_b16 v[164:165], v17 offset:24576
    v_mfma_f32_16x16x32_bf16 v[60:63], v[172:175], v[196:199], v[60:63]
    ds_read_b64_tr_b16 v[166:167], v17 offset:25600
    s_waitcnt lgkmcnt(9)
    v_mfma_f32_16x16x32_bf16 v[64:67], v[176:179], v[192:195], v[64:67]
    ds_read_b64_tr_b16 v[168:169], v16 offset:24832
    v_mfma_f32_16x16x32_bf16 v[68:71], v[176:179], v[196:199], v[68:71]
    ds_read_b64_tr_b16 v[170:171], v16 offset:25856
    v_mfma_f32_16x16x32_bf16 v[72:75], v[180:183], v[192:195], v[72:75]
    ds_read_b64_tr_b16 v[172:173], v17 offset:24832
    v_mfma_f32_16x16x32_bf16 v[76:79], v[180:183], v[196:199], v[76:79]
    ds_read_b64_tr_b16 v[174:175], v17 offset:25856
    s_waitcnt lgkmcnt(9)
    v_mfma_f32_16x16x32_bf16 v[80:83], v[184:187], v[192:195], v[80:83]
    ds_read_b64_tr_b16 v[176:177], v16 offset:25088
    v_mfma_f32_16x16x32_bf16 v[84:87], v[184:187], v[196:199], v[84:87]
    ds_read_b64_tr_b16 v[178:179], v16 offset:26112
    v_mfma_f32_16x16x32_bf16 v[88:91], v[188:191], v[192:195], v[88:91]
    ds_read_b64_tr_b16 v[180:181], v17 offset:25088
    v_mfma_f32_16x16x32_bf16 v[92:95], v[188:191], v[196:199], v[92:95]
    ds_read_b64_tr_b16 v[182:183], v17 offset:26112
    s_waitcnt lgkmcnt(8)
    v_mfma_f32_16x16x32_bf16 v[96:99], v[160:163], v[192:195], v[96:99]
    ds_read_b64_tr_b16 v[184:185], v16 offset:25344
    v_mfma_f32_16x16x32_bf16 v[100:103], v[160:163], v[196:199], v[100:103]
    ds_read_b64_tr_b16 v[186:187], v16 offset:26368
    v_mfma_f32_16x16x32_bf16 v[104:107], v[164:167], v[192:195], v[104:107]
    v_cmp_gt_u32 vcc, 16, v21
    ds_read_b64_tr_b16 v[188:189], v17 offset:25344
    v_mfma_f32_16x16x32_bf16 v[108:111], v[164:167], v[196:199], v[108:111]
    ds_read_b64_tr_b16 v[190:191], v17 offset:26368
    s_waitcnt lgkmcnt(8)
    v_mfma_f32_16x16x32_bf16 v[112:115], v[168:171], v[192:195], v[112:115]
    s_cbranch_vccnz L_cs40
L_co40:
    ds_read_b64_tr_b16 v[160:161], v4 offset:49152
    v_mfma_f32_16x16x32_bf16 v[116:119], v[168:171], v[196:199], v[116:119]
    ds_read_b64_tr_b16 v[162:163], v4 offset:50176
    v_mfma_f32_16x16x32_bf16 v[120:123], v[172:175], v[192:195], v[120:123]
    ds_read_b64_tr_b16 v[164:165], v5 offset:49152
    v_mfma_f32_16x16x32_bf16 v[124:127], v[172:175], v[196:199], v[124:127]
    ds_read_b64_tr_b16 v[166:167], v5 offset:50176
    s_waitcnt lgkmcnt(8)
    v_mfma_f32_16x16x32_bf16 v[128:131], v[176:179], v[192:195], v[128:131]
    ds_read_b128 v[200:203], v19 offset:0
    ds_read_b64_tr_b16 v[168:169], v4 offset:49408
    v_mfma_f32_16x16x32_bf16 v[132:135], v[176:179], v[196:199], v[132:135]
    ds_read_b64_tr_b16 v[170:171], v4 offset:50432
    v_mfma_f32_16x16x32_bf16 v[136:139], v[180:183], v[192:195], v[136:139]
    ds_read_b128 v[204:207], v27 offset:0
    ds_read_b64_tr_b16 v[172:173], v5 offset:49408
    v_mfma_f32_16x16x32_bf16 v[140:143], v[180:183], v[196:199], v[140:143]
    ds_read_b64_tr_b16 v[174:175], v5 offset:50432
    s_waitcnt lgkmcnt(10)
    v_mfma_f32_16x16x32_bf16 v[144:147], v[184:187], v[192:195], v[144:147]
    ds_read_b64_tr_b16 v[176:177], v4 offset:49664
    v_mfma_f32_16x16x32_bf16 v[148:151], v[184:187], v[196:199], v[148:151]
    ds_read_b64_tr_b16 v[178:179], v4 offset:50688
    v_mfma_f32_16x16x32_bf16 v[152:155], v[188:191], v[192:195], v[152:155]
    ds_read_b64_tr_b16 v[180:181], v5 offset:49664
    v_mfma_f32_16x16x32_bf16 v[156:159], v[188:191], v[196:199], v[156:159]
    ds_read_b64_tr_b16 v[182:183], v5 offset:50688
    s_waitcnt lgkmcnt(6)
    v_mfma_f32_16x16x32_bf16 v[32:35], v[160:163], v[200:203], v[32:35]
    ds_read_b64_tr_b16 v[184:185], v4 offset:49920
    v_mfma_f32_16x16x32_bf16 v[36:39], v[160:163], v[204:207], v[36:39]
    ds_read_b64_tr_b16 v[186:187], v4 offset:50944
    v_mfma_f32_16x16x32_bf16 v[40:43], v[164:167], v[200:203], v[40:43]
    ds_read_b64_tr_b16 v[188:189], v5 offset:49920
    v_mfma_f32_16x16x32_bf16 v[44:47], v[164:167], v[204:207], v[44:47]
    ds_read_b64_tr_b16 v[190:191], v5 offset:50944
    s_waitcnt lgkmcnt(8)
    v_mfma_f32_16x16x32_bf16 v[48:51], v[168:171], v[200:203], v[48:51]
    ds_read_b32 v21, v22
    ds_read_b64_tr_b16 v[160:161], v4 offset:57344
    v_mfma_f32_16x16x32_bf16 v[52:55], v[168:171], v[204:207], v[52:55]
    ds_read_b64_tr_b16 v[162:163], v4 offset:58368
    v_mfma_f32_16x16x32_bf16 v[56:59], v[172:175], v[200:203], v[56:59]
    ds_read_b64_tr_b16 v[164:165], v5 offset:57344
    v_mfma_f32_16x16x32_bf16 v[60:63], v[172:175], v[204:207], v[60:63]
    ds_read_b64_tr_b16 v[166:167], v5 offset:58368
    s_waitcnt lgkmcnt(9)
    v_mfma_f32_16x16x32_bf16 v[64:67], v[176:179], v[200:203], v[64:67]
    ds_read_b64_tr_b16 v[168:169], v4 offset:57600
    v_mfma_f32_16x16x32_bf16 v[68:71], v[176:179], v[204:207], v[68:71]
    ds_read_b64_tr_b16 v[170:171], v4 offset:58624
    v_mfma_f32_16x16x32_bf16 v[72:75], v[180:183], v[200:203], v[72:75]
    ds_read_b64_tr_b16 v[172:173], v5 offset:57600
    v_mfma_f32_16x16x32_bf16 v[76:79], v[180:183], v[204:207], v[76:79]
    ds_read_b64_tr_b16 v[174:175], v5 offset:58624
    s_waitcnt lgkmcnt(9)
    v_mfma_f32_16x16x32_bf16 v[80:83], v[184:187], v[200:203], v[80:83]
    v_mov_b32 v20, 16
    ds_read_b64_tr_b16 v[176:177], v4 offset:57856
    v_mfma_f32_16x16x32_bf16 v[84:87], v[184:187], v[204:207], v[84:87]
    ds_read_b64_tr_b16 v[178:179], v4 offset:58880
    v_mfma_f32_16x16x32_bf16 v[88:91], v[188:191], v[200:203], v[88:91]
    ds_read_b64_tr_b16 v[180:181], v5 offset:57856
    v_mfma_f32_16x16x32_bf16 v[92:95], v[188:191], v[204:207], v[92:95]
    ds_read_b64_tr_b16 v[182:183], v5 offset:58880
    s_waitcnt lgkmcnt(8)
    v_mfma_f32_16x16x32_bf16 v[96:99], v[160:163], v[200:203], v[96:99]
    ds_read_b64_tr_b16 v[184:185], v4 offset:58112
    v_mfma_f32_16x16x32_bf16 v[100:103], v[160:163], v[204:207], v[100:103]
    ds_read_b64_tr_b16 v[186:187], v4 offset:59136
    v_mfma_f32_16x16x32_bf16 v[104:107], v[164:167], v[200:203], v[104:107]
    v_cmp_gt_u32 vcc, 17, v21
    ds_read_b64_tr_b16 v[188:189], v5 offset:58112
    v_mfma_f32_16x16x32_bf16 v[108:111], v[164:167], v[204:207], v[108:111]
    ds_read_b64_tr_b16 v[190:191], v5 offset:59136
    s_waitcnt lgkmcnt(8)
    v_mfma_f32_16x16x32_bf16 v[112:115], v[168:171], v[200:203], v[112:115]
    s_cbranch_vccnz L_cs41
L_co41:
    ds_read_b64_tr_b16 v[160:161], v16 offset:0
    v_mfma_f32_16x16x32_bf16 v[116:119], v[168:171], v[204:207], v[116:119]
    ds_read_b64_tr_b16 v[162:163], v16 offset:1024
    v_mfma_f32_16x16x32_bf16 v[120:123], v[172:175], v[200:203], v[120:123]
    ds_write_b32 v23, v20
    ds_read_b64_tr_b16 v[164:165], v17 offset:0
    v_mfma_f32_16x16x32_bf16 v[124:127], v[172:175], v[204:207], v[124:127]
    ds_read_b64_tr_b16 v[166:167], v17 offset:1024
    s_waitcnt lgkmcnt(9)
    v_mfma_f32_16x16x32_bf16 v[128:131], v[176:179], v[200:203], v[128:131]
    ds_read_b128 v[192:195], v18 offset:32768
    ds_read_b64_tr_b16 v[168:169], v16 offset:256
    v_mfma_f32_16x16x32_bf16 v[132:135], v[176:179], v[204:207], v[132:135]
    ds_read_b64_tr_b16 v[170:171], v16 offset:1280
    v_mfma_f32_16x16x32_bf16 v[136:139], v[180:183], v[200:203], v[136:139]
    ds_read_b128 v[196:199], v26 offset:32768
    ds_read_b64_tr_b16 v[172:173], v17 offset:256
    v_mfma_f32_16x16x32_bf16 v[140:143], v[180:183], v[204:207], v[140:143]
    ds_read_b64_tr_b16 v[174:175], v17 offset:1280
    s_waitcnt lgkmcnt(11)
    v_mfma_f32_16x16x32_bf16 v[144:147], v[184:187], v[200:203], v[144:147]
    ds_read_b64_tr_b16 v[176:177], v16 offset:512
    v_mfma_f32_16x16x32_bf16 v[148:151], v[184:187], v[204:207], v[148:151]
    ds_read_b64_tr_b16 v[178:179], v16 offset:1536
    v_mfma_f32_16x16x32_bf16 v[152:155], v[188:191], v[200:203], v[152:155]
    ds_read_b64_tr_b16 v[180:181], v17 offset:512
    v_mfma_f32_16x16x32_bf16 v[156:159], v[188:191], v[204:207], v[156:159]
    ds_read_b64_tr_b16 v[182:183], v17 offset:1536
    s_waitcnt lgkmcnt(6)
    v_mfma_f32_16x16x32_bf16 v[32:35], v[160:163], v[192:195], v[32:35]
    ds_read_b64_tr_b16 v[184:185], v16 offset:768
    v_mfma_f32_16x16x32_bf16 v[36:39], v[160:163], v[196:199], v[36:39]
    ds_read_b64_tr_b16 v[186:187], v16 offset:1792
    v_mfma_f32_16x16x32_bf16 v[40:43], v[164:167], v[192:195], v[40:43]
    ds_read_b64_tr_b16 v[188:189], v17 offset:768
    v_mfma_f32_16x16x32_bf16 v[44:47], v[164:167], v[196:199], v[44:47]
    ds_read_b64_tr_b16 v[190:191], v17 offset:1792
    s_waitcnt lgkmcnt(8)
    v_mfma_f32_16x16x32_bf16 v[48:51], v[168:171], v[192:195], v[48:51]
    ds_read_b32 v21, v22
    ds_read_b64_tr_b16 v[160:161], v16 offset:8192
    v_mfma_f32_16x16x32_bf16 v[52:55], v[168:171], v[196:199], v[52:55]
    ds_read_b64_tr_b16 v[162:163], v16 offset:9216
    v_mfma_f32_16x16x32_bf16 v[56:59], v[172:175], v[192:195], v[56:59]
    ds_read_b64_tr_b16 v[164:165], v17 offset:8192
    v_mfma_f32_16x16x32_bf16 v[60:63], v[172:175], v[196:199], v[60:63]
    ds_read_b64_tr_b16 v[166:167], v17 offset:9216
    s_waitcnt lgkmcnt(9)
    v_mfma_f32_16x16x32_bf16 v[64:67], v[176:179], v[192:195], v[64:67]
    ds_read_b64_tr_b16 v[168:169], v16 offset:8448
    v_mfma_f32_16x16x32_bf16 v[68:71], v[176:179], v[196:199], v[68:71]
    ds_read_b64_tr_b16 v[170:171], v16 offset:9472
    v_mfma_f32_16x16x32_bf16 v[72:75], v[180:183], v[192:195], v[72:75]
    ds_read_b64_tr_b16 v[172:173], v17 offset:8448
    v_mfma_f32_16x16x32_bf16 v[76:79], v[180:183], v[196:199], v[76:79]
    ds_read_b64_tr_b16 v[174:175], v17 offset:9472
    s_waitcnt lgkmcnt(9)
    v_mfma_f32_16x16x32_bf16 v[80:83], v[184:187], v[192:195], v[80:83]
    v_mov_b32 v20, 17
    ds_read_b64_tr_b16 v[176:177], v16 offset:8704
    v_mfma_f32_16x16x32_bf16 v[84:87], v[184:187], v[196:199], v[84:87]
    ds_read_b64_tr_b16 v[178:179], v16 offset:9728
    v_mfma_f32_16x16x32_bf16 v[88:91], v[188:191], v[192:195], v[88:91]
    ds_read_b64_tr_b16 v[180:181], v17 offset:8704
    v_mfma_f32_16x16x32_bf16 v[92:95], v[188:191], v[196:199], v[92:95]
    ds_read_b64_tr_b16 v[182:183], v17 offset:9728
    s_waitcnt lgkmcnt(8)
    v_mfma_f32_16x16x32_bf16 v[96:99], v[160:163], v[192:195], v[96:99]
    ds_read_b64_tr_b16 v[184:185], v16 offset:8960
    v_mfma_f32_16x16x32_bf16 v[100:103], v[160:163], v[196:199], v[100:103]
    ds_read_b64_tr_b16 v[186:187], v16 offset:9984
    v_mfma_f32_16x16x32_bf16 v[104:107], v[164:167], v[192:195], v[104:107]
    v_cmp_gt_u32 vcc, 18, v21
    ds_read_b64_tr_b16 v[188:189], v17 offset:8960
    v_mfma_f32_16x16x32_bf16 v[108:111], v[164:167], v[196:199], v[108:111]
    ds_read_b64_tr_b16 v[190:191], v17 offset:9984
    s_waitcnt lgkmcnt(8)
    v_mfma_f32_16x16x32_bf16 v[112:115], v[168:171], v[192:195], v[112:115]
    s_cbranch_vccnz L_cs42
L_co42:
    ds_read_b64_tr_b16 v[160:161], v16 offset:49152
    v_mfma_f32_16x16x32_bf16 v[116:119], v[168:171], v[196:199], v[116:119]
    ds_read_b64_tr_b16 v[162:163], v16 offset:50176
    v_mfma_f32_16x16x32_bf16 v[120:123], v[172:175], v[192:195], v[120:123]
    ds_write_b32 v23, v20
    ds_read_b64_tr_b16 v[164:165], v17 offset:49152
    v_mfma_f32_16x16x32_bf16 v[124:127], v[172:175], v[196:199], v[124:127]
    ds_read_b64_tr_b16 v[166:167], v17 offset:50176
    s_waitcnt lgkmcnt(9)
    v_mfma_f32_16x16x32_bf16 v[128:131], v[176:179], v[192:195], v[128:131]
    ds_read_b128 v[200:203], v19 offset:32768
    ds_read_b64_tr_b16 v[168:169], v16 offset:49408
    v_mfma_f32_16x16x32_bf16 v[132:135], v[176:179], v[196:199], v[132:135]
    ds_read_b64_tr_b16 v[170:171], v16 offset:50432
    v_mfma_f32_16x16x32_bf16 v[136:139], v[180:183], v[192:195], v[136:139]
    ds_read_b128 v[204:207], v27 offset:32768
    ds_read_b64_tr_b16 v[172:173], v17 offset:49408
    v_mfma_f32_16x16x32_bf16 v[140:143], v[180:183], v[196:199], v[140:143]
    ds_read_b64_tr_b16 v[174:175], v17 offset:50432
    s_waitcnt lgkmcnt(11)
    v_mfma_f32_16x16x32_bf16 v[144:147], v[184:187], v[192:195], v[144:147]
    ds_read_b64_tr_b16 v[176:177], v16 offset:49664
    v_mfma_f32_16x16x32_bf16 v[148:151], v[184:187], v[196:199], v[148:151]
    ds_read_b64_tr_b16 v[178:179], v16 offset:50688
    v_mfma_f32_16x16x32_bf16 v[152:155], v[188:191], v[192:195], v[152:155]
    ds_read_b64_tr_b16 v[180:181], v17 offset:49664
    v_mfma_f32_16x16x32_bf16 v[156:159], v[188:191], v[196:199], v[156:159]
    ds_read_b64_tr_b16 v[182:183], v17 offset:50688
    s_waitcnt lgkmcnt(6)
    v_mfma_f32_16x16x32_bf16 v[32:35], v[160:163], v[200:203], v[32:35]
    ds_read_b64_tr_b16 v[184:185], v16 offset:49920
    v_mfma_f32_16x16x32_bf16 v[36:39], v[160:163], v[204:207], v[36:39]
    ds_read_b64_tr_b16 v[186:187], v16 offset:50944
    v_mfma_f32_16x16x32_bf16 v[40:43], v[164:167], v[200:203], v[40:43]
    ds_read_b64_tr_b16 v[188:189], v17 offset:49920
    v_mfma_f32_16x16x32_bf16 v[44:47], v[164:167], v[204:207], v[44:47]
    ds_read_b64_tr_b16 v[190:191], v17 offset:50944
    s_waitcnt lgkmcnt(8)
    v_mfma_f32_16x16x32_bf16 v[48:51], v[168:171], v[200:203], v[48:51]
    ds_read_b64_tr_b16 v[160:161], v16 offset:57344
    v_mfma_f32_16x16x32_bf16 v[52:55], v[168:171], v[204:207], v[52:55]
    ds_read_b64_tr_b16 v[162:163], v16 offset:58368
    v_mfma_f32_16x16x32_bf16 v[56:59], v[172:175], v[200:203], v[56:59]
    ds_read_b64_tr_b16 v[164:165], v17 offset:57344
    v_mfma_f32_16x16x32_bf16 v[60:63], v[172:175], v[204:207], v[60:63]
    ds_read_b64_tr_b16 v[166:167], v17 offset:58368
    s_waitcnt lgkmcnt(8)
    v_mfma_f32_16x16x32_bf16 v[64:67], v[176:179], v[200:203], v[64:67]
    ds_read_b64_tr_b16 v[168:169], v16 offset:57600
    v_mfma_f32_16x16x32_bf16 v[68:71], v[176:179], v[204:207], v[68:71]
    ds_read_b64_tr_b16 v[170:171], v16 offset:58624
    v_mfma_f32_16x16x32_bf16 v[72:75], v[180:183], v[200:203], v[72:75]
    ds_read_b64_tr_b16 v[172:173], v17 offset:57600
    v_mfma_f32_16x16x32_bf16 v[76:79], v[180:183], v[204:207], v[76:79]
    ds_read_b64_tr_b16 v[174:175], v17 offset:58624
    s_waitcnt lgkmcnt(8)
    v_mfma_f32_16x16x32_bf16 v[80:83], v[184:187], v[200:203], v[80:83]
    v_mov_b32 v20, 18
    ds_read_b64_tr_b16 v[176:177], v16 offset:57856
    v_mfma_f32_16x16x32_bf16 v[84:87], v[184:187], v[204:207], v[84:87]
    ds_read_b64_tr_b16 v[178:179], v16 offset:58880
    v_mfma_f32_16x16x32_bf16 v[88:91], v[188:191], v[200:203], v[88:91]
    ds_read_b64_tr_b16 v[180:181], v17 offset:57856
    v_mfma_f32_16x16x32_bf16 v[92:95], v[188:191], v[204:207], v[92:95]
    ds_read_b64_tr_b16 v[182:183], v17 offset:58880
    s_waitcnt lgkmcnt(8)
    v_mfma_f32_16x16x32_bf16 v[96:99], v[160:163], v[200:203], v[96:99]
    ds_read_b64_tr_b16 v[184:185], v16 offset:58112
    v_mfma_f32_16x16x32_bf16 v[100:103], v[160:163], v[204:207], v[100:103]
    ds_read_b64_tr_b16 v[186:187], v16 offset:59136
    v_mfma_f32_16x16x32_bf16 v[104:107], v[164:167], v[200:203], v[104:107]
    ds_read_b64_tr_b16 v[188:189], v17 offset:58112
    v_mfma_f32_16x16x32_bf16 v[108:111], v[164:167], v[204:207], v[108:111]
    ds_read_b64_tr_b16 v[190:191], v17 offset:59136
    s_waitcnt lgkmcnt(8)
    v_mfma_f32_16x16x32_bf16 v[112:115], v[168:171], v[200:203], v[112:115]
    v_mfma_f32_16x16x32_bf16 v[116:119], v[168:171], v[204:207], v[116:119]
    v_mfma_f32_16x16x32_bf16 v[120:123], v[172:175], v[200:203], v[120:123]
    ds_write_b32 v23, v20
    v_mfma_f32_16x16x32_bf16 v[124:127], v[172:175], v[204:207], v[124:127]
    s_waitcnt lgkmcnt(5)
    v_mfma_f32_16x16x32_bf16 v[128:131], v[176:179], v[200:203], v[128:131]
    v_mfma_f32_16x16x32_bf16 v[132:135], v[176:179], v[204:207], v[132:135]
    v_mfma_f32_16x16x32_bf16 v[136:139], v[180:183], v[200:203], v[136:139]
    v_mfma_f32_16x16x32_bf16 v[140:143], v[180:183], v[204:207], v[140:143]
    s_waitcnt lgkmcnt(1)
    v_mfma_f32_16x16x32_bf16 v[144:147], v[184:187], v[200:203], v[144:147]
    v_mfma_f32_16x16x32_bf16 v[148:151], v[184:187], v[204:207], v[148:151]
    v_mfma_f32_16x16x32_bf16 v[152:155], v[188:191], v[200:203], v[152:155]
    v_mfma_f32_16x16x32_bf16 v[156:159], v[188:191], v[204:207], v[156:159]
    ds_read_b32 v21, v22
    v_mov_b32 v24, v9
    v_xor_b32 v25, 32, v9
    v_xor_b32 v26, 64, v9
    v_xor_b32 v27, 96, v9
    v_xor_b32 v28, 128, v9
    v_xor_b32 v29, 160, v9
    v_xor_b32 v30, 192, v9
    v_xor_b32 v31, 224, v9
    v_cvt_pk_bf16_f32 v32, v32, v33
    v_cvt_pk_bf16_f32 v33, v34, v35
    v_cvt_pk_bf16_f32 v34, v40, v41
    v_cvt_pk_bf16_f32 v35, v42, v43
    v_cvt_pk_bf16_f32 v36, v36, v37
    v_cvt_pk_bf16_f32 v37, v38, v39
    v_cvt_pk_bf16_f32 v38, v44, v45
    v_cvt_pk_bf16_f32 v39, v46, v47
    v_cvt_pk_bf16_f32 v40, v48, v49
    v_cvt_pk_bf16_f32 v41, v50, v51
    v_cvt_pk_bf16_f32 v42, v56, v57
    v_cvt_pk_bf16_f32 v43, v58, v59
    v_cvt_pk_bf16_f32 v44, v52, v53
    v_cvt_pk_bf16_f32 v45, v54, v55
    v_cvt_pk_bf16_f32 v46, v60, v61
    v_cvt_pk_bf16_f32 v47, v62, v63
    v_cvt_pk_bf16_f32 v48, v64, v65
    v_cvt_pk_bf16_f32 v49, v66, v67
    v_cvt_pk_bf16_f32 v50, v72, v73
    v_cvt_pk_bf16_f32 v51, v74, v75
    v_cvt_pk_bf16_f32 v52, v68, v69
    v_cvt_pk_bf16_f32 v53, v70, v71
    v_cvt_pk_bf16_f32 v54, v76, v77
    v_cvt_pk_bf16_f32 v55, v78, v79
    v_cvt_pk_bf16_f32 v56, v80, v81
    v_cvt_pk_bf16_f32 v57, v82, v83
    v_cvt_pk_bf16_f32 v58, v88, v89
    v_cvt_pk_bf16_f32 v59, v90, v91
    v_cvt_pk_bf16_f32 v60, v84, v85
    v_cvt_pk_bf16_f32 v61, v86, v87
    v_cvt_pk_bf16_f32 v62, v92, v93
    v_cvt_pk_bf16_f32 v63, v94, v95
    s_add_u32 s53, s14, 3
    s_lshl_b32 s12, s6, 12
    s_lshl_b32 s93, s6, 14
    s_xor_b32 s3, s6, 1
    s_lshl_b32 s11, s3, 14
    s_add_u32 s90, s11, s12
    s_lshl_b32 s11, s3, 12
    s_add_u32 s81, s11, s93
    s_xor_b32 s3, s6, 2
    s_lshl_b32 s11, s3, 14
    s_add_u32 s91, s11, s12
    s_lshl_b32 s11, s3, 12
    s_add_u32 s82, s11, s93
    s_xor_b32 s3, s6, 3
    s_lshl_b32 s11, s3, 14
    s_add_u32 s92, s11, s12
    s_lshl_b32 s11, s3, 12
    s_add_u32 s83, s11, s93
    s_mov_b32 s12, s93
    s_bitcmp1_b32 s6, 1
    s_cselect_b64 s[50:51], -1, 0
    s_mov_b32 s48, 0x00ff00ff
    s_mov_b32 s49, 0x00ff00ff
    s_and_b32 s3, s6, 1
    s_mul_i32 s3, s3, 36864
    s_lshr_b32 s11, s6, 1
    s_lshl_b32 s93, s11, 7
    s_add_u32 s93, s93, s3
    s_mul_i32 s11, s11, 18432
    s_add_u32 s3, s3, s11
    s_lshl_b32 s11, s8, 8
    s_add_u32 s93, s93, s11
    s_lshl_b32 s11, s8, 5
    s_add_u32 s3, s3, s11
    s_add_u32 s89, s3, 1024
    v_and_b32 v7, 15, v1
    v_mul_u32_u24 v7, 2304, v7
    v_bfe_u32 v8, v1, 4, 1
    v_lshl_add_u32 v7, v8, 5, v7
    v_lshrrev_b32 v8, 5, v1
    v_lshl_add_u32 v7, v8, 4, v7
    v_and_b32 v6, 7, v1
    v_mul_u32_u24 v6, 2304, v6
    v_lshrrev_b32 v8, 4, v1
    v_lshl_add_u32 v6, v8, 3, v6
    v_bfe_u32 v8, v1, 3, 1
    v_lshl_add_u32 v6, v8, 2, v6
    v_and_b32 v8, 3, v1
    v_min_u32 v8, 2, v8
    v_add_u32 v8, 1, v8
    v_xor_b32 v8, s6, v8
    v_lshlrev_b32 v8, 12, v8
    v_add_u32 v8, 3068, v8
    s_waitcnt lgkmcnt(0)
    v_cmp_gt_u32 vcc, 19, v21
    s_cbranch_vccnz L_cs43
L_co43:
    ds_read_b64 v[160:161], v24 offset:0
    ds_read_b64 v[162:163], v25 offset:0
    ds_read_b64 v[164:165], v24 offset:4096
    ds_read_b64 v[166:167], v25 offset:4096
    ds_read_b64 v[168:169], v26 offset:0
    ds_read_b64 v[170:171], v27 offset:0
    ds_read_b64 v[172:173], v26 offset:4096
    ds_read_b64 v[174:175], v27 offset:4096
    ds_read_b64 v[176:177], v28 offset:0
    ds_read_b64 v[178:179], v29 offset:0
    ds_read_b64 v[180:181], v28 offset:4096
    ds_read_b64 v[182:183], v29 offset:4096
    ds_read_b64 v[184:185], v30 offset:0
    ds_read_b64 v[186:187], v31 offset:0
    ds_read_b64 v[188:189], v30 offset:4096
    ds_read_b64 v[190:191], v31 offset:4096
    ds_read_b32 v21, v22
    s_waitcnt lgkmcnt(15)
    v_mfma_f32_16x16x32_bf16 v[64:67], v[160:163], v[32:35], 0
    v_cvt_pk_bf16_f32 v96, v96, v97
    v_cvt_pk_bf16_f32 v97, v98, v99
    v_mfma_f32_16x16x32_bf16 v[68:71], v[160:163], v[36:39], 0
    v_cvt_pk_bf16_f32 v98, v104, v105
    v_cvt_pk_bf16_f32 v99, v106, v107
    s_waitcnt lgkmcnt(13)
    v_mfma_f32_16x16x32_bf16 v[72:75], v[164:167], v[32:35], 0
    v_cvt_pk_bf16_f32 v100, v100, v101
    v_cvt_pk_bf16_f32 v101, v102, v103
    v_mfma_f32_16x16x32_bf16 v[76:79], v[164:167], v[36:39], 0
    v_cvt_pk_bf16_f32 v102, v108, v109
    v_cvt_pk_bf16_f32 v103, v110, v111
    s_waitcnt lgkmcnt(11)
    v_mfma_f32_16x16x32_bf16 v[64:67], v[168:171], v[40:43], v[64:67]
    v_cvt_pk_bf16_f32 v104, v112, v113
    v_cvt_pk_bf16_f32 v105, v114, v115
    v_mfma_f32_16x16x32_bf16 v[68:71], v[168:171], v[44:47], v[68:71]
    v_cvt_pk_bf16_f32 v106, v120, v121
    v_cvt_pk_bf16_f32 v107, v122, v123
    s_waitcnt lgkmcnt(9)
    v_mfma_f32_16x16x32_bf16 v[72:75], v[172:175], v[40:43], v[72:75]
    v_cvt_pk_bf16_f32 v108, v116, v117
    v_cvt_pk_bf16_f32 v109, v118, v119
    v_mfma_f32_16x16x32_bf16 v[76:79], v[172:175], v[44:47], v[76:79]
    v_cvt_pk_bf16_f32 v110, v124, v125
    v_cvt_pk_bf16_f32 v111, v126, v127
    s_waitcnt lgkmcnt(0)
    v_cmp_gt_u32 vcc, 20, v21
    s_cbranch_vccnz L_cs44
L_co44:
    ds_read_b64 v[208:209], v24 offset:32768
    ds_read_b64 v[210:211], v25 offset:32768
    ds_read_b64 v[212:213], v24 offset:36864
    ds_read_b64 v[214:215], v25 offset:36864
    ds_read_b64 v[216:217], v26 offset:32768
    ds_read_b64 v[218:219], v27 offset:32768
    ds_read_b64 v[220:221], v26 offset:36864
    ds_read_b64 v[222:223], v27 offset:36864
    ds_read_b64 v[224:225], v28 offset:32768
    ds_read_b64 v[226:227], v29 offset:32768
    ds_read_b64 v[228:229], v28 offset:36864
    ds_read_b64 v[230:231], v29 offset:36864
    ds_read_b64 v[232:233], v30 offset:32768
    ds_read_b64 v[234:235], v31 offset:32768
    ds_read_b64 v[236:237], v30 offset:36864
    ds_read_b64 v[238:239], v31 offset:36864
    v_mov_b32 v20, 20
    ds_write_b32 v23, v20
    v_mfma_f32_16x16x32_bf16 v[64:67], v[176:179], v[48:51], v[64:67]
    v_cvt_pk_bf16_f32 v112, v128, v129
    v_cvt_pk_bf16_f32 v113, v130, v131
    v_mfma_f32_16x16x32_bf16 v[68:71], v[176:179], v[52:55], v[68:71]
    v_cvt_pk_bf16_f32 v114, v136, v137
    v_cvt_pk_bf16_f32 v115, v138, v139
    v_mfma_f32_16x16x32_bf16 v[72:75], v[180:183], v[48:51], v[72:75]
    v_cvt_pk_bf16_f32 v116, v132, v133
    v_cvt_pk_bf16_f32 v117, v134, v135
    v_mfma_f32_16x16x32_bf16 v[76:79], v[180:183], v[52:55], v[76:79]
    v_cvt_pk_bf16_f32 v118, v140, v141
    v_cvt_pk_bf16_f32 v119, v142, v143
    v_mfma_f32_16x16x32_bf16 v[64:67], v[184:187], v[56:59], v[64:67]
    v_cvt_pk_bf16_f32 v120, v144, v145
    v_cvt_pk_bf16_f32 v121, v146, v147
    v_mfma_f32_16x16x32_bf16 v[68:71], v[184:187], v[60:63], v[68:71]
    v_cvt_pk_bf16_f32 v122, v152, v153
    v_cvt_pk_bf16_f32 v123, v154, v155
    v_mfma_f32_16x16x32_bf16 v[72:75], v[188:191], v[56:59], v[72:75]
    v_cvt_pk_bf16_f32 v124, v148, v149
    v_cvt_pk_bf16_f32 v125, v150, v151
    v_mfma_f32_16x16x32_bf16 v[76:79], v[188:191], v[60:63], v[76:79]
    v_cvt_pk_bf16_f32 v126, v156, v157
    v_cvt_pk_bf16_f32 v127, v158, v159
    s_waitcnt lgkmcnt(15)
    v_mfma_f32_16x16x32_bf16 v[128:131], v[208:211], v[96:99], 0
    v_mfma_f32_16x16x32_bf16 v[132:135], v[208:211], v[100:103], 0
    s_waitcnt lgkmcnt(13)
    v_mfma_f32_16x16x32_bf16 v[136:139], v[212:215], v[96:99], 0
    v_mfma_f32_16x16x32_bf16 v[140:143], v[212:215], v[100:103], 0
    v_max3_f32 v88, v64, v65, v66
    v_max3_f32 v89, v67, v72, v73
    s_waitcnt lgkmcnt(11)
    v_mfma_f32_16x16x32_bf16 v[128:131], v[216:219], v[104:107], v[128:131]
    v_max3_f32 v90, v68, v69, v70
    v_max3_f32 v91, v71, v76, v77
    v_mfma_f32_16x16x32_bf16 v[132:135], v[216:219], v[108:111], v[132:135]
    v_max3_f32 v88, v88, v74, v75
    v_max3_f32 v90, v90, v78, v79
    s_waitcnt lgkmcnt(9)
    v_mfma_f32_16x16x32_bf16 v[136:139], v[220:223], v[104:107], v[136:139]
    v_max_f32 v88, v88, v89
    v_max_f32 v90, v90, v91
    v_mfma_f32_16x16x32_bf16 v[140:143], v[220:223], v[108:111], v[140:143]
    s_nop 0
    v_permlane32_swap_b32 v88, v90
    v_max_f32 v88, v88, v90
    s_waitcnt lgkmcnt(7)
    v_mfma_f32_16x16x32_bf16 v[128:131], v[224:227], v[112:115], v[128:131]
    v_mov_b32 v89, v88
    s_nop 1
    v_permlane16_swap_b32 v88, v89
    v_mfma_f32_16x16x32_bf16 v[132:135], v[224:227], v[116:119], v[132:135]
    v_max_f32 v88, v88, v89
    v_mul_f32 v88, s86, v88
    s_waitcnt lgkmcnt(5)
    v_mfma_f32_16x16x32_bf16 v[136:139], v[228:231], v[112:115], v[136:139]
    v_mov_b32 v90, v88
    s_nop 1
    v_permlane32_swap_b32 v88, v90
    v_mfma_f32_16x16x32_bf16 v[140:143], v[228:231], v[116:119], v[140:143]
    v_fma_f32 v64, v64, s86, -v88
    v_fma_f32 v65, v65, s86, -v88
    s_waitcnt lgkmcnt(3)
    v_mfma_f32_16x16x32_bf16 v[128:131], v[232:235], v[120:123], v[128:131]
    v_fma_f32 v66, v66, s86, -v88
    v_fma_f32 v67, v67, s86, -v88
    v_mfma_f32_16x16x32_bf16 v[132:135], v[232:235], v[124:127], v[132:135]
    v_fma_f32 v72, v72, s86, -v88
    v_fma_f32 v73, v73, s86, -v88
    s_waitcnt lgkmcnt(1)
    v_mfma_f32_16x16x32_bf16 v[136:139], v[236:239], v[120:123], v[136:139]
    v_fma_f32 v74, v74, s86, -v88
    v_fma_f32 v75, v75, s86, -v88
    v_mfma_f32_16x16x32_bf16 v[140:143], v[236:239], v[124:127], v[140:143]
    v_fma_f32 v68, v68, s86, -v90
    v_fma_f32 v69, v69, s86, -v90
    ds_read_b32 v21, v22
    v_max3_f32 v152, v128, v129, v130
    v_fma_f32 v70, v70, s86, -v90
    v_max3_f32 v153, v131, v136, v137
    v_fma_f32 v71, v71, s86, -v90
    v_max3_f32 v154, v132, v133, v134
    v_fma_f32 v76, v76, s86, -v90
    v_max3_f32 v155, v135, v140, v141
    v_fma_f32 v77, v77, s86, -v90
    v_max3_f32 v152, v152, v138, v139
    v_fma_f32 v78, v78, s86, -v90
    v_max3_f32 v154, v154, v142, v143
    v_fma_f32 v79, v79, s86, -v90
    v_max_f32 v152, v152, v153
    v_exp_f32 v64, v64
    v_max_f32 v154, v154, v155
    v_exp_f32 v65, v65
    s_nop 0
    v_permlane32_swap_b32 v152, v154
    v_exp_f32 v66, v66
    v_max_f32 v152, v152, v154
    v_exp_f32 v67, v67
    v_mov_b32 v153, v152
    v_exp_f32 v72, v72
    s_nop 0
    v_permlane16_swap_b32 v152, v153
    v_exp_f32 v73, v73
    v_max_f32 v152, v152, v153
    v_exp_f32 v74, v74
    v_mul_f32 v152, s86, v152
    v_exp_f32 v75, v75
    v_mov_b32 v154, v152
    v_exp_f32 v68, v68
    s_nop 0
    v_permlane32_swap_b32 v152, v154
    v_exp_f32 v69, v69
    v_fma_f32 v128, v128, s86, -v152
    v_exp_f32 v70, v70
    v_fma_f32 v129, v129, s86, -v152
    v_exp_f32 v71, v71
    v_fma_f32 v130, v130, s86, -v152
    v_exp_f32 v76, v76
    v_fma_f32 v131, v131, s86, -v152
    v_exp_f32 v77, v77
    v_fma_f32 v136, v136, s86, -v152
    v_exp_f32 v78, v78
    v_fma_f32 v137, v137, s86, -v152
    v_exp_f32 v79, v79
    v_fma_f32 v138, v138, s86, -v152
    v_pk_add_f32 v[88:89], v[64:65], v[66:67]
    v_fma_f32 v139, v139, s86, -v152
    v_pk_add_f32 v[90:91], v[68:69], v[70:71]
    v_fma_f32 v132, v132, s86, -v154
    v_pk_add_f32 v[88:89], v[88:89], v[72:73]
    v_fma_f32 v133, v133, s86, -v154
    v_pk_add_f32 v[90:91], v[90:91], v[76:77]
    v_fma_f32 v134, v134, s86, -v154
    v_pk_add_f32 v[88:89], v[88:89], v[74:75]
    v_fma_f32 v135, v135, s86, -v154
    v_pk_add_f32 v[90:91], v[90:91], v[78:79]
    v_fma_f32 v140, v140, s86, -v154
    v_add_f32 v88, v88, v89
    v_fma_f32 v141, v141, s86, -v154
    v_add_f32 v90, v90, v91
    v_fma_f32 v142, v142, s86, -v154
    s_nop 0
    v_permlane32_swap_b32 v88, v90
    v_fma_f32 v143, v143, s86, -v154
    v_add_f32 v88, v88, v90
    v_exp_f32 v128, v128
    v_mov_b32 v89, v88
    v_exp_f32 v129, v129
    s_nop 0
    v_permlane16_swap_b32 v88, v89
    v_exp_f32 v130, v130
    v_add_f32 v88, v88, v89
    v_exp_f32 v131, v131
    v_rcp_f32 v88, v88
    v_exp_f32 v136, v136
    v_mov_b32 v90, v88
    v_exp_f32 v137, v137
    s_nop 0
    v_permlane32_swap_b32 v88, v90
    v_exp_f32 v138, v138
    v_pk_mul_f32 v[64:65], v[64:65], v[88:89] op_sel_hi:[1,0]
    v_exp_f32 v139, v139
    v_pk_mul_f32 v[66:67], v[66:67], v[88:89] op_sel_hi:[1,0]
    v_exp_f32 v132, v132
    v_pk_mul_f32 v[72:73], v[72:73], v[88:89] op_sel_hi:[1,0]
    v_exp_f32 v133, v133
    v_pk_mul_f32 v[74:75], v[74:75], v[88:89] op_sel_hi:[1,0]
    v_exp_f32 v134, v134
    v_pk_mul_f32 v[68:69], v[68:69], v[90:91] op_sel_hi:[1,0]
    v_exp_f32 v135, v135
    v_pk_mul_f32 v[70:71], v[70:71], v[90:91] op_sel_hi:[1,0]
    v_exp_f32 v140, v140
    v_pk_mul_f32 v[76:77], v[76:77], v[90:91] op_sel_hi:[1,0]
    v_exp_f32 v141, v141
    v_pk_mul_f32 v[78:79], v[78:79], v[90:91] op_sel_hi:[1,0]
    v_exp_f32 v142, v142
    v_cvt_pk_bf16_f32 v192, v64, v65
    v_exp_f32 v143, v143
    v_cvt_pk_bf16_f32 v193, v66, v67
    v_pk_add_f32 v[152:153], v[128:129], v[130:131]
    v_cvt_pk_bf16_f32 v194, v72, v73
    v_pk_add_f32 v[154:155], v[132:133], v[134:135]
    v_cvt_pk_bf16_f32 v195, v74, v75
    v_pk_add_f32 v[152:153], v[152:153], v[136:137]
    buffer_store_dwordx4 v[192:195], v10, s[56:59], s76 offen offset:0 sc1
    v_pk_add_f32 v[154:155], v[154:155], v[140:141]
    v_cvt_pk_bf16_f32 v196, v68, v69
    v_pk_add_f32 v[152:153], v[152:153], v[138:139]
    v_cvt_pk_bf16_f32 v197, v70, v71
    v_pk_add_f32 v[154:155], v[154:155], v[142:143]
    v_cvt_pk_bf16_f32 v198, v76, v77
    v_add_f32 v152, v152, v153
    v_cvt_pk_bf16_f32 v199, v78, v79
    v_add_f32 v154, v154, v155
    buffer_store_dwordx4 v[196:199], v10, s[56:59], s76 offen offset:1024 sc1
    s_nop 0
    v_permlane32_swap_b32 v152, v154
    v_add_f32 v152, v152, v154
    v_mov_b32 v153, v152
    s_nop 1
    v_permlane16_swap_b32 v152, v153
    v_add_f32 v152, v152, v153
    v_rcp_f32 v152, v152
    s_nop 0
    v_mov_b32 v154, v152
    s_nop 1
    v_permlane32_swap_b32 v152, v154
    v_pk_mul_f32 v[128:129], v[128:129], v[152:153] op_sel_hi:[1,0]
    v_pk_mul_f32 v[130:131], v[130:131], v[152:153] op_sel_hi:[1,0]
    v_pk_mul_f32 v[136:137], v[136:137], v[152:153] op_sel_hi:[1,0]
    v_pk_mul_f32 v[138:139], v[138:139], v[152:153] op_sel_hi:[1,0]
    v_pk_mul_f32 v[132:133], v[132:133], v[154:155] op_sel_hi:[1,0]
    v_pk_mul_f32 v[134:135], v[134:135], v[154:155] op_sel_hi:[1,0]
    v_pk_mul_f32 v[140:141], v[140:141], v[154:155] op_sel_hi:[1,0]
    v_pk_mul_f32 v[142:143], v[142:143], v[154:155] op_sel_hi:[1,0]
    v_cvt_pk_bf16_f32 v200, v128, v129
    v_cvt_pk_bf16_f32 v201, v130, v131
    v_cvt_pk_bf16_f32 v202, v136, v137
    v_cvt_pk_bf16_f32 v203, v138, v139
    buffer_store_dwordx4 v[200:203], v10, s[56:59], s76 offen offset:2048 sc1
    v_cvt_pk_bf16_f32 v204, v132, v133
    v_cvt_pk_bf16_f32 v205, v134, v135
    v_cvt_pk_bf16_f32 v206, v140, v141
    v_cvt_pk_bf16_f32 v207, v142, v143
    buffer_store_dwordx4 v[204:207], v10, s[56:59], s76 offen offset:3072 sc1
    v_bitop3_b32 v15, v192, v196, s53 bitop3:0x96
    v_bitop3_b32 v88, v193, v197, v201 bitop3:0x96
    v_bitop3_b32 v89, v194, v198, v202 bitop3:0x96
    v_bitop3_b32 v90, v195, v199, v203 bitop3:0x96
    v_bitop3_b32 v15, v200, v204, v15 bitop3:0x96
    v_xor_b32 v88, v205, v88
    v_xor_b32 v89, v206, v89
    v_xor_b32 v90, v207, v90
    v_alignbit_b32 v88, v88, v88, 5
    v_alignbit_b32 v89, v89, v89, 10
    v_alignbit_b32 v90, v90, v90, 15
    v_bitop3_b32 v15, v88, v89, v15 bitop3:0x96
    v_xor_b32 v15, v90, v15
    buffer_store_dword v15, v11, s[56:59], s76 offen sc1
    v_mov_b32 v24, v12
    v_xor_b32 v25, 64, v12
    v_add_u32 v18, 150528, v3
    s_waitcnt lgkmcnt(0)
    v_cmp_gt_u32 vcc, 21, v21
    s_cbranch_vccnz L_cs45
L_co45:
    ds_read_b128 v[104:107], v24 offset:16384
    ds_read_b128 v[108:111], v24 offset:18432
    ds_read_b128 v[112:115], v25 offset:16384
    ds_read_b128 v[116:119], v25 offset:18432
    ds_read_b128 v[120:123], v24 offset:32768
    ds_read_b128 v[124:127], v24 offset:34816
    ds_read_b128 v[128:131], v25 offset:32768
    ds_read_b128 v[132:135], v25 offset:34816
    ds_read_b64_tr_b16 v[160:161], v18 offset:0
    ds_read_b64_tr_b16 v[162:163], v18 offset:256
    ds_read_b64_tr_b16 v[164:165], v18 offset:1024
    ds_read_b64_tr_b16 v[166:167], v18 offset:1280
    ds_read_b64_tr_b16 v[168:169], v18 offset:2048
    ds_read_b64_tr_b16 v[170:171], v18 offset:2304
    ds_read_b64_tr_b16 v[172:173], v18 offset:3072
    ds_read_b64_tr_b16 v[174:175], v18 offset:3328
    ds_read_b64_tr_b16 v[176:177], v4 offset:512
    ds_read_b64_tr_b16 v[178:179], v4 offset:1536
    ds_read_b64_tr_b16 v[180:181], v4 offset:8704
    ds_read_b64_tr_b16 v[182:183], v4 offset:9728
    s_waitcnt lgkmcnt(15)
    s_waitcnt lgkmcnt(8)
    v_mfma_f32_16x16x32_bf16 v[136:139], v[104:107], v[160:163], 0
    s_barrier
    ds_read_b64_tr_b16 v[184:185], v4 offset:16896
    v_mfma_f32_16x16x32_bf16 v[140:143], v[108:111], v[160:163], 0
    ds_read_b64_tr_b16 v[186:187], v4 offset:17920
    v_mfma_f32_16x16x32_bf16 v[136:139], v[112:115], v[164:167], v[136:139]
    ds_read_b64_tr_b16 v[188:189], v4 offset:25088
    v_mfma_f32_16x16x32_bf16 v[140:143], v[116:119], v[164:167], v[140:143]
    ds_read_b64_tr_b16 v[190:191], v4 offset:26112
    s_waitcnt lgkmcnt(8)
    v_mfma_f32_16x16x32_bf16 v[136:139], v[120:123], v[168:171], v[136:139]
    ds_read_b64_tr_b16 v[160:161], v5 offset:512
    v_mfma_f32_16x16x32_bf16 v[140:143], v[124:127], v[168:171], v[140:143]
    ds_read_b64_tr_b16 v[162:163], v5 offset:1536
    v_mfma_f32_16x16x32_bf16 v[136:139], v[128:131], v[172:175], v[136:139]
    ds_read_b64_tr_b16 v[164:165], v5 offset:8704
    v_mfma_f32_16x16x32_bf16 v[140:143], v[132:135], v[172:175], v[140:143]
    ds_read_b64_tr_b16 v[166:167], v5 offset:9728
    s_waitcnt lgkmcnt(8)
    v_mfma_f32_16x16x32_bf16 v[144:147], v[104:107], v[176:179], 0
    ds_read_b64_tr_b16 v[168:169], v5 offset:16896
    v_mfma_f32_16x16x32_bf16 v[148:151], v[108:111], v[176:179], 0
    ds_read_b64_tr_b16 v[170:171], v5 offset:17920
    v_cvt_pk_bf16_f32 v152, v136, v137
    v_cvt_pk_bf16_f32 v153, v138, v139
    v_mfma_f32_16x16x32_bf16 v[144:147], v[112:115], v[180:183], v[144:147]
    ds_read_b64_tr_b16 v[172:173], v5 offset:25088
    v_mfma_f32_16x16x32_bf16 v[148:151], v[116:119], v[180:183], v[148:151]
    ds_read_b64_tr_b16 v[174:175], v5 offset:26112
    s_waitcnt lgkmcnt(8)
    v_mfma_f32_16x16x32_bf16 v[144:147], v[120:123], v[184:187], v[144:147]
    ds_read_b64_tr_b16 v[176:177], v4 offset:768
    v_mfma_f32_16x16x32_bf16 v[148:151], v[124:127], v[184:187], v[148:151]
    ds_read_b64_tr_b16 v[178:179], v4 offset:1792
    v_cvt_pk_bf16_f32 v154, v140, v141
    v_cvt_pk_bf16_f32 v155, v142, v143
    v_mfma_f32_16x16x32_bf16 v[144:147], v[128:131], v[188:191], v[144:147]
    ds_read_b64_tr_b16 v[180:181], v4 offset:8960
    v_mfma_f32_16x16x32_bf16 v[148:151], v[132:135], v[188:191], v[148:151]
    ds_read_b64_tr_b16 v[182:183], v4 offset:9984
    s_waitcnt lgkmcnt(8)
    v_mfma_f32_16x16x32_bf16 v[136:139], v[104:107], v[160:163], 0
    ds_read_b64_tr_b16 v[184:185], v4 offset:17152
    v_mfma_f32_16x16x32_bf16 v[140:143], v[108:111], v[160:163], 0
    ds_read_b64_tr_b16 v[186:187], v4 offset:18176
    v_mfma_f32_16x16x32_bf16 v[96:99], v[152:155], v[192:195], 0
    v_cvt_pk_bf16_f32 v156, v144, v145
    v_cvt_pk_bf16_f32 v157, v146, v147
    v_mfma_f32_16x16x32_bf16 v[136:139], v[112:115], v[164:167], v[136:139]
    ds_read_b64_tr_b16 v[188:189], v4 offset:25344
    v_mfma_f32_16x16x32_bf16 v[140:143], v[116:119], v[164:167], v[140:143]
    ds_read_b64_tr_b16 v[190:191], v4 offset:26368
    s_waitcnt lgkmcnt(8)
    v_mfma_f32_16x16x32_bf16 v[136:139], v[120:123], v[168:171], v[136:139]
    ds_read_b64_tr_b16 v[160:161], v5 offset:768
    v_mfma_f32_16x16x32_bf16 v[140:143], v[124:127], v[168:171], v[140:143]
    ds_read_b64_tr_b16 v[162:163], v5 offset:1792
    v_mfma_f32_16x16x32_bf16 v[100:103], v[152:155], v[196:199], 0
    v_cvt_pk_bf16_f32 v158, v148, v149
    v_cvt_pk_bf16_f32 v159, v150, v151
    v_mfma_f32_16x16x32_bf16 v[136:139], v[128:131], v[172:175], v[136:139]
    ds_read_b64_tr_b16 v[164:165], v5 offset:8960
    v_mfma_f32_16x16x32_bf16 v[140:143], v[132:135], v[172:175], v[140:143]
    ds_read_b64_tr_b16 v[166:167], v5 offset:9984
    s_waitcnt lgkmcnt(8)
    v_mfma_f32_16x16x32_bf16 v[144:147], v[104:107], v[176:179], 0
    ds_read_b64_tr_b16 v[168:169], v5 offset:17152
    v_mfma_f32_16x16x32_bf16 v[148:151], v[108:111], v[176:179], 0
    ds_read_b64_tr_b16 v[170:171], v5 offset:18176
    v_mfma_f32_16x16x32_bf16 v[64:67], v[156:159], v[192:195], 0
    v_cvt_pk_bf16_f32 v152, v136, v137
    v_cvt_pk_bf16_f32 v153, v138, v139
    v_mfma_f32_16x16x32_bf16 v[144:147], v[112:115], v[180:183], v[144:147]
    ds_read_b64_tr_b16 v[172:173], v5 offset:25344
    v_mfma_f32_16x16x32_bf16 v[148:151], v[116:119], v[180:183], v[148:151]
    ds_read_b64_tr_b16 v[174:175], v5 offset:26368
    s_waitcnt lgkmcnt(8)
    v_mfma_f32_16x16x32_bf16 v[144:147], v[120:123], v[184:187], v[144:147]
    ds_read_b64_tr_b16 v[176:177], v4 offset:0
    v_mfma_f32_16x16x32_bf16 v[148:151], v[124:127], v[184:187], v[148:151]
    ds_read_b64_tr_b16 v[178:179], v4 offset:1024
    v_mfma_f32_16x16x32_bf16 v[80:83], v[156:159], v[196:199], 0
    v_cvt_pk_bf16_f32 v154, v140, v141
    v_cvt_pk_bf16_f32 v155, v142, v143
    v_mfma_f32_16x16x32_bf16 v[144:147], v[128:131], v[188:191], v[144:147]
    ds_read_b64_tr_b16 v[180:181], v4 offset:8192
    v_mfma_f32_16x16x32_bf16 v[148:151], v[132:135], v[188:191], v[148:151]
    ds_read_b64_tr_b16 v[182:183], v4 offset:9216
    s_waitcnt lgkmcnt(8)
    v_mfma_f32_16x16x32_bf16 v[136:139], v[104:107], v[160:163], 0
    ds_read_b64_tr_b16 v[184:185], v4 offset:16384
    v_mfma_f32_16x16x32_bf16 v[140:143], v[108:111], v[160:163], 0
    ds_read_b64_tr_b16 v[186:187], v4 offset:17408
    v_mfma_f32_16x16x32_bf16 v[68:71], v[152:155], v[192:195], 0
    v_cvt_pk_bf16_f32 v156, v144, v145
    v_cvt_pk_bf16_f32 v157, v146, v147
    v_mfma_f32_16x16x32_bf16 v[136:139], v[112:115], v[164:167], v[136:139]
    ds_read_b64_tr_b16 v[188:189], v4 offset:24576
    v_mfma_f32_16x16x32_bf16 v[140:143], v[116:119], v[164:167], v[140:143]
    ds_read_b64_tr_b16 v[190:191], v4 offset:25600
    s_waitcnt lgkmcnt(8)
    v_mfma_f32_16x16x32_bf16 v[136:139], v[120:123], v[168:171], v[136:139]
    ds_read_b64_tr_b16 v[160:161], v5 offset:0
    v_mfma_f32_16x16x32_bf16 v[140:143], v[124:127], v[168:171], v[140:143]
    ds_read_b64_tr_b16 v[162:163], v5 offset:1024
    v_mfma_f32_16x16x32_bf16 v[84:87], v[152:155], v[196:199], 0
    v_cvt_pk_bf16_f32 v158, v148, v149
    v_cvt_pk_bf16_f32 v159, v150, v151
    v_mfma_f32_16x16x32_bf16 v[136:139], v[128:131], v[172:175], v[136:139]
    ds_read_b64_tr_b16 v[164:165], v5 offset:8192
    v_mfma_f32_16x16x32_bf16 v[140:143], v[132:135], v[172:175], v[140:143]
    ds_read_b64_tr_b16 v[166:167], v5 offset:9216
    s_waitcnt lgkmcnt(8)
    v_mfma_f32_16x16x32_bf16 v[144:147], v[104:107], v[176:179], 0
    ds_read_b64_tr_b16 v[168:169], v5 offset:16384
    v_mfma_f32_16x16x32_bf16 v[148:151], v[108:111], v[176:179], 0
    ds_read_b64_tr_b16 v[170:171], v5 offset:17408
    v_mfma_f32_16x16x32_bf16 v[72:75], v[156:159], v[192:195], 0
    v_cvt_pk_bf16_f32 v152, v136, v137
    v_cvt_pk_bf16_f32 v153, v138, v139
    v_mfma_f32_16x16x32_bf16 v[144:147], v[112:115], v[180:183], v[144:147]
    ds_read_b64_tr_b16 v[172:173], v5 offset:24576
    v_mfma_f32_16x16x32_bf16 v[148:151], v[116:119], v[180:183], v[148:151]
    ds_read_b64_tr_b16 v[174:175], v5 offset:25600
    s_waitcnt lgkmcnt(8)
    v_mfma_f32_16x16x32_bf16 v[144:147], v[120:123], v[184:187], v[144:147]
    ds_read_b64_tr_b16 v[176:177], v4 offset:256
    v_mfma_f32_16x16x32_bf16 v[148:151], v[124:127], v[184:187], v[148:151]
    ds_read_b64_tr_b16 v[178:179], v4 offset:1280
    v_mfma_f32_16x16x32_bf16 v[88:91], v[156:159], v[196:199], 0
    v_cvt_pk_bf16_f32 v154, v140, v141
    v_cvt_pk_bf16_f32 v155, v142, v143
    v_mfma_f32_16x16x32_bf16 v[144:147], v[128:131], v[188:191], v[144:147]
    ds_read_b64_tr_b16 v[180:181], v4 offset:8448
    v_mfma_f32_16x16x32_bf16 v[148:151], v[132:135], v[188:191], v[148:151]
    ds_read_b64_tr_b16 v[182:183], v4 offset:9472
    s_waitcnt lgkmcnt(8)
    v_mfma_f32_16x16x32_bf16 v[136:139], v[104:107], v[160:163], 0
    ds_read_b64_tr_b16 v[184:185], v4 offset:16640
    v_mfma_f32_16x16x32_bf16 v[140:143], v[108:111], v[160:163], 0
    ds_read_b64_tr_b16 v[186:187], v4 offset:17664
    v_mfma_f32_16x16x32_bf16 v[76:79], v[152:155], v[192:195], 0
    v_cvt_pk_bf16_f32 v156, v144, v145
    v_cvt_pk_bf16_f32 v157, v146, v147
    v_mfma_f32_16x16x32_bf16 v[136:139], v[112:115], v[164:167], v[136:139]
    ds_read_b32 v21, v22
    ds_read_b64_tr_b16 v[188:189], v4 offset:24832
    v_mfma_f32_16x16x32_bf16 v[140:143], v[116:119], v[164:167], v[140:143]
    ds_read_b64_tr_b16 v[190:191], v4 offset:25856
    s_waitcnt lgkmcnt(9)
    v_mfma_f32_16x16x32_bf16 v[136:139], v[120:123], v[168:171], v[136:139]
    ds_read_b64_tr_b16 v[160:161], v5 offset:256
    v_mfma_f32_16x16x32_bf16 v[140:143], v[124:127], v[168:171], v[140:143]
    ds_read_b64_tr_b16 v[162:163], v5 offset:1280
    v_mfma_f32_16x16x32_bf16 v[92:95], v[152:155], v[196:199], 0
    v_cvt_pk_bf16_f32 v158, v148, v149
    v_cvt_pk_bf16_f32 v159, v150, v151
    v_mfma_f32_16x16x32_bf16 v[136:139], v[128:131], v[172:175], v[136:139]
    ds_read_b64_tr_b16 v[164:165], v5 offset:8448
    v_mfma_f32_16x16x32_bf16 v[140:143], v[132:135], v[172:175], v[140:143]
    ds_read_b64_tr_b16 v[166:167], v5 offset:9472
    s_waitcnt lgkmcnt(9)
    v_mfma_f32_16x16x32_bf16 v[144:147], v[104:107], v[176:179], 0
    s_waitcnt lgkmcnt(6)
    v_cmp_gt_u32 vcc, 23, v21
    ds_read_b64_tr_b16 v[168:169], v5 offset:16640
    v_mfma_f32_16x16x32_bf16 v[148:151], v[108:111], v[176:179], 0
    s_cbranch_vccnz L_cs46
L_co46:
    ds_read_b64_tr_b16 v[170:171], v5 offset:17664
    v_mfma_f32_16x16x32_bf16 v[32:35], v[156:159], v[192:195], 0
    v_cvt_pk_bf16_f32 v152, v136, v137
    v_cvt_pk_bf16_f32 v153, v138, v139
    v_mfma_f32_16x16x32_bf16 v[144:147], v[112:115], v[180:183], v[144:147]
    ds_read_b128 v[224:227], v24 offset:0
    ds_read_b64_tr_b16 v[172:173], v5 offset:24832
    v_mfma_f32_16x16x32_bf16 v[148:151], v[116:119], v[180:183], v[148:151]
    ds_read_b64_tr_b16 v[174:175], v5 offset:25856
    s_waitcnt lgkmcnt(9)
    v_mfma_f32_16x16x32_bf16 v[144:147], v[120:123], v[184:187], v[144:147]
    ds_read_b128 v[228:231], v24 offset:2048
    ds_read_b64_tr_b16 v[176:177], v18 offset:4096
    v_mfma_f32_16x16x32_bf16 v[148:151], v[124:127], v[184:187], v[148:151]
    ds_read_b128 v[232:235], v25 offset:0
    ds_read_b64_tr_b16 v[178:179], v18 offset:4352
    v_mfma_f32_16x16x32_bf16 v[48:51], v[156:159], v[196:199], 0
    v_cvt_pk_bf16_f32 v154, v140, v141
    v_cvt_pk_bf16_f32 v155, v142, v143
    v_mfma_f32_16x16x32_bf16 v[144:147], v[128:131], v[188:191], v[144:147]
    ds_read_b128 v[236:239], v25 offset:2048
    ds_read_b64_tr_b16 v[180:181], v18 offset:5120
    v_mfma_f32_16x16x32_bf16 v[148:151], v[132:135], v[188:191], v[148:151]
    ds_read_b64_tr_b16 v[182:183], v18 offset:5376
    s_waitcnt lgkmcnt(12)
    v_mfma_f32_16x16x32_bf16 v[136:139], v[104:107], v[160:163], 0
    ds_read_b128 v[240:243], v24 offset:16384
    ds_read_b64_tr_b16 v[184:185], v18 offset:6144
    v_mfma_f32_16x16x32_bf16 v[140:143], v[108:111], v[160:163], 0
    ds_read_b128 v[244:247], v24 offset:18432
    ds_read_b64_tr_b16 v[186:187], v18 offset:6400
    v_mfma_f32_16x16x32_bf16 v[36:39], v[152:155], v[192:195], 0
    v_cvt_pk_bf16_f32 v156, v144, v145
    v_cvt_pk_bf16_f32 v157, v146, v147
    v_mfma_f32_16x16x32_bf16 v[136:139], v[112:115], v[164:167], v[136:139]
    ds_read_b128 v[248:251], v25 offset:16384
    ds_read_b64_tr_b16 v[188:189], v18 offset:7168
    v_mfma_f32_16x16x32_bf16 v[140:143], v[116:119], v[164:167], v[140:143]
    ds_read_b64_tr_b16 v[190:191], v18 offset:7424
    s_waitcnt lgkmcnt(14)
    v_mfma_f32_16x16x32_bf16 v[136:139], v[120:123], v[168:171], v[136:139]
    ds_read_b128 v[252:255], v25 offset:18432
    ds_read_b64_tr_b16 v[160:161], v4 offset:33280
    v_mfma_f32_16x16x32_bf16 v[140:143], v[124:127], v[168:171], v[140:143]
    ds_read_b64_tr_b16 v[162:163], v4 offset:34304
    buffer_load_dwordx4 v[208:211], v10, s[56:59], s77 offen offset:0 sc1
    v_mfma_f32_16x16x32_bf16 v[52:55], v[152:155], v[196:199], 0
    v_cvt_pk_bf16_f32 v158, v148, v149
    v_cvt_pk_bf16_f32 v159, v150, v151
    v_mfma_f32_16x16x32_bf16 v[136:139], v[128:131], v[172:175], v[136:139]
    s_waitcnt lgkmcnt(2)
    s_barrier
    ds_read_b64_tr_b16 v[164:165], v4 offset:41472
    v_mfma_f32_16x16x32_bf16 v[140:143], v[132:135], v[172:175], v[140:143]
    ds_read_b64_tr_b16 v[166:167], v4 offset:42496
    v_mfma_f32_16x16x32_bf16 v[144:147], v[224:227], v[176:179], 0
    ds_read_b64_tr_b16 v[168:169], v4 offset:49664
    buffer_load_dwordx4 v[212:215], v10, s[56:59], s77 offen offset:1024 sc1
    v_mfma_f32_16x16x32_bf16 v[148:151], v[228:231], v[176:179], 0
    ds_read_b64_tr_b16 v[170:171], v4 offset:50688
    buffer_load_dwordx4 v[216:219], v10, s[56:59], s77 offen offset:2048 sc1
    v_mfma_f32_16x16x32_bf16 v[40:43], v[156:159], v[192:195], 0
    v_cvt_pk_bf16_f32 v152, v136, v137
    v_cvt_pk_bf16_f32 v153, v138, v139
    v_mfma_f32_16x16x32_bf16 v[144:147], v[232:235], v[180:183], v[144:147]
    ds_read_b64_tr_b16 v[172:173], v4 offset:57856
    buffer_load_dwordx4 v[220:223], v10, s[56:59], s77 offen offset:3072 sc1
    v_mfma_f32_16x16x32_bf16 v[148:151], v[236:239], v[180:183], v[148:151]
    ds_read_b64_tr_b16 v[174:175], v4 offset:58880
    v_mfma_f32_16x16x32_bf16 v[144:147], v[240:243], v[184:187], v[144:147]
    ds_read_b64_tr_b16 v[176:177], v5 offset:33280
    buffer_load_dword v14, v11, s[56:59], s77 offen sc1
    v_mfma_f32_16x16x32_bf16 v[148:151], v[244:247], v[184:187], v[148:151]
    ds_read_b64_tr_b16 v[178:179], v5 offset:34304
    v_mfma_f32_16x16x32_bf16 v[56:59], v[156:159], v[196:199], 0
    v_cvt_pk_bf16_f32 v154, v140, v141
    v_cvt_pk_bf16_f32 v155, v142, v143
    v_mfma_f32_16x16x32_bf16 v[144:147], v[248:251], v[188:191], v[144:147]
    ds_read_b64_tr_b16 v[180:181], v5 offset:41472
    v_mfma_f32_16x16x32_bf16 v[148:151], v[252:255], v[188:191], v[148:151]
    ds_read_b64_tr_b16 v[182:183], v5 offset:42496
    s_waitcnt lgkmcnt(8)
    v_mfma_f32_16x16x32_bf16 v[136:139], v[224:227], v[160:163], 0
    ds_read_b64_tr_b16 v[184:185], v5 offset:49664
    v_mfma_f32_16x16x32_bf16 v[140:143], v[228:231], v[160:163], 0
    ds_read_b64_tr_b16 v[186:187], v5 offset:50688
    v_mfma_f32_16x16x32_bf16 v[44:47], v[152:155], v[192:195], 0
    v_cvt_pk_bf16_f32 v156, v144, v145
    v_cvt_pk_bf16_f32 v157, v146, v147
    v_mfma_f32_16x16x32_bf16 v[136:139], v[232:235], v[164:167], v[136:139]
    ds_read_b64_tr_b16 v[188:189], v5 offset:57856
    v_mfma_f32_16x16x32_bf16 v[140:143], v[236:239], v[164:167], v[140:143]
    ds_read_b64_tr_b16 v[190:191], v5 offset:58880
    s_waitcnt lgkmcnt(8)
    v_mfma_f32_16x16x32_bf16 v[136:139], v[240:243], v[168:171], v[136:139]
    ds_read_b64_tr_b16 v[160:161], v4 offset:33536
    v_mfma_f32_16x16x32_bf16 v[140:143], v[244:247], v[168:171], v[140:143]
    ds_read_b64_tr_b16 v[162:163], v4 offset:34560
    v_mfma_f32_16x16x32_bf16 v[60:63], v[152:155], v[196:199], 0
    v_cvt_pk_bf16_f32 v158, v148, v149
    v_cvt_pk_bf16_f32 v159, v150, v151
    v_mfma_f32_16x16x32_bf16 v[136:139], v[248:251], v[172:175], v[136:139]
    ds_read_b64_tr_b16 v[164:165], v4 offset:41728
    v_mfma_f32_16x16x32_bf16 v[140:143], v[252:255], v[172:175], v[140:143]
    ds_read_b64_tr_b16 v[166:167], v4 offset:42752
    s_waitcnt lgkmcnt(8)
    v_mfma_f32_16x16x32_bf16 v[144:147], v[224:227], v[176:179], 0
    ds_read_b64_tr_b16 v[168:169], v4 offset:49920
    v_mfma_f32_16x16x32_bf16 v[148:151], v[228:231], v[176:179], 0
    ds_read_b64_tr_b16 v[170:171], v4 offset:50944
    v_mfma_f32_16x16x32_bf16 v[96:99], v[156:159], v[200:203], v[96:99]
    v_cvt_pk_bf16_f32 v152, v136, v137
    v_cvt_pk_bf16_f32 v153, v138, v139
    v_mfma_f32_16x16x32_bf16 v[144:147], v[232:235], v[180:183], v[144:147]
    ds_read_b64_tr_b16 v[172:173], v4 offset:58112
    v_mfma_f32_16x16x32_bf16 v[148:151], v[236:239], v[180:183], v[148:151]
    ds_read_b64_tr_b16 v[174:175], v4 offset:59136
    s_waitcnt lgkmcnt(8)
    v_mfma_f32_16x16x32_bf16 v[144:147], v[240:243], v[184:187], v[144:147]
    ds_read_b64_tr_b16 v[176:177], v5 offset:33536
    v_mfma_f32_16x16x32_bf16 v[148:151], v[244:247], v[184:187], v[148:151]
    ds_read_b64_tr_b16 v[178:179], v5 offset:34560
    v_mfma_f32_16x16x32_bf16 v[100:103], v[156:159], v[204:207], v[100:103]
    v_cvt_pk_bf16_f32 v154, v140, v141
    v_cvt_pk_bf16_f32 v155, v142, v143
    v_mfma_f32_16x16x32_bf16 v[144:147], v[248:251], v[188:191], v[144:147]
    ds_read_b64_tr_b16 v[180:181], v5 offset:41728
    v_mfma_f32_16x16x32_bf16 v[148:151], v[252:255], v[188:191], v[148:151]
    ds_read_b64_tr_b16 v[182:183], v5 offset:42752
    s_waitcnt lgkmcnt(8)
    v_mfma_f32_16x16x32_bf16 v[136:139], v[224:227], v[160:163], 0
    ds_read_b64_tr_b16 v[184:185], v5 offset:49920
    v_mfma_f32_16x16x32_bf16 v[140:143], v[228:231], v[160:163], 0
    ds_read_b64_tr_b16 v[186:187], v5 offset:50944
    v_mfma_f32_16x16x32_bf16 v[64:67], v[152:155], v[200:203], v[64:67]
    v_cvt_pk_bf16_f32 v156, v144, v145
    v_cvt_pk_bf16_f32 v157, v146, v147
    v_mfma_f32_16x16x32_bf16 v[136:139], v[232:235], v[164:167], v[136:139]
    ds_read_b64_tr_b16 v[188:189], v5 offset:58112
    v_mfma_f32_16x16x32_bf16 v[140:143], v[236:239], v[164:167], v[140:143]
    ds_read_b64_tr_b16 v[190:191], v5 offset:59136
    s_waitcnt lgkmcnt(8)
    v_mfma_f32_16x16x32_bf16 v[136:139], v[240:243], v[168:171], v[136:139]
    ds_read_b64_tr_b16 v[160:161], v4 offset:32768
    v_mfma_f32_16x16x32_bf16 v[140:143], v[244:247], v[168:171], v[140:143]
    ds_read_b64_tr_b16 v[162:163], v4 offset:33792
    v_mfma_f32_16x16x32_bf16 v[80:83], v[152:155], v[204:207], v[80:83]
    v_cvt_pk_bf16_f32 v158, v148, v149
    v_cvt_pk_bf16_f32 v159, v150, v151
    v_mfma_f32_16x16x32_bf16 v[136:139], v[248:251], v[172:175], v[136:139]
    ds_read_b64_tr_b16 v[164:165], v4 offset:40960
    v_mfma_f32_16x16x32_bf16 v[140:143], v[252:255], v[172:175], v[140:143]
    ds_read_b64_tr_b16 v[166:167], v4 offset:41984
    s_waitcnt lgkmcnt(8)
    v_mfma_f32_16x16x32_bf16 v[144:147], v[224:227], v[176:179], 0
    ds_read_b64_tr_b16 v[168:169], v4 offset:49152
    v_mfma_f32_16x16x32_bf16 v[148:151], v[228:231], v[176:179], 0
    ds_read_b64_tr_b16 v[170:171], v4 offset:50176
    v_mfma_f32_16x16x32_bf16 v[68:71], v[156:159], v[200:203], v[68:71]
    v_cvt_pk_bf16_f32 v152, v136, v137
    v_cvt_pk_bf16_f32 v153, v138, v139
    v_mfma_f32_16x16x32_bf16 v[144:147], v[232:235], v[180:183], v[144:147]
    ds_read_b64_tr_b16 v[172:173], v4 offset:57344
    v_mfma_f32_16x16x32_bf16 v[148:151], v[236:239], v[180:183], v[148:151]
    ds_read_b64_tr_b16 v[174:175], v4 offset:58368
    s_waitcnt lgkmcnt(8)
    v_mfma_f32_16x16x32_bf16 v[144:147], v[240:243], v[184:187], v[144:147]
    ds_read_b64_tr_b16 v[176:177], v5 offset:32768
    v_mfma_f32_16x16x32_bf16 v[148:151], v[244:247], v[184:187], v[148:151]
    ds_read_b64_tr_b16 v[178:179], v5 offset:33792
    v_mfma_f32_16x16x32_bf16 v[84:87], v[156:159], v[204:207], v[84:87]
    v_cvt_pk_bf16_f32 v154, v140, v141
    v_cvt_pk_bf16_f32 v155, v142, v143
    v_mfma_f32_16x16x32_bf16 v[144:147], v[248:251], v[188:191], v[144:147]
    ds_read_b64_tr_b16 v[180:181], v5 offset:40960
    v_mfma_f32_16x16x32_bf16 v[148:151], v[252:255], v[188:191], v[148:151]
    ds_read_b64_tr_b16 v[182:183], v5 offset:41984
    s_waitcnt lgkmcnt(8)
    v_mfma_f32_16x16x32_bf16 v[136:139], v[224:227], v[160:163], 0
    ds_read_b64_tr_b16 v[184:185], v5 offset:49152
    s_waitcnt vmcnt(0)
    v_bitop3_b32 v14, v208, v212, v14 bitop3:0x96
    v_mfma_f32_16x16x32_bf16 v[140:143], v[228:231], v[160:163], 0
    ds_read_b64_tr_b16 v[186:187], v5 offset:50176
    v_bitop3_b32 v26, v209, v213, v217 bitop3:0x96
    v_mfma_f32_16x16x32_bf16 v[72:75], v[152:155], v[200:203], v[72:75]
    v_cvt_pk_bf16_f32 v156, v144, v145
    v_cvt_pk_bf16_f32 v157, v146, v147
    v_mfma_f32_16x16x32_bf16 v[136:139], v[232:235], v[164:167], v[136:139]
    ds_read_b64_tr_b16 v[188:189], v5 offset:57344
    v_bitop3_b32 v27, v210, v214, v218 bitop3:0x96
    v_mfma_f32_16x16x32_bf16 v[140:143], v[236:239], v[164:167], v[140:143]
    ds_read_b64_tr_b16 v[190:191], v5 offset:58368
    s_waitcnt lgkmcnt(8)
    v_mfma_f32_16x16x32_bf16 v[136:139], v[240:243], v[168:171], v[136:139]
    ds_read_b64_tr_b16 v[160:161], v4 offset:33024
    v_bitop3_b32 v9, v211, v215, v219 bitop3:0x96
    v_mfma_f32_16x16x32_bf16 v[140:143], v[244:247], v[168:171], v[140:143]
    ds_read_b64_tr_b16 v[162:163], v4 offset:34048
    v_bitop3_b32 v14, v216, v220, v14 bitop3:0x96
    v_mfma_f32_16x16x32_bf16 v[88:91], v[152:155], v[204:207], v[88:91]
    v_cvt_pk_bf16_f32 v158, v148, v149
    v_cvt_pk_bf16_f32 v159, v150, v151
    v_mfma_f32_16x16x32_bf16 v[136:139], v[248:251], v[172:175], v[136:139]
    ds_read_b64_tr_b16 v[164:165], v4 offset:41216
    v_xor_b32 v26, v221, v26
    v_mfma_f32_16x16x32_bf16 v[140:143], v[252:255], v[172:175], v[140:143]
    ds_read_b64_tr_b16 v[166:167], v4 offset:42240
    s_waitcnt lgkmcnt(8)
    v_mfma_f32_16x16x32_bf16 v[144:147], v[224:227], v[176:179], 0
    ds_read_b64_tr_b16 v[168:169], v4 offset:49408
    v_xor_b32 v27, v222, v27
    v_mfma_f32_16x16x32_bf16 v[148:151], v[228:231], v[176:179], 0
    ds_read_b64_tr_b16 v[170:171], v4 offset:50432
    v_xor_b32 v9, v223, v9
    v_mfma_f32_16x16x32_bf16 v[76:79], v[156:159], v[200:203], v[76:79]
    v_cvt_pk_bf16_f32 v152, v136, v137
    v_cvt_pk_bf16_f32 v153, v138, v139
    v_mfma_f32_16x16x32_bf16 v[144:147], v[232:235], v[180:183], v[144:147]
    ds_read_b32 v21, v22
    ds_read_b64_tr_b16 v[172:173], v4 offset:57600
    v_mfma_f32_16x16x32_bf16 v[148:151], v[236:239], v[180:183], v[148:151]
    ds_read_b64_tr_b16 v[174:175], v4 offset:58624
    s_waitcnt lgkmcnt(9)
    v_mfma_f32_16x16x32_bf16 v[144:147], v[240:243], v[184:187], v[144:147]
    ds_read_b64_tr_b16 v[176:177], v5 offset:33024
    v_alignbit_b32 v26, v26, v26, 5
    v_mfma_f32_16x16x32_bf16 v[148:151], v[244:247], v[184:187], v[148:151]
    ds_read_b64_tr_b16 v[178:179], v5 offset:34048
    v_alignbit_b32 v27, v27, v27, 10
    v_mfma_f32_16x16x32_bf16 v[92:95], v[156:159], v[204:207], v[92:95]
    v_cvt_pk_bf16_f32 v154, v140, v141
    v_cvt_pk_bf16_f32 v155, v142, v143
    v_mfma_f32_16x16x32_bf16 v[144:147], v[248:251], v[188:191], v[144:147]
    ds_read_b64_tr_b16 v[180:181], v5 offset:41216
    v_alignbit_b32 v9, v9, v9, 15
    v_mfma_f32_16x16x32_bf16 v[148:151], v[252:255], v[188:191], v[148:151]
    ds_read_b64_tr_b16 v[182:183], v5 offset:42240
    s_waitcnt lgkmcnt(9)
    v_mfma_f32_16x16x32_bf16 v[136:139], v[224:227], v[160:163], 0
    ds_read_b64_tr_b16 v[184:185], v5 offset:49408
    v_bitop3_b32 v14, v26, v27, v14 bitop3:0x96
    v_mfma_f32_16x16x32_bf16 v[140:143], v[228:231], v[160:163], 0
    ds_read_b64_tr_b16 v[186:187], v5 offset:50432
    v_xor_b32 v14, v9, v14
    v_mfma_f32_16x16x32_bf16 v[32:35], v[152:155], v[200:203], v[32:35]
    v_cvt_pk_bf16_f32 v156, v144, v145
    v_cvt_pk_bf16_f32 v157, v146, v147
    v_mfma_f32_16x16x32_bf16 v[136:139], v[232:235], v[164:167], v[136:139]
    s_waitcnt lgkmcnt(8)
    v_cmp_gt_u32 vcc, 24, v21
    ds_read_b64_tr_b16 v[188:189], v5 offset:57600
    v_mfma_f32_16x16x32_bf16 v[140:143], v[236:239], v[164:167], v[140:143]
    s_cbranch_vccnz L_cs47
L_co47:
    ds_read_b64_tr_b16 v[190:191], v5 offset:58624
    s_waitcnt lgkmcnt(8)
    v_mfma_f32_16x16x32_bf16 v[136:139], v[240:243], v[168:171], v[136:139]
    ds_read_b64_tr_b16 v[160:161], v18 offset:8192
    v_cmp_ne_u32 vcc, s53, v14
    s_cbranch_vccnz L_p_spin1
L_p_ok1:
    v_mfma_f32_16x16x32_bf16 v[140:143], v[244:247], v[168:171], v[140:143]
    ds_read_b32 v21, v22
    ds_read_b64_tr_b16 v[162:163], v18 offset:8448
    v_mfma_f32_16x16x32_bf16 v[48:51], v[152:155], v[204:207], v[48:51]
    v_cvt_pk_bf16_f32 v158, v148, v149
    v_cvt_pk_bf16_f32 v159, v150, v151
    v_mfma_f32_16x16x32_bf16 v[136:139], v[248:251], v[172:175], v[136:139]
    ds_read_b64_tr_b16 v[164:165], v18 offset:9216
    v_mfma_f32_16x16x32_bf16 v[140:143], v[252:255], v[172:175], v[140:143]
    ds_read_b64_tr_b16 v[166:167], v18 offset:9472
    s_waitcnt lgkmcnt(9)
    v_mfma_f32_16x16x32_bf16 v[144:147], v[224:227], v[176:179], 0
    s_waitcnt lgkmcnt(3)
    v_cmp_gt_u32 vcc, 25, v21
    ds_read_b64_tr_b16 v[168:169], v18 offset:10240
    v_mfma_f32_16x16x32_bf16 v[148:151], v[228:231], v[176:179], 0
    s_cbranch_vccnz L_cs48
L_co48:
    ds_read_b64_tr_b16 v[170:171], v18 offset:10496
    v_mfma_f32_16x16x32_bf16 v[36:39], v[156:159], v[200:203], v[36:39]
    v_cvt_pk_bf16_f32 v152, v136, v137
    v_cvt_pk_bf16_f32 v153, v138, v139
    v_mfma_f32_16x16x32_bf16 v[144:147], v[232:235], v[180:183], v[144:147]
    ds_read_b128 v[104:107], v24 offset:32768
    ds_read_b128 v[108:111], v24 offset:34816
    ds_read_b64_tr_b16 v[172:173], v18 offset:11264
    v_mfma_f32_16x16x32_bf16 v[148:151], v[236:239], v[180:183], v[148:151]
    ds_read_b128 v[112:115], v25 offset:32768
    ds_read_b128 v[116:119], v25 offset:34816
    ds_read_b64_tr_b16 v[174:175], v18 offset:11520
    v_mfma_f32_16x16x32_bf16 v[144:147], v[240:243], v[184:187], v[144:147]
    ds_read_b128 v[120:123], v24 offset:0
    ds_read_b128 v[124:127], v24 offset:2048
    ds_read_b64_tr_b16 v[176:177], v16 offset:512
    v_mfma_f32_16x16x32_bf16 v[148:151], v[244:247], v[184:187], v[148:151]
    ds_read_b128 v[128:131], v25 offset:0
    ds_read_b128 v[132:135], v25 offset:2048
    ds_read_b64_tr_b16 v[178:179], v16 offset:1536
    v_mfma_f32_16x16x32_bf16 v[52:55], v[156:159], v[204:207], v[52:55]
    v_cvt_pk_bf16_f32 v154, v140, v141
    v_cvt_pk_bf16_f32 v155, v142, v143
    v_mfma_f32_16x16x32_bf16 v[144:147], v[248:251], v[188:191], v[144:147]
    ds_read_b64_tr_b16 v[180:181], v16 offset:8704
    v_mfma_f32_16x16x32_bf16 v[148:151], v[252:255], v[188:191], v[148:151]
    ds_read_b64_tr_b16 v[182:183], v16 offset:9728
    s_waitcnt lgkmcnt(12)
    v_mfma_f32_16x16x32_bf16 v[136:139], v[104:107], v[160:163], 0
    ds_read_b64_tr_b16 v[184:185], v16 offset:16896
    v_mfma_f32_16x16x32_bf16 v[140:143], v[108:111], v[160:163], 0
    ds_read_b64_tr_b16 v[186:187], v16 offset:17920
    v_mfma_f32_16x16x32_bf16 v[40:43], v[152:155], v[200:203], v[40:43]
    v_cvt_pk_bf16_f32 v156, v144, v145
    v_cvt_pk_bf16_f32 v157, v146, v147
    s_waitcnt lgkmcnt(11)
    v_mfma_f32_16x16x32_bf16 v[136:139], v[112:115], v[164:167], v[136:139]
    s_waitcnt lgkmcnt(5)
    s_barrier
    ds_read_b64_tr_b16 v[188:189], v16 offset:25088
    v_mfma_f32_16x16x32_bf16 v[140:143], v[116:119], v[164:167], v[140:143]
    ds_read_b64_tr_b16 v[190:191], v16 offset:26112
    v_mfma_f32_16x16x32_bf16 v[136:139], v[120:123], v[168:171], v[136:139]
    ds_read_b64_tr_b16 v[160:161], v17 offset:512
    v_mfma_f32_16x16x32_bf16 v[140:143], v[124:127], v[168:171], v[140:143]
    ds_read_b64_tr_b16 v[162:163], v17 offset:1536
    v_mfma_f32_16x16x32_bf16 v[56:59], v[152:155], v[204:207], v[56:59]
    v_cvt_pk_bf16_f32 v158, v148, v149
    v_cvt_pk_bf16_f32 v159, v150, v151
    v_mfma_f32_16x16x32_bf16 v[136:139], v[128:131], v[172:175], v[136:139]
    ds_read_b64_tr_b16 v[164:165], v17 offset:8704
    v_mfma_f32_16x16x32_bf16 v[140:143], v[132:135], v[172:175], v[140:143]
    ds_read_b64_tr_b16 v[166:167], v17 offset:9728
    s_waitcnt lgkmcnt(8)
    v_mfma_f32_16x16x32_bf16 v[144:147], v[104:107], v[176:179], 0
    ds_read_b64_tr_b16 v[168:169], v17 offset:16896
    v_mfma_f32_16x16x32_bf16 v[148:151], v[108:111], v[176:179], 0
    ds_read_b64_tr_b16 v[170:171], v17 offset:17920
    v_mfma_f32_16x16x32_bf16 v[44:47], v[156:159], v[200:203], v[44:47]
    v_cvt_pk_bf16_f32 v152, v136, v137
    v_cvt_pk_bf16_f32 v153, v138, v139
    v_mfma_f32_16x16x32_bf16 v[144:147], v[112:115], v[180:183], v[144:147]
    ds_read_b64_tr_b16 v[172:173], v17 offset:25088
    v_mfma_f32_16x16x32_bf16 v[148:151], v[116:119], v[180:183], v[148:151]
    ds_read_b64_tr_b16 v[174:175], v17 offset:26112
    s_waitcnt lgkmcnt(8)
    v_mfma_f32_16x16x32_bf16 v[144:147], v[120:123], v[184:187], v[144:147]
    ds_read_b64_tr_b16 v[176:177], v16 offset:768
    v_mfma_f32_16x16x32_bf16 v[148:151], v[124:127], v[184:187], v[148:151]
    ds_read_b64_tr_b16 v[178:179], v16 offset:1792
    v_mfma_f32_16x16x32_bf16 v[60:63], v[156:159], v[204:207], v[60:63]
    v_cvt_pk_bf16_f32 v154, v140, v141
    v_cvt_pk_bf16_f32 v155, v142, v143
    v_mfma_f32_16x16x32_bf16 v[144:147], v[128:131], v[188:191], v[144:147]
    ds_read_b64_tr_b16 v[180:181], v16 offset:8960
    v_mfma_f32_16x16x32_bf16 v[148:151], v[132:135], v[188:191], v[148:151]
    ds_read_b64_tr_b16 v[182:183], v16 offset:9984
    s_waitcnt lgkmcnt(8)
    v_mfma_f32_16x16x32_bf16 v[136:139], v[104:107], v[160:163], 0
    ds_read_b64_tr_b16 v[184:185], v16 offset:17152
    v_mfma_f32_16x16x32_bf16 v[140:143], v[108:111], v[160:163], 0
    ds_read_b64_tr_b16 v[186:187], v16 offset:18176
    v_mfma_f32_16x16x32_bf16 v[96:99], v[152:155], v[208:211], v[96:99]
    v_cvt_pk_bf16_f32 v156, v144, v145
    v_cvt_pk_bf16_f32 v157, v146, v147
    v_mfma_f32_16x16x32_bf16 v[136:139], v[112:115], v[164:167], v[136:139]
    ds_read_b64_tr_b16 v[188:189], v16 offset:25344
    v_mfma_f32_16x16x32_bf16 v[140:143], v[116:119], v[164:167], v[140:143]
    ds_read_b64_tr_b16 v[190:191], v16 offset:26368
    s_waitcnt lgkmcnt(8)
    v_mfma_f32_16x16x32_bf16 v[136:139], v[120:123], v[168:171], v[136:139]
    ds_read_b64_tr_b16 v[160:161], v17 offset:768
    v_mfma_f32_16x16x32_bf16 v[140:143], v[124:127], v[168:171], v[140:143]
    ds_read_b64_tr_b16 v[162:163], v17 offset:1792
    v_mfma_f32_16x16x32_bf16 v[100:103], v[152:155], v[212:215], v[100:103]
    v_cvt_pk_bf16_f32 v158, v148, v149
    v_cvt_pk_bf16_f32 v159, v150, v151
    v_mfma_f32_16x16x32_bf16 v[136:139], v[128:131], v[172:175], v[136:139]
    ds_read_b64_tr_b16 v[164:165], v17 offset:8960
    v_mfma_f32_16x16x32_bf16 v[140:143], v[132:135], v[172:175], v[140:143]
    ds_read_b64_tr_b16 v[166:167], v17 offset:9984
    s_waitcnt lgkmcnt(8)
    v_mfma_f32_16x16x32_bf16 v[144:147], v[104:107], v[176:179], 0
    ds_read_b64_tr_b16 v[168:169], v17 offset:17152
    v_mfma_f32_16x16x32_bf16 v[148:151], v[108:111], v[176:179], 0
    ds_read_b64_tr_b16 v[170:171], v17 offset:18176
    v_mfma_f32_16x16x32_bf16 v[64:67], v[156:159], v[208:211], v[64:67]
    v_cvt_pk_bf16_f32 v152, v136, v137
    v_cvt_pk_bf16_f32 v153, v138, v139
    v_mfma_f32_16x16x32_bf16 v[144:147], v[112:115], v[180:183], v[144:147]
    ds_read_b64_tr_b16 v[172:173], v17 offset:25344
    v_mfma_f32_16x16x32_bf16 v[148:151], v[116:119], v[180:183], v[148:151]
    ds_read_b64_tr_b16 v[174:175], v17 offset:26368
    s_waitcnt lgkmcnt(8)
    v_mfma_f32_16x16x32_bf16 v[144:147], v[120:123], v[184:187], v[144:147]
    ds_read_b64_tr_b16 v[176:177], v16 offset:0
    v_mfma_f32_16x16x32_bf16 v[148:151], v[124:127], v[184:187], v[148:151]
    ds_read_b64_tr_b16 v[178:179], v16 offset:1024
    v_mfma_f32_16x16x32_bf16 v[80:83], v[156:159], v[212:215], v[80:83]
    v_cvt_pk_bf16_f32 v154, v140, v141
    v_cvt_pk_bf16_f32 v155, v142, v143
    v_mfma_f32_16x16x32_bf16 v[144:147], v[128:131], v[188:191], v[144:147]
    ds_read_b64_tr_b16 v[180:181], v16 offset:8192
    v_mfma_f32_16x16x32_bf16 v[148:151], v[132:135], v[188:191], v[148:151]
    ds_read_b64_tr_b16 v[182:183], v16 offset:9216
    s_waitcnt lgkmcnt(8)
    v_mfma_f32_16x16x32_bf16 v[136:139], v[104:107], v[160:163], 0
    ds_read_b64_tr_b16 v[184:185], v16 offset:16384
    v_mfma_f32_16x16x32_bf16 v[140:143], v[108:111], v[160:163], 0
    ds_read_b64_tr_b16 v[186:187], v16 offset:17408
    v_mfma_f32_16x16x32_bf16 v[68:71], v[152:155], v[208:211], v[68:71]
    v_cvt_pk_bf16_f32 v156, v144, v145
    v_cvt_pk_bf16_f32 v157, v146, v147
    v_mfma_f32_16x16x32_bf16 v[136:139], v[112:115], v[164:167], v[136:139]
    ds_read_b64_tr_b16 v[188:189], v16 offset:24576
    v_mfma_f32_16x16x32_bf16 v[140:143], v[116:119], v[164:167], v[140:143]
    ds_read_b64_tr_b16 v[190:191], v16 offset:25600
    s_waitcnt lgkmcnt(8)
    v_mfma_f32_16x16x32_bf16 v[136:139], v[120:123], v[168:171], v[136:139]
    ds_read_b64_tr_b16 v[160:161], v17 offset:0
    v_mfma_f32_16x16x32_bf16 v[140:143], v[124:127], v[168:171], v[140:143]
    ds_read_b64_tr_b16 v[162:163], v17 offset:1024
    v_mfma_f32_16x16x32_bf16 v[84:87], v[152:155], v[212:215], v[84:87]
    v_cvt_pk_bf16_f32 v158, v148, v149
    v_cvt_pk_bf16_f32 v159, v150, v151
    v_mfma_f32_16x16x32_bf16 v[136:139], v[128:131], v[172:175], v[136:139]
    ds_read_b64_tr_b16 v[164:165], v17 offset:8192
    v_mfma_f32_16x16x32_bf16 v[140:143], v[132:135], v[172:175], v[140:143]
    ds_read_b64_tr_b16 v[166:167], v17 offset:9216
    s_waitcnt lgkmcnt(8)
    v_mfma_f32_16x16x32_bf16 v[144:147], v[104:107], v[176:179], 0
    ds_read_b64_tr_b16 v[168:169], v17 offset:16384
    v_mfma_f32_16x16x32_bf16 v[148:151], v[108:111], v[176:179], 0
    ds_read_b64_tr_b16 v[170:171], v17 offset:17408
    v_mfma_f32_16x16x32_bf16 v[72:75], v[156:159], v[208:211], v[72:75]
    v_cvt_pk_bf16_f32 v152, v136, v137
    v_cvt_pk_bf16_f32 v153, v138, v139
    v_mfma_f32_16x16x32_bf16 v[144:147], v[112:115], v[180:183], v[144:147]
    ds_read_b64_tr_b16 v[172:173], v17 offset:24576
    v_mfma_f32_16x16x32_bf16 v[148:151], v[116:119], v[180:183], v[148:151]
    ds_read_b64_tr_b16 v[174:175], v17 offset:25600
    s_waitcnt lgkmcnt(8)
    v_mfma_f32_16x16x32_bf16 v[144:147], v[120:123], v[184:187], v[144:147]
    ds_read_b64_tr_b16 v[176:177], v16 offset:256
    v_mfma_f32_16x16x32_bf16 v[148:151], v[124:127], v[184:187], v[148:151]
    ds_read_b64_tr_b16 v[178:179], v16 offset:1280
    v_mfma_f32_16x16x32_bf16 v[88:91], v[156:159], v[212:215], v[88:91]
    v_cvt_pk_bf16_f32 v154, v140, v141
    v_cvt_pk_bf16_f32 v155, v142, v143
    v_mfma_f32_16x16x32_bf16 v[144:147], v[128:131], v[188:191], v[144:147]
    ds_read_b64_tr_b16 v[180:181], v16 offset:8448
    v_mfma_f32_16x16x32_bf16 v[148:151], v[132:135], v[188:191], v[148:151]
    ds_read_b64_tr_b16 v[182:183], v16 offset:9472
    s_waitcnt lgkmcnt(8)
    v_mfma_f32_16x16x32_bf16 v[136:139], v[104:107], v[160:163], 0
    ds_read_b64_tr_b16 v[184:185], v16 offset:16640
    v_mfma_f32_16x16x32_bf16 v[140:143], v[108:111], v[160:163], 0
    ds_read_b64_tr_b16 v[186:187], v16 offset:17664
    v_mfma_f32_16x16x32_bf16 v[76:79], v[152:155], v[208:211], v[76:79]
    v_cvt_pk_bf16_f32 v156, v144, v145
    v_cvt_pk_bf16_f32 v157, v146, v147
    v_mfma_f32_16x16x32_bf16 v[136:139], v[112:115], v[164:167], v[136:139]
    ds_read_b32 v21, v22
    ds_read_b64_tr_b16 v[188:189], v16 offset:24832
    v_mfma_f32_16x16x32_bf16 v[140:143], v[116:119], v[164:167], v[140:143]
    ds_read_b64_tr_b16 v[190:191], v16 offset:25856
    s_waitcnt lgkmcnt(9)
    v_mfma_f32_16x16x32_bf16 v[136:139], v[120:123], v[168:171], v[136:139]
    ds_read_b64_tr_b16 v[160:161], v17 offset:256
    v_mfma_f32_16x16x32_bf16 v[140:143], v[124:127], v[168:171], v[140:143]
    ds_read_b64_tr_b16 v[162:163], v17 offset:1280
    v_mfma_f32_16x16x32_bf16 v[92:95], v[152:155], v[212:215], v[92:95]
    v_cvt_pk_bf16_f32 v158, v148, v149
    v_cvt_pk_bf16_f32 v159, v150, v151
    v_mfma_f32_16x16x32_bf16 v[136:139], v[128:131], v[172:175], v[136:139]
    ds_read_b64_tr_b16 v[164:165], v17 offset:8448
    v_mfma_f32_16x16x32_bf16 v[140:143], v[132:135], v[172:175], v[140:143]
    ds_read_b64_tr_b16 v[166:167], v17 offset:9472
    s_waitcnt lgkmcnt(9)
    v_mfma_f32_16x16x32_bf16 v[144:147], v[104:107], v[176:179], 0
    ds_read_b64_tr_b16 v[168:169], v17 offset:16640
    buffer_load_dwordx4 v[192:195], v10, s[56:59], s78 offen offset:0 sc1
    v_mfma_f32_16x16x32_bf16 v[148:151], v[108:111], v[176:179], 0
    ds_read_b64_tr_b16 v[170:171], v17 offset:17664
    buffer_load_dwordx4 v[196:199], v10, s[56:59], s78 offen offset:1024 sc1
    v_mfma_f32_16x16x32_bf16 v[32:35], v[156:159], v[208:211], v[32:35]
    v_cvt_pk_bf16_f32 v152, v136, v137
    v_cvt_pk_bf16_f32 v153, v138, v139
    v_mfma_f32_16x16x32_bf16 v[144:147], v[112:115], v[180:183], v[144:147]
    s_waitcnt lgkmcnt(8)
    v_cmp_gt_u32 vcc, 26, v21
    ds_read_b64_tr_b16 v[172:173], v17 offset:24832
    v_mfma_f32_16x16x32_bf16 v[148:151], v[116:119], v[180:183], v[148:151]
    s_cbranch_vccnz L_cs49
L_co49:
    ds_read_b64_tr_b16 v[174:175], v17 offset:25856
    s_waitcnt lgkmcnt(8)
    v_mfma_f32_16x16x32_bf16 v[144:147], v[120:123], v[184:187], v[144:147]
    ds_read_b64_tr_b16 v[176:177], v18 offset:0
    buffer_load_dwordx4 v[200:203], v10, s[56:59], s78 offen offset:2048 sc1
    v_mfma_f32_16x16x32_bf16 v[148:151], v[124:127], v[184:187], v[148:151]
    ds_read_b32 v21, v22
    ds_read_b64_tr_b16 v[178:179], v18 offset:256
    v_mfma_f32_16x16x32_bf16 v[48:51], v[156:159], v[212:215], v[48:51]
    v_cvt_pk_bf16_f32 v154, v140, v141
    v_cvt_pk_bf16_f32 v155, v142, v143
    v_mfma_f32_16x16x32_bf16 v[144:147], v[128:131], v[188:191], v[144:147]
    ds_read_b64_tr_b16 v[180:181], v18 offset:1024
    buffer_load_dwordx4 v[204:207], v10, s[56:59], s78 offen offset:3072 sc1
    v_mfma_f32_16x16x32_bf16 v[148:151], v[132:135], v[188:191], v[148:151]
    ds_read_b64_tr_b16 v[182:183], v18 offset:1280
    s_waitcnt lgkmcnt(9)
    v_mfma_f32_16x16x32_bf16 v[136:139], v[104:107], v[160:163], 0
    s_waitcnt lgkmcnt(3)
    v_cmp_gt_u32 vcc, 27, v21
    ds_read_b64_tr_b16 v[184:185], v18 offset:2048
    v_mfma_f32_16x16x32_bf16 v[140:143], v[108:111], v[160:163], 0
    s_cbranch_vccnz L_cs50
L_co50:
    ds_read_b64_tr_b16 v[186:187], v18 offset:2304
    v_mfma_f32_16x16x32_bf16 v[36:39], v[152:155], v[208:211], v[36:39]
    v_cvt_pk_bf16_f32 v156, v144, v145
    v_cvt_pk_bf16_f32 v157, v146, v147
    v_mfma_f32_16x16x32_bf16 v[136:139], v[112:115], v[164:167], v[136:139]
    ds_read_b128 v[224:227], v24 offset:16384
    ds_read_b128 v[228:231], v24 offset:18432
    ds_read_b64_tr_b16 v[188:189], v18 offset:3072
    v_mfma_f32_16x16x32_bf16 v[140:143], v[116:119], v[164:167], v[140:143]
    ds_read_b128 v[232:235], v25 offset:16384
    ds_read_b128 v[236:239], v25 offset:18432
    ds_read_b64_tr_b16 v[190:191], v18 offset:3328
    v_mfma_f32_16x16x32_bf16 v[136:139], v[120:123], v[168:171], v[136:139]
    ds_read_b128 v[240:243], v24 offset:32768
    ds_read_b128 v[244:247], v24 offset:34816
    ds_read_b64_tr_b16 v[160:161], v4 offset:512
    v_mfma_f32_16x16x32_bf16 v[140:143], v[124:127], v[168:171], v[140:143]
    ds_read_b128 v[248:251], v25 offset:32768
    ds_read_b128 v[252:255], v25 offset:34816
    ds_read_b64_tr_b16 v[162:163], v4 offset:1536
    v_mfma_f32_16x16x32_bf16 v[52:55], v[152:155], v[212:215], v[52:55]
    v_cvt_pk_bf16_f32 v158, v148, v149
    v_cvt_pk_bf16_f32 v159, v150, v151
    v_mfma_f32_16x16x32_bf16 v[136:139], v[128:131], v[172:175], v[136:139]
    ds_read_b64_tr_b16 v[164:165], v4 offset:8704
    buffer_load_dword v14, v11, s[56:59], s78 offen sc1
    v_mfma_f32_16x16x32_bf16 v[140:143], v[132:135], v[172:175], v[140:143]
    ds_read_b64_tr_b16 v[166:167], v4 offset:9728
    s_waitcnt lgkmcnt(12)
    v_mfma_f32_16x16x32_bf16 v[144:147], v[224:227], v[176:179], 0
    ds_read_b64_tr_b16 v[168:169], v4 offset:16896
    v_mfma_f32_16x16x32_bf16 v[148:151], v[228:231], v[176:179], 0
    ds_read_b64_tr_b16 v[170:171], v4 offset:17920
    v_mfma_f32_16x16x32_bf16 v[40:43], v[156:159], v[208:211], v[40:43]
    v_cvt_pk_bf16_f32 v152, v136, v137
    v_cvt_pk_bf16_f32 v153, v138, v139
    s_waitcnt lgkmcnt(11)
    v_mfma_f32_16x16x32_bf16 v[144:147], v[232:235], v[180:183], v[144:147]
    s_waitcnt lgkmcnt(5)
    s_barrier
    ds_read_b64_tr_b16 v[172:173], v4 offset:25088
    v_mfma_f32_16x16x32_bf16 v[148:151], v[236:239], v[180:183], v[148:151]
    ds_read_b64_tr_b16 v[174:175], v4 offset:26112
    v_mfma_f32_16x16x32_bf16 v[144:147], v[240:243], v[184:187], v[144:147]
    ds_read_b64_tr_b16 v[176:177], v5 offset:512
    v_mfma_f32_16x16x32_bf16 v[148:151], v[244:247], v[184:187], v[148:151]
    ds_read_b64_tr_b16 v[178:179], v5 offset:1536
    v_mfma_f32_16x16x32_bf16 v[56:59], v[156:159], v[212:215], v[56:59]
    v_cvt_pk_bf16_f32 v154, v140, v141
    v_cvt_pk_bf16_f32 v155, v142, v143
    v_mfma_f32_16x16x32_bf16 v[144:147], v[248:251], v[188:191], v[144:147]
    ds_read_b64_tr_b16 v[180:181], v5 offset:8704
    v_mfma_f32_16x16x32_bf16 v[148:151], v[252:255], v[188:191], v[148:151]
    ds_read_b64_tr_b16 v[182:183], v5 offset:9728
    s_waitcnt lgkmcnt(8)
    v_mfma_f32_16x16x32_bf16 v[136:139], v[224:227], v[160:163], 0
    ds_read_b64_tr_b16 v[184:185], v5 offset:16896
    v_mfma_f32_16x16x32_bf16 v[140:143], v[228:231], v[160:163], 0
    ds_read_b64_tr_b16 v[186:187], v5 offset:17920
    v_mfma_f32_16x16x32_bf16 v[44:47], v[152:155], v[208:211], v[44:47]
    v_cvt_pk_bf16_f32 v156, v144, v145
    v_cvt_pk_bf16_f32 v157, v146, v147
    v_mfma_f32_16x16x32_bf16 v[136:139], v[232:235], v[164:167], v[136:139]
    ds_read_b64_tr_b16 v[188:189], v5 offset:25088
    v_mfma_f32_16x16x32_bf16 v[140:143], v[236:239], v[164:167], v[140:143]
    ds_read_b64_tr_b16 v[190:191], v5 offset:26112
    s_waitcnt lgkmcnt(8)
    v_mfma_f32_16x16x32_bf16 v[136:139], v[240:243], v[168:171], v[136:139]
    ds_read_b64_tr_b16 v[160:161], v4 offset:768
    v_mfma_f32_16x16x32_bf16 v[140:143], v[244:247], v[168:171], v[140:143]
    ds_read_b64_tr_b16 v[162:163], v4 offset:1792
    v_mfma_f32_16x16x32_bf16 v[60:63], v[152:155], v[212:215], v[60:63]
    v_cvt_pk_bf16_f32 v158, v148, v149
    v_cvt_pk_bf16_f32 v159, v150, v151
    v_mfma_f32_16x16x32_bf16 v[136:139], v[248:251], v[172:175], v[136:139]
    ds_read_b64_tr_b16 v[164:165], v4 offset:8960
    v_mfma_f32_16x16x32_bf16 v[140:143], v[252:255], v[172:175], v[140:143]
    ds_read_b64_tr_b16 v[166:167], v4 offset:9984
    s_waitcnt lgkmcnt(8)
    v_mfma_f32_16x16x32_bf16 v[144:147], v[224:227], v[176:179], 0
    ds_read_b64_tr_b16 v[168:169], v4 offset:17152
    v_mfma_f32_16x16x32_bf16 v[148:151], v[228:231], v[176:179], 0
    ds_read_b64_tr_b16 v[170:171], v4 offset:18176
    v_mfma_f32_16x16x32_bf16 v[96:99], v[156:159], v[216:219], v[96:99]
    v_cvt_pk_bf16_f32 v152, v136, v137
    v_cvt_pk_bf16_f32 v153, v138, v139
    v_mfma_f32_16x16x32_bf16 v[144:147], v[232:235], v[180:183], v[144:147]
    ds_read_b64_tr_b16 v[172:173], v4 offset:25344
    v_mfma_f32_16x16x32_bf16 v[148:151], v[236:239], v[180:183], v[148:151]
    ds_read_b64_tr_b16 v[174:175], v4 offset:26368
    s_waitcnt lgkmcnt(8)
    v_mfma_f32_16x16x32_bf16 v[144:147], v[240:243], v[184:187], v[144:147]
    ds_read_b64_tr_b16 v[176:177], v5 offset:768
    v_mfma_f32_16x16x32_bf16 v[148:151], v[244:247], v[184:187], v[148:151]
    ds_read_b64_tr_b16 v[178:179], v5 offset:1792
    v_mfma_f32_16x16x32_bf16 v[100:103], v[156:159], v[220:223], v[100:103]
    v_cvt_pk_bf16_f32 v154, v140, v141
    v_cvt_pk_bf16_f32 v155, v142, v143
    v_mfma_f32_16x16x32_bf16 v[144:147], v[248:251], v[188:191], v[144:147]
    ds_read_b64_tr_b16 v[180:181], v5 offset:8960
    v_mfma_f32_16x16x32_bf16 v[148:151], v[252:255], v[188:191], v[148:151]
    ds_read_b64_tr_b16 v[182:183], v5 offset:9984
    s_waitcnt lgkmcnt(8)
    v_mfma_f32_16x16x32_bf16 v[136:139], v[224:227], v[160:163], 0
    ds_read_b64_tr_b16 v[184:185], v5 offset:17152
    s_waitcnt vmcnt(0)
    v_bitop3_b32 v14, v192, v196, v14 bitop3:0x96
    v_mfma_f32_16x16x32_bf16 v[140:143], v[228:231], v[160:163], 0
    ds_read_b64_tr_b16 v[186:187], v5 offset:18176
    v_bitop3_b32 v26, v193, v197, v201 bitop3:0x96
    v_mfma_f32_16x16x32_bf16 v[64:67], v[152:155], v[216:219], v[64:67]
    v_cvt_pk_bf16_f32 v156, v144, v145
    v_cvt_pk_bf16_f32 v157, v146, v147
    v_mfma_f32_16x16x32_bf16 v[136:139], v[232:235], v[164:167], v[136:139]
    ds_read_b64_tr_b16 v[188:189], v5 offset:25344
    v_bitop3_b32 v27, v194, v198, v202 bitop3:0x96
    v_mfma_f32_16x16x32_bf16 v[140:143], v[236:239], v[164:167], v[140:143]
    ds_read_b64_tr_b16 v[190:191], v5 offset:26368
    s_waitcnt lgkmcnt(8)
    v_mfma_f32_16x16x32_bf16 v[136:139], v[240:243], v[168:171], v[136:139]
    ds_read_b64_tr_b16 v[160:161], v4 offset:0
    v_bitop3_b32 v9, v195, v199, v203 bitop3:0x96
    v_mfma_f32_16x16x32_bf16 v[140:143], v[244:247], v[168:171], v[140:143]
    ds_read_b64_tr_b16 v[162:163], v4 offset:1024
    v_bitop3_b32 v14, v200, v204, v14 bitop3:0x96
    v_mfma_f32_16x16x32_bf16 v[80:83], v[152:155], v[220:223], v[80:83]
    v_cvt_pk_bf16_f32 v158, v148, v149
    v_cvt_pk_bf16_f32 v159, v150, v151
    v_mfma_f32_16x16x32_bf16 v[136:139], v[248:251], v[172:175], v[136:139]
    ds_read_b64_tr_b16 v[164:165], v4 offset:8192
    v_xor_b32 v26, v205, v26
    v_mfma_f32_16x16x32_bf16 v[140:143], v[252:255], v[172:175], v[140:143]
    ds_read_b64_tr_b16 v[166:167], v4 offset:9216
    s_waitcnt lgkmcnt(8)
    v_mfma_f32_16x16x32_bf16 v[144:147], v[224:227], v[176:179], 0
    ds_read_b64_tr_b16 v[168:169], v4 offset:16384
    v_xor_b32 v27, v206, v27
    v_mfma_f32_16x16x32_bf16 v[148:151], v[228:231], v[176:179], 0
    ds_read_b64_tr_b16 v[170:171], v4 offset:17408
    v_xor_b32 v9, v207, v9
    v_mfma_f32_16x16x32_bf16 v[68:71], v[156:159], v[216:219], v[68:71]
    v_cvt_pk_bf16_f32 v152, v136, v137
    v_cvt_pk_bf16_f32 v153, v138, v139
    v_mfma_f32_16x16x32_bf16 v[144:147], v[232:235], v[180:183], v[144:147]
    ds_read_b64_tr_b16 v[172:173], v4 offset:24576
    v_alignbit_b32 v26, v26, v26, 5
    v_mfma_f32_16x16x32_bf16 v[148:151], v[236:239], v[180:183], v[148:151]
    ds_read_b64_tr_b16 v[174:175], v4 offset:25600
    s_waitcnt lgkmcnt(8)
    v_mfma_f32_16x16x32_bf16 v[144:147], v[240:243], v[184:187], v[144:147]
    ds_read_b64_tr_b16 v[176:177], v5 offset:0
    v_alignbit_b32 v27, v27, v27, 10
    v_mfma_f32_16x16x32_bf16 v[148:151], v[244:247], v[184:187], v[148:151]
    ds_read_b64_tr_b16 v[178:179], v5 offset:1024
    v_alignbit_b32 v9, v9, v9, 15
    v_mfma_f32_16x16x32_bf16 v[84:87], v[156:159], v[220:223], v[84:87]
    v_cvt_pk_bf16_f32 v154, v140, v141
    v_cvt_pk_bf16_f32 v155, v142, v143
    v_mfma_f32_16x16x32_bf16 v[144:147], v[248:251], v[188:191], v[144:147]
    ds_read_b64_tr_b16 v[180:181], v5 offset:8192
    v_bitop3_b32 v14, v26, v27, v14 bitop3:0x96
    v_mfma_f32_16x16x32_bf16 v[148:151], v[252:255], v[188:191], v[148:151]
    ds_read_b64_tr_b16 v[182:183], v5 offset:9216
    s_waitcnt lgkmcnt(8)
    v_mfma_f32_16x16x32_bf16 v[136:139], v[224:227], v[160:163], 0
    ds_read_b64_tr_b16 v[184:185], v5 offset:16384
    v_xor_b32 v14, v9, v14
    v_mfma_f32_16x16x32_bf16 v[140:143], v[228:231], v[160:163], 0
    ds_read_b64_tr_b16 v[186:187], v5 offset:17408
    v_cmp_ne_u32 vcc, s53, v14
    s_cbranch_vccnz L_p_spin2
L_p_ok2:
    v_mfma_f32_16x16x32_bf16 v[72:75], v[152:155], v[216:219], v[72:75]
    v_cvt_pk_bf16_f32 v156, v144, v145
    v_cvt_pk_bf16_f32 v157, v146, v147
    v_mfma_f32_16x16x32_bf16 v[136:139], v[232:235], v[164:167], v[136:139]
    ds_read_b64_tr_b16 v[188:189], v5 offset:24576
    v_mfma_f32_16x16x32_bf16 v[140:143], v[236:239], v[164:167], v[140:143]
    ds_read_b64_tr_b16 v[190:191], v5 offset:25600
    s_waitcnt lgkmcnt(8)
    v_mfma_f32_16x16x32_bf16 v[136:139], v[240:243], v[168:171], v[136:139]
    ds_read_b64_tr_b16 v[160:161], v4 offset:256
    v_mfma_f32_16x16x32_bf16 v[140:143], v[244:247], v[168:171], v[140:143]
    ds_read_b64_tr_b16 v[162:163], v4 offset:1280
    v_mfma_f32_16x16x32_bf16 v[88:91], v[152:155], v[220:223], v[88:91]
    v_cvt_pk_bf16_f32 v158, v148, v149
    v_cvt_pk_bf16_f32 v159, v150, v151
    v_mfma_f32_16x16x32_bf16 v[136:139], v[248:251], v[172:175], v[136:139]
    ds_read_b64_tr_b16 v[164:165], v4 offset:8448
    v_mfma_f32_16x16x32_bf16 v[140:143], v[252:255], v[172:175], v[140:143]
    ds_read_b64_tr_b16 v[166:167], v4 offset:9472
    s_waitcnt lgkmcnt(8)
    v_mfma_f32_16x16x32_bf16 v[144:147], v[224:227], v[176:179], 0
    ds_read_b64_tr_b16 v[168:169], v4 offset:16640
    v_mfma_f32_16x16x32_bf16 v[148:151], v[228:231], v[176:179], 0
    ds_read_b64_tr_b16 v[170:171], v4 offset:17664
    v_mfma_f32_16x16x32_bf16 v[76:79], v[156:159], v[216:219], v[76:79]
    v_cvt_pk_bf16_f32 v152, v136, v137
    v_cvt_pk_bf16_f32 v153, v138, v139
    v_mfma_f32_16x16x32_bf16 v[144:147], v[232:235], v[180:183], v[144:147]
    ds_read_b32 v21, v22
    ds_read_b64_tr_b16 v[172:173], v4 offset:24832
    v_mfma_f32_16x16x32_bf16 v[148:151], v[236:239], v[180:183], v[148:151]
    ds_read_b64_tr_b16 v[174:175], v4 offset:25856
    s_waitcnt lgkmcnt(9)
    v_mfma_f32_16x16x32_bf16 v[144:147], v[240:243], v[184:187], v[144:147]
    ds_read_b64_tr_b16 v[176:177], v5 offset:256
    v_mfma_f32_16x16x32_bf16 v[148:151], v[244:247], v[184:187], v[148:151]
    ds_read_b64_tr_b16 v[178:179], v5 offset:1280
    v_mfma_f32_16x16x32_bf16 v[92:95], v[156:159], v[220:223], v[92:95]
    v_cvt_pk_bf16_f32 v154, v140, v141
    v_cvt_pk_bf16_f32 v155, v142, v143
    v_mfma_f32_16x16x32_bf16 v[144:147], v[248:251], v[188:191], v[144:147]
    ds_read_b64_tr_b16 v[180:181], v5 offset:8448
    v_mfma_f32_16x16x32_bf16 v[148:151], v[252:255], v[188:191], v[148:151]
    ds_read_b64_tr_b16 v[182:183], v5 offset:9472
    s_waitcnt lgkmcnt(9)
    v_mfma_f32_16x16x32_bf16 v[136:139], v[224:227], v[160:163], 0
    ds_read_b64_tr_b16 v[184:185], v5 offset:16640
    v_mfma_f32_16x16x32_bf16 v[140:143], v[228:231], v[160:163], 0
    ds_read_b64_tr_b16 v[186:187], v5 offset:17664
    v_mfma_f32_16x16x32_bf16 v[32:35], v[152:155], v[216:219], v[32:35]
    v_cvt_pk_bf16_f32 v156, v144, v145
    v_cvt_pk_bf16_f32 v157, v146, v147
    v_mfma_f32_16x16x32_bf16 v[136:139], v[232:235], v[164:167], v[136:139]
    s_waitcnt lgkmcnt(8)
    v_cmp_gt_u32 vcc, 28, v21
    ds_read_b64_tr_b16 v[188:189], v5 offset:24832
    v_mfma_f32_16x16x32_bf16 v[140:143], v[236:239], v[164:167], v[140:143]
    s_cbranch_vccnz L_cs51
L_co51:
    ds_read_b64_tr_b16 v[190:191], v5 offset:25856
    s_waitcnt lgkmcnt(8)
    v_mfma_f32_16x16x32_bf16 v[136:139], v[240:243], v[168:171], v[136:139]
    ds_read_b64_tr_b16 v[160:161], v18 offset:4096
    v_mfma_f32_16x16x32_bf16 v[140:143], v[244:247], v[168:171], v[140:143]
    ds_read_b32 v21, v22
    ds_read_b64_tr_b16 v[162:163], v18 offset:4352
    v_mfma_f32_16x16x32_bf16 v[48:51], v[152:155], v[220:223], v[48:51]
    v_cvt_pk_bf16_f32 v158, v148, v149
    v_cvt_pk_bf16_f32 v159, v150, v151
    v_mfma_f32_16x16x32_bf16 v[136:139], v[248:251], v[172:175], v[136:139]
    ds_read_b64_tr_b16 v[164:165], v18 offset:5120
    v_mfma_f32_16x16x32_bf16 v[140:143], v[252:255], v[172:175], v[140:143]
    ds_read_b64_tr_b16 v[166:167], v18 offset:5376
    s_waitcnt lgkmcnt(9)
    v_mfma_f32_16x16x32_bf16 v[144:147], v[224:227], v[176:179], 0
    s_waitcnt lgkmcnt(3)
    v_cmp_gt_u32 vcc, 29, v21
    ds_read_b64_tr_b16 v[168:169], v18 offset:6144
    v_mfma_f32_16x16x32_bf16 v[148:151], v[228:231], v[176:179], 0
    s_cbranch_vccnz L_cs52
L_co52:
    ds_read_b64_tr_b16 v[170:171], v18 offset:6400
    v_mfma_f32_16x16x32_bf16 v[36:39], v[156:159], v[216:219], v[36:39]
    v_cvt_pk_bf16_f32 v152, v136, v137
    v_cvt_pk_bf16_f32 v153, v138, v139
    v_mfma_f32_16x16x32_bf16 v[144:147], v[232:235], v[180:183], v[144:147]
    ds_read_b128 v[104:107], v24 offset:0
    ds_read_b128 v[108:111], v24 offset:2048
    ds_read_b64_tr_b16 v[172:173], v18 offset:7168
    v_mfma_f32_16x16x32_bf16 v[148:151], v[236:239], v[180:183], v[148:151]
    ds_read_b128 v[112:115], v25 offset:0
    ds_read_b128 v[116:119], v25 offset:2048
    ds_read_b64_tr_b16 v[174:175], v18 offset:7424
    v_mfma_f32_16x16x32_bf16 v[144:147], v[240:243], v[184:187], v[144:147]
    ds_read_b128 v[120:123], v24 offset:16384
    ds_read_b128 v[124:127], v24 offset:18432
    ds_read_b64_tr_b16 v[176:177], v4 offset:33280
    v_mfma_f32_16x16x32_bf16 v[148:151], v[244:247], v[184:187], v[148:151]
    ds_read_b128 v[128:131], v25 offset:16384
    ds_read_b128 v[132:135], v25 offset:18432
    ds_read_b64_tr_b16 v[178:179], v4 offset:34304
    v_mfma_f32_16x16x32_bf16 v[52:55], v[156:159], v[220:223], v[52:55]
    v_cvt_pk_bf16_f32 v154, v140, v141
    v_cvt_pk_bf16_f32 v155, v142, v143
    v_mfma_f32_16x16x32_bf16 v[144:147], v[248:251], v[188:191], v[144:147]
    ds_read_b64_tr_b16 v[180:181], v4 offset:41472
    v_mfma_f32_16x16x32_bf16 v[148:151], v[252:255], v[188:191], v[148:151]
    ds_read_b64_tr_b16 v[182:183], v4 offset:42496
    s_waitcnt lgkmcnt(12)
    v_mfma_f32_16x16x32_bf16 v[136:139], v[104:107], v[160:163], 0
    ds_read_b64_tr_b16 v[184:185], v4 offset:49664
    v_mfma_f32_16x16x32_bf16 v[140:143], v[108:111], v[160:163], 0
    ds_read_b64_tr_b16 v[186:187], v4 offset:50688
    v_mfma_f32_16x16x32_bf16 v[40:43], v[152:155], v[216:219], v[40:43]
    v_cvt_pk_bf16_f32 v156, v144, v145
    v_cvt_pk_bf16_f32 v157, v146, v147
    s_waitcnt lgkmcnt(11)
    v_mfma_f32_16x16x32_bf16 v[136:139], v[112:115], v[164:167], v[136:139]
    s_waitcnt lgkmcnt(5)
    s_barrier
    ds_read_b64_tr_b16 v[188:189], v4 offset:57856
    v_mfma_f32_16x16x32_bf16 v[140:143], v[116:119], v[164:167], v[140:143]
    ds_read_b64_tr_b16 v[190:191], v4 offset:58880
    v_mfma_f32_16x16x32_bf16 v[136:139], v[120:123], v[168:171], v[136:139]
    ds_read_b64_tr_b16 v[160:161], v5 offset:33280
    v_mfma_f32_16x16x32_bf16 v[140:143], v[124:127], v[168:171], v[140:143]
    ds_read_b64_tr_b16 v[162:163], v5 offset:34304
    v_mfma_f32_16x16x32_bf16 v[56:59], v[152:155], v[220:223], v[56:59]
    v_cvt_pk_bf16_f32 v158, v148, v149
    v_cvt_pk_bf16_f32 v159, v150, v151
    v_mfma_f32_16x16x32_bf16 v[136:139], v[128:131], v[172:175], v[136:139]
    ds_read_b64_tr_b16 v[164:165], v5 offset:41472
    v_mfma_f32_16x16x32_bf16 v[140:143], v[132:135], v[172:175], v[140:143]
    ds_read_b64_tr_b16 v[166:167], v5 offset:42496
    s_waitcnt lgkmcnt(8)
    v_mfma_f32_16x16x32_bf16 v[144:147], v[104:107], v[176:179], 0
    ds_read_b64_tr_b16 v[168:169], v5 offset:49664
    v_mfma_f32_16x16x32_bf16 v[148:151], v[108:111], v[176:179], 0
    ds_read_b64_tr_b16 v[170:171], v5 offset:50688
    v_mfma_f32_16x16x32_bf16 v[44:47], v[156:159], v[216:219], v[44:47]
    v_cvt_pk_bf16_f32 v152, v136, v137
    v_cvt_pk_bf16_f32 v153, v138, v139
    v_mfma_f32_16x16x32_bf16 v[144:147], v[112:115], v[180:183], v[144:147]
    ds_read_b64_tr_b16 v[172:173], v5 offset:57856
    v_mfma_f32_16x16x32_bf16 v[148:151], v[116:119], v[180:183], v[148:151]
    ds_read_b64_tr_b16 v[174:175], v5 offset:58880
    s_waitcnt lgkmcnt(8)
    v_mfma_f32_16x16x32_bf16 v[144:147], v[120:123], v[184:187], v[144:147]
    ds_read_b64_tr_b16 v[176:177], v4 offset:33536
    v_mfma_f32_16x16x32_bf16 v[148:151], v[124:127], v[184:187], v[148:151]
    ds_read_b64_tr_b16 v[178:179], v4 offset:34560
    v_mfma_f32_16x16x32_bf16 v[60:63], v[156:159], v[220:223], v[60:63]
    v_cvt_pk_bf16_f32 v154, v140, v141
    v_cvt_pk_bf16_f32 v155, v142, v143
    v_mfma_f32_16x16x32_bf16 v[144:147], v[128:131], v[188:191], v[144:147]
    ds_read_b64_tr_b16 v[180:181], v4 offset:41728
    v_mfma_f32_16x16x32_bf16 v[148:151], v[132:135], v[188:191], v[148:151]
    ds_read_b64_tr_b16 v[182:183], v4 offset:42752
    s_waitcnt lgkmcnt(8)
    v_mfma_f32_16x16x32_bf16 v[136:139], v[104:107], v[160:163], 0
    ds_read_b64_tr_b16 v[184:185], v4 offset:49920
    v_mfma_f32_16x16x32_bf16 v[140:143], v[108:111], v[160:163], 0
    ds_read_b64_tr_b16 v[186:187], v4 offset:50944
    v_mfma_f32_16x16x32_bf16 v[96:99], v[152:155], v[192:195], v[96:99]
    v_cvt_pk_bf16_f32 v156, v144, v145
    v_cvt_pk_bf16_f32 v157, v146, v147
    v_mfma_f32_16x16x32_bf16 v[136:139], v[112:115], v[164:167], v[136:139]
    ds_read_b64_tr_b16 v[188:189], v4 offset:58112
    v_mfma_f32_16x16x32_bf16 v[140:143], v[116:119], v[164:167], v[140:143]
    ds_read_b64_tr_b16 v[190:191], v4 offset:59136
    s_waitcnt lgkmcnt(8)
    v_mfma_f32_16x16x32_bf16 v[136:139], v[120:123], v[168:171], v[136:139]
    ds_read_b64_tr_b16 v[160:161], v5 offset:33536
    v_mfma_f32_16x16x32_bf16 v[140:143], v[124:127], v[168:171], v[140:143]
    ds_read_b64_tr_b16 v[162:163], v5 offset:34560
    v_mfma_f32_16x16x32_bf16 v[100:103], v[152:155], v[196:199], v[100:103]
    v_cvt_pk_bf16_f32 v158, v148, v149
    v_cvt_pk_bf16_f32 v159, v150, v151
    v_mfma_f32_16x16x32_bf16 v[136:139], v[128:131], v[172:175], v[136:139]
    ds_read_b64_tr_b16 v[164:165], v5 offset:41728
    v_mfma_f32_16x16x32_bf16 v[140:143], v[132:135], v[172:175], v[140:143]
    ds_read_b64_tr_b16 v[166:167], v5 offset:42752
    s_waitcnt lgkmcnt(8)
    v_mfma_f32_16x16x32_bf16 v[144:147], v[104:107], v[176:179], 0
    ds_read_b64_tr_b16 v[168:169], v5 offset:49920
    v_mfma_f32_16x16x32_bf16 v[148:151], v[108:111], v[176:179], 0
    ds_read_b64_tr_b16 v[170:171], v5 offset:50944
    v_mfma_f32_16x16x32_bf16 v[64:67], v[156:159], v[192:195], v[64:67]
    v_cvt_pk_bf16_f32 v152, v136, v137
    v_cvt_pk_bf16_f32 v153, v138, v139
    v_mfma_f32_16x16x32_bf16 v[144:147], v[112:115], v[180:183], v[144:147]
    ds_read_b64_tr_b16 v[172:173], v5 offset:58112
    v_mfma_f32_16x16x32_bf16 v[148:151], v[116:119], v[180:183], v[148:151]
    ds_read_b64_tr_b16 v[174:175], v5 offset:59136
    s_waitcnt lgkmcnt(8)
    v_mfma_f32_16x16x32_bf16 v[144:147], v[120:123], v[184:187], v[144:147]
    ds_read_b64_tr_b16 v[176:177], v4 offset:32768
    v_mfma_f32_16x16x32_bf16 v[148:151], v[124:127], v[184:187], v[148:151]
    ds_read_b64_tr_b16 v[178:179], v4 offset:33792
    v_mfma_f32_16x16x32_bf16 v[80:83], v[156:159], v[196:199], v[80:83]
    v_cvt_pk_bf16_f32 v154, v140, v141
    v_cvt_pk_bf16_f32 v155, v142, v143
    v_mfma_f32_16x16x32_bf16 v[144:147], v[128:131], v[188:191], v[144:147]
    ds_read_b64_tr_b16 v[180:181], v4 offset:40960
    v_mfma_f32_16x16x32_bf16 v[148:151], v[132:135], v[188:191], v[148:151]
    ds_read_b64_tr_b16 v[182:183], v4 offset:41984
    s_waitcnt lgkmcnt(8)
    v_mfma_f32_16x16x32_bf16 v[136:139], v[104:107], v[160:163], 0
    ds_read_b64_tr_b16 v[184:185], v4 offset:49152
    v_mfma_f32_16x16x32_bf16 v[140:143], v[108:111], v[160:163], 0
    ds_read_b64_tr_b16 v[186:187], v4 offset:50176
    v_mfma_f32_16x16x32_bf16 v[68:71], v[152:155], v[192:195], v[68:71]
    v_cvt_pk_bf16_f32 v156, v144, v145
    v_cvt_pk_bf16_f32 v157, v146, v147
    v_mfma_f32_16x16x32_bf16 v[136:139], v[112:115], v[164:167], v[136:139]
    ds_read_b64_tr_b16 v[188:189], v4 offset:57344
    v_mfma_f32_16x16x32_bf16 v[140:143], v[116:119], v[164:167], v[140:143]
    ds_read_b64_tr_b16 v[190:191], v4 offset:58368
    s_waitcnt lgkmcnt(8)
    v_mfma_f32_16x16x32_bf16 v[136:139], v[120:123], v[168:171], v[136:139]
    ds_read_b64_tr_b16 v[160:161], v5 offset:32768
    v_mfma_f32_16x16x32_bf16 v[140:143], v[124:127], v[168:171], v[140:143]
    ds_read_b64_tr_b16 v[162:163], v5 offset:33792
    v_mfma_f32_16x16x32_bf16 v[84:87], v[152:155], v[196:199], v[84:87]
    v_cvt_pk_bf16_f32 v158, v148, v149
    v_cvt_pk_bf16_f32 v159, v150, v151
    v_mfma_f32_16x16x32_bf16 v[136:139], v[128:131], v[172:175], v[136:139]
    ds_read_b64_tr_b16 v[164:165], v5 offset:40960
    v_mfma_f32_16x16x32_bf16 v[140:143], v[132:135], v[172:175], v[140:143]
    ds_read_b64_tr_b16 v[166:167], v5 offset:41984
    s_waitcnt lgkmcnt(8)
    v_mfma_f32_16x16x32_bf16 v[144:147], v[104:107], v[176:179], 0
    ds_read_b64_tr_b16 v[168:169], v5 offset:49152
    v_mfma_f32_16x16x32_bf16 v[148:151], v[108:111], v[176:179], 0
    ds_read_b64_tr_b16 v[170:171], v5 offset:50176
    v_mfma_f32_16x16x32_bf16 v[72:75], v[156:159], v[192:195], v[72:75]
    v_cvt_pk_bf16_f32 v152, v136, v137
    v_cvt_pk_bf16_f32 v153, v138, v139
    v_mfma_f32_16x16x32_bf16 v[144:147], v[112:115], v[180:183], v[144:147]
    ds_read_b64_tr_b16 v[172:173], v5 offset:57344
    v_mfma_f32_16x16x32_bf16 v[148:151], v[116:119], v[180:183], v[148:151]
    ds_read_b64_tr_b16 v[174:175], v5 offset:58368
    s_waitcnt lgkmcnt(8)
    v_mfma_f32_16x16x32_bf16 v[144:147], v[120:123], v[184:187], v[144:147]
    ds_read_b64_tr_b16 v[176:177], v4 offset:33024
    v_mfma_f32_16x16x32_bf16 v[148:151], v[124:127], v[184:187], v[148:151]
    ds_read_b64_tr_b16 v[178:179], v4 offset:34048
    v_mfma_f32_16x16x32_bf16 v[88:91], v[156:159], v[196:199], v[88:91]
    v_cvt_pk_bf16_f32 v154, v140, v141
    v_cvt_pk_bf16_f32 v155, v142, v143
    v_mfma_f32_16x16x32_bf16 v[144:147], v[128:131], v[188:191], v[144:147]
    ds_read_b64_tr_b16 v[180:181], v4 offset:41216
    v_mfma_f32_16x16x32_bf16 v[148:151], v[132:135], v[188:191], v[148:151]
    ds_read_b64_tr_b16 v[182:183], v4 offset:42240
    s_waitcnt lgkmcnt(8)
    v_mfma_f32_16x16x32_bf16 v[136:139], v[104:107], v[160:163], 0
    ds_read_b64_tr_b16 v[184:185], v4 offset:49408
    v_mfma_f32_16x16x32_bf16 v[140:143], v[108:111], v[160:163], 0
    ds_read_b64_tr_b16 v[186:187], v4 offset:50432
    v_mfma_f32_16x16x32_bf16 v[76:79], v[152:155], v[192:195], v[76:79]
    v_cvt_pk_bf16_f32 v156, v144, v145
    v_cvt_pk_bf16_f32 v157, v146, v147
    v_mfma_f32_16x16x32_bf16 v[136:139], v[112:115], v[164:167], v[136:139]
    ds_read_b32 v21, v22
    ds_read_b64_tr_b16 v[188:189], v4 offset:57600
    v_mfma_f32_16x16x32_bf16 v[140:143], v[116:119], v[164:167], v[140:143]
    ds_read_b64_tr_b16 v[190:191], v4 offset:58624
    s_waitcnt lgkmcnt(9)
    v_mfma_f32_16x16x32_bf16 v[136:139], v[120:123], v[168:171], v[136:139]
    ds_read_b64_tr_b16 v[160:161], v5 offset:33024
    v_mfma_f32_16x16x32_bf16 v[140:143], v[124:127], v[168:171], v[140:143]
    ds_read_b64_tr_b16 v[162:163], v5 offset:34048
    v_mfma_f32_16x16x32_bf16 v[92:95], v[152:155], v[196:199], v[92:95]
    v_cvt_pk_bf16_f32 v158, v148, v149
    v_cvt_pk_bf16_f32 v159, v150, v151
    v_mfma_f32_16x16x32_bf16 v[136:139], v[128:131], v[172:175], v[136:139]
    ds_read_b64_tr_b16 v[164:165], v5 offset:41216
    v_mfma_f32_16x16x32_bf16 v[140:143], v[132:135], v[172:175], v[140:143]
    ds_read_b64_tr_b16 v[166:167], v5 offset:42240
    s_waitcnt lgkmcnt(9)
    v_mfma_f32_16x16x32_bf16 v[144:147], v[104:107], v[176:179], 0
    ds_read_b64_tr_b16 v[168:169], v5 offset:49408
    buffer_load_dwordx4 v[208:211], v10, s[56:59], s79 offen offset:0 sc1
    v_mfma_f32_16x16x32_bf16 v[148:151], v[108:111], v[176:179], 0
    ds_read_b64_tr_b16 v[170:171], v5 offset:50432
    buffer_load_dwordx4 v[212:215], v10, s[56:59], s79 offen offset:1024 sc1
    v_mfma_f32_16x16x32_bf16 v[32:35], v[156:159], v[192:195], v[32:35]
    v_cvt_pk_bf16_f32 v152, v136, v137
    v_cvt_pk_bf16_f32 v153, v138, v139
    v_mfma_f32_16x16x32_bf16 v[144:147], v[112:115], v[180:183], v[144:147]
    s_waitcnt lgkmcnt(8)
    v_cmp_gt_u32 vcc, 30, v21
    ds_read_b64_tr_b16 v[172:173], v5 offset:57600
    v_mfma_f32_16x16x32_bf16 v[148:151], v[116:119], v[180:183], v[148:151]
    s_cbranch_vccnz L_cs53
L_co53:
    ds_read_b64_tr_b16 v[174:175], v5 offset:58624
    s_waitcnt lgkmcnt(8)
    v_mfma_f32_16x16x32_bf16 v[144:147], v[120:123], v[184:187], v[144:147]
    ds_read_b64_tr_b16 v[176:177], v18 offset:8192
    buffer_load_dwordx4 v[216:219], v10, s[56:59], s79 offen offset:2048 sc1
    v_mfma_f32_16x16x32_bf16 v[148:151], v[124:127], v[184:187], v[148:151]
    ds_read_b32 v21, v22
    ds_read_b64_tr_b16 v[178:179], v18 offset:8448
    v_mfma_f32_16x16x32_bf16 v[48:51], v[156:159], v[196:199], v[48:51]
    v_cvt_pk_bf16_f32 v154, v140, v141
    v_cvt_pk_bf16_f32 v155, v142, v143
    v_mfma_f32_16x16x32_bf16 v[144:147], v[128:131], v[188:191], v[144:147]
    ds_read_b64_tr_b16 v[180:181], v18 offset:9216
    buffer_load_dwordx4 v[220:223], v10, s[56:59], s79 offen offset:3072 sc1
    v_mfma_f32_16x16x32_bf16 v[148:151], v[132:135], v[188:191], v[148:151]
    ds_read_b64_tr_b16 v[182:183], v18 offset:9472
    s_waitcnt lgkmcnt(9)
    v_mfma_f32_16x16x32_bf16 v[136:139], v[104:107], v[160:163], 0
    s_waitcnt lgkmcnt(3)
    v_cmp_gt_u32 vcc, 31, v21
    ds_read_b64_tr_b16 v[184:185], v18 offset:10240
    v_mfma_f32_16x16x32_bf16 v[140:143], v[108:111], v[160:163], 0
    s_cbranch_vccnz L_cs54
L_co54:
    ds_read_b64_tr_b16 v[186:187], v18 offset:10496
    v_mfma_f32_16x16x32_bf16 v[36:39], v[152:155], v[192:195], v[36:39]
    v_cvt_pk_bf16_f32 v156, v144, v145
    v_cvt_pk_bf16_f32 v157, v146, v147
    v_mfma_f32_16x16x32_bf16 v[136:139], v[112:115], v[164:167], v[136:139]
    ds_read_b128 v[224:227], v24 offset:32768
    ds_read_b128 v[228:231], v24 offset:34816
    ds_read_b64_tr_b16 v[188:189], v18 offset:11264
    v_mfma_f32_16x16x32_bf16 v[140:143], v[116:119], v[164:167], v[140:143]
    ds_read_b128 v[232:235], v25 offset:32768
    ds_read_b128 v[236:239], v25 offset:34816
    ds_read_b64_tr_b16 v[190:191], v18 offset:11520
    v_mfma_f32_16x16x32_bf16 v[136:139], v[120:123], v[168:171], v[136:139]
    ds_read_b128 v[240:243], v24 offset:0
    ds_read_b128 v[244:247], v24 offset:2048
    ds_read_b64_tr_b16 v[160:161], v16 offset:512
    v_mfma_f32_16x16x32_bf16 v[140:143], v[124:127], v[168:171], v[140:143]
    ds_read_b128 v[248:251], v25 offset:0
    ds_read_b128 v[252:255], v25 offset:2048
    ds_read_b64_tr_b16 v[162:163], v16 offset:1536
    v_mfma_f32_16x16x32_bf16 v[52:55], v[152:155], v[196:199], v[52:55]
    v_cvt_pk_bf16_f32 v158, v148, v149
    v_cvt_pk_bf16_f32 v159, v150, v151
    v_mfma_f32_16x16x32_bf16 v[136:139], v[128:131], v[172:175], v[136:139]
    ds_read_b64_tr_b16 v[164:165], v16 offset:8704
    buffer_load_dword v14, v11, s[56:59], s79 offen sc1
    v_mfma_f32_16x16x32_bf16 v[140:143], v[132:135], v[172:175], v[140:143]
    ds_read_b64_tr_b16 v[166:167], v16 offset:9728
    s_waitcnt lgkmcnt(12)
    v_mfma_f32_16x16x32_bf16 v[144:147], v[224:227], v[176:179], 0
    ds_read_b64_tr_b16 v[168:169], v16 offset:16896
    v_mfma_f32_16x16x32_bf16 v[148:151], v[228:231], v[176:179], 0
    ds_read_b64_tr_b16 v[170:171], v16 offset:17920
    v_mfma_f32_16x16x32_bf16 v[40:43], v[156:159], v[192:195], v[40:43]
    v_cvt_pk_bf16_f32 v152, v136, v137
    v_cvt_pk_bf16_f32 v153, v138, v139
    s_waitcnt lgkmcnt(11)
    v_mfma_f32_16x16x32_bf16 v[144:147], v[232:235], v[180:183], v[144:147]
    s_waitcnt lgkmcnt(5)
    s_barrier
    ds_read_b64_tr_b16 v[172:173], v16 offset:25088
    v_mfma_f32_16x16x32_bf16 v[148:151], v[236:239], v[180:183], v[148:151]
    ds_read_b64_tr_b16 v[174:175], v16 offset:26112
    v_mfma_f32_16x16x32_bf16 v[144:147], v[240:243], v[184:187], v[144:147]
    ds_read_b64_tr_b16 v[176:177], v17 offset:512
    v_mfma_f32_16x16x32_bf16 v[148:151], v[244:247], v[184:187], v[148:151]
    ds_read_b64_tr_b16 v[178:179], v17 offset:1536
    v_mfma_f32_16x16x32_bf16 v[56:59], v[156:159], v[196:199], v[56:59]
    v_cvt_pk_bf16_f32 v154, v140, v141
    v_cvt_pk_bf16_f32 v155, v142, v143
    v_mfma_f32_16x16x32_bf16 v[144:147], v[248:251], v[188:191], v[144:147]
    ds_read_b64_tr_b16 v[180:181], v17 offset:8704
    v_mfma_f32_16x16x32_bf16 v[148:151], v[252:255], v[188:191], v[148:151]
    ds_read_b64_tr_b16 v[182:183], v17 offset:9728
    s_waitcnt lgkmcnt(8)
    v_mfma_f32_16x16x32_bf16 v[136:139], v[224:227], v[160:163], 0
    ds_read_b64_tr_b16 v[184:185], v17 offset:16896
    v_mfma_f32_16x16x32_bf16 v[140:143], v[228:231], v[160:163], 0
    ds_read_b64_tr_b16 v[186:187], v17 offset:17920
    v_mfma_f32_16x16x32_bf16 v[44:47], v[152:155], v[192:195], v[44:47]
    v_cvt_pk_bf16_f32 v156, v144, v145
    v_cvt_pk_bf16_f32 v157, v146, v147
    v_mfma_f32_16x16x32_bf16 v[136:139], v[232:235], v[164:167], v[136:139]
    ds_read_b64_tr_b16 v[188:189], v17 offset:25088
    v_mfma_f32_16x16x32_bf16 v[140:143], v[236:239], v[164:167], v[140:143]
    ds_read_b64_tr_b16 v[190:191], v17 offset:26112
    s_waitcnt lgkmcnt(8)
    v_mfma_f32_16x16x32_bf16 v[136:139], v[240:243], v[168:171], v[136:139]
    ds_read_b64_tr_b16 v[160:161], v16 offset:768
    v_mfma_f32_16x16x32_bf16 v[140:143], v[244:247], v[168:171], v[140:143]
    ds_read_b64_tr_b16 v[162:163], v16 offset:1792
    v_mfma_f32_16x16x32_bf16 v[60:63], v[152:155], v[196:199], v[60:63]
    v_cvt_pk_bf16_f32 v158, v148, v149
    v_cvt_pk_bf16_f32 v159, v150, v151
    v_mfma_f32_16x16x32_bf16 v[136:139], v[248:251], v[172:175], v[136:139]
    ds_read_b64_tr_b16 v[164:165], v16 offset:8960
    v_mfma_f32_16x16x32_bf16 v[140:143], v[252:255], v[172:175], v[140:143]
    ds_read_b64_tr_b16 v[166:167], v16 offset:9984
    s_waitcnt lgkmcnt(8)
    v_mfma_f32_16x16x32_bf16 v[144:147], v[224:227], v[176:179], 0
    ds_read_b64_tr_b16 v[168:169], v16 offset:17152
    v_mfma_f32_16x16x32_bf16 v[148:151], v[228:231], v[176:179], 0
    ds_read_b64_tr_b16 v[170:171], v16 offset:18176
    v_mfma_f32_16x16x32_bf16 v[96:99], v[156:159], v[200:203], v[96:99]
    v_cvt_pk_bf16_f32 v152, v136, v137
    v_cvt_pk_bf16_f32 v153, v138, v139
    v_mfma_f32_16x16x32_bf16 v[144:147], v[232:235], v[180:183], v[144:147]
    ds_read_b64_tr_b16 v[172:173], v16 offset:25344
    v_mfma_f32_16x16x32_bf16 v[148:151], v[236:239], v[180:183], v[148:151]
    ds_read_b64_tr_b16 v[174:175], v16 offset:26368
    s_waitcnt lgkmcnt(8)
    v_mfma_f32_16x16x32_bf16 v[144:147], v[240:243], v[184:187], v[144:147]
    ds_read_b64_tr_b16 v[176:177], v17 offset:768
    v_mfma_f32_16x16x32_bf16 v[148:151], v[244:247], v[184:187], v[148:151]
    ds_read_b64_tr_b16 v[178:179], v17 offset:1792
    v_mfma_f32_16x16x32_bf16 v[100:103], v[156:159], v[204:207], v[100:103]
    v_cvt_pk_bf16_f32 v154, v140, v141
    v_cvt_pk_bf16_f32 v155, v142, v143
    v_mfma_f32_16x16x32_bf16 v[144:147], v[248:251], v[188:191], v[144:147]
    ds_read_b64_tr_b16 v[180:181], v17 offset:8960
    v_mfma_f32_16x16x32_bf16 v[148:151], v[252:255], v[188:191], v[148:151]
    ds_read_b64_tr_b16 v[182:183], v17 offset:9984
    s_waitcnt lgkmcnt(8)
    v_mfma_f32_16x16x32_bf16 v[136:139], v[224:227], v[160:163], 0
    ds_read_b64_tr_b16 v[184:185], v17 offset:17152
    s_waitcnt vmcnt(0)
    v_bitop3_b32 v14, v208, v212, v14 bitop3:0x96
    v_mfma_f32_16x16x32_bf16 v[140:143], v[228:231], v[160:163], 0
    ds_read_b64_tr_b16 v[186:187], v17 offset:18176
    v_bitop3_b32 v26, v209, v213, v217 bitop3:0x96
    v_mfma_f32_16x16x32_bf16 v[64:67], v[152:155], v[200:203], v[64:67]
    v_cvt_pk_bf16_f32 v156, v144, v145
    v_cvt_pk_bf16_f32 v157, v146, v147
    v_mfma_f32_16x16x32_bf16 v[136:139], v[232:235], v[164:167], v[136:139]
    ds_read_b64_tr_b16 v[188:189], v17 offset:25344
    v_bitop3_b32 v27, v210, v214, v218 bitop3:0x96
    v_mfma_f32_16x16x32_bf16 v[140:143], v[236:239], v[164:167], v[140:143]
    ds_read_b64_tr_b16 v[190:191], v17 offset:26368
    s_waitcnt lgkmcnt(8)
    v_mfma_f32_16x16x32_bf16 v[136:139], v[240:243], v[168:171], v[136:139]
    ds_read_b64_tr_b16 v[160:161], v16 offset:0
    v_bitop3_b32 v9, v211, v215, v219 bitop3:0x96
    v_mfma_f32_16x16x32_bf16 v[140:143], v[244:247], v[168:171], v[140:143]
    ds_read_b64_tr_b16 v[162:163], v16 offset:1024
    v_bitop3_b32 v14, v216, v220, v14 bitop3:0x96
    v_mfma_f32_16x16x32_bf16 v[80:83], v[152:155], v[204:207], v[80:83]
    v_cvt_pk_bf16_f32 v158, v148, v149
    v_cvt_pk_bf16_f32 v159, v150, v151
    v_mfma_f32_16x16x32_bf16 v[136:139], v[248:251], v[172:175], v[136:139]
    ds_read_b64_tr_b16 v[164:165], v16 offset:8192
    v_xor_b32 v26, v221, v26
    v_mfma_f32_16x16x32_bf16 v[140:143], v[252:255], v[172:175], v[140:143]
    ds_read_b64_tr_b16 v[166:167], v16 offset:9216
    s_waitcnt lgkmcnt(8)
    v_mfma_f32_16x16x32_bf16 v[144:147], v[224:227], v[176:179], 0
    ds_read_b64_tr_b16 v[168:169], v16 offset:16384
    v_xor_b32 v27, v222, v27
    v_mfma_f32_16x16x32_bf16 v[148:151], v[228:231], v[176:179], 0
    ds_read_b64_tr_b16 v[170:171], v16 offset:17408
    v_xor_b32 v9, v223, v9
    v_mfma_f32_16x16x32_bf16 v[68:71], v[156:159], v[200:203], v[68:71]
    v_cvt_pk_bf16_f32 v152, v136, v137
    v_cvt_pk_bf16_f32 v153, v138, v139
    v_mfma_f32_16x16x32_bf16 v[144:147], v[232:235], v[180:183], v[144:147]
    ds_read_b32 v21, v22
    ds_read_b64_tr_b16 v[172:173], v16 offset:24576
    v_mfma_f32_16x16x32_bf16 v[148:151], v[236:239], v[180:183], v[148:151]
    ds_read_b64_tr_b16 v[174:175], v16 offset:25600
    s_waitcnt lgkmcnt(9)
    v_mfma_f32_16x16x32_bf16 v[144:147], v[240:243], v[184:187], v[144:147]
    ds_read_b64_tr_b16 v[176:177], v17 offset:0
    v_alignbit_b32 v26, v26, v26, 5
    v_mfma_f32_16x16x32_bf16 v[148:151], v[244:247], v[184:187], v[148:151]
    ds_read_b64_tr_b16 v[178:179], v17 offset:1024
    v_alignbit_b32 v27, v27, v27, 10
    v_mfma_f32_16x16x32_bf16 v[84:87], v[156:159], v[204:207], v[84:87]
    v_cvt_pk_bf16_f32 v154, v140, v141
    v_cvt_pk_bf16_f32 v155, v142, v143
    v_mfma_f32_16x16x32_bf16 v[144:147], v[248:251], v[188:191], v[144:147]
    ds_read_b64_tr_b16 v[180:181], v17 offset:8192
    v_alignbit_b32 v9, v9, v9, 15
    v_mfma_f32_16x16x32_bf16 v[148:151], v[252:255], v[188:191], v[148:151]
    ds_read_b64_tr_b16 v[182:183], v17 offset:9216
    s_waitcnt lgkmcnt(9)
    v_mfma_f32_16x16x32_bf16 v[136:139], v[224:227], v[160:163], 0
    ds_read_b64_tr_b16 v[184:185], v17 offset:16384
    v_bitop3_b32 v14, v26, v27, v14 bitop3:0x96
    v_mfma_f32_16x16x32_bf16 v[140:143], v[228:231], v[160:163], 0
    ds_read_b64_tr_b16 v[186:187], v17 offset:17408
    v_xor_b32 v14, v9, v14
    v_mfma_f32_16x16x32_bf16 v[72:75], v[152:155], v[200:203], v[72:75]
    v_cvt_pk_bf16_f32 v156, v144, v145
    v_cvt_pk_bf16_f32 v157, v146, v147
    v_mfma_f32_16x16x32_bf16 v[136:139], v[232:235], v[164:167], v[136:139]
    s_waitcnt lgkmcnt(8)
    v_cmp_gt_u32 vcc, 32, v21
    ds_read_b64_tr_b16 v[188:189], v17 offset:24576
    v_mfma_f32_16x16x32_bf16 v[140:143], v[236:239], v[164:167], v[140:143]
    s_cbranch_vccnz L_cs55
L_co55:
    ds_read_b64_tr_b16 v[190:191], v17 offset:25600
    s_waitcnt lgkmcnt(8)
    v_mfma_f32_16x16x32_bf16 v[136:139], v[240:243], v[168:171], v[136:139]
    ds_read_b64_tr_b16 v[160:161], v16 offset:256
    v_cmp_ne_u32 vcc, s53, v14
    s_cbranch_vccnz L_p_spin3
L_p_ok3:
    v_mfma_f32_16x16x32_bf16 v[140:143], v[244:247], v[168:171], v[140:143]
    ds_read_b32 v21, v22
    ds_read_b64_tr_b16 v[162:163], v16 offset:1280
    v_mfma_f32_16x16x32_bf16 v[88:91], v[152:155], v[204:207], v[88:91]
    v_cvt_pk_bf16_f32 v158, v148, v149
    v_cvt_pk_bf16_f32 v159, v150, v151
    v_mfma_f32_16x16x32_bf16 v[136:139], v[248:251], v[172:175], v[136:139]
    ds_read_b64_tr_b16 v[164:165], v16 offset:8448
    v_mfma_f32_16x16x32_bf16 v[140:143], v[252:255], v[172:175], v[140:143]
    ds_read_b64_tr_b16 v[166:167], v16 offset:9472
    s_waitcnt lgkmcnt(9)
    v_mfma_f32_16x16x32_bf16 v[144:147], v[224:227], v[176:179], 0
    s_waitcnt lgkmcnt(3)
    v_cmp_gt_u32 vcc, 33, v21
    ds_read_b64_tr_b16 v[168:169], v16 offset:16640
    v_mfma_f32_16x16x32_bf16 v[148:151], v[228:231], v[176:179], 0
    s_cbranch_vccnz L_cs56
L_co56:
    ds_read_b64_tr_b16 v[170:171], v16 offset:17664
    v_mfma_f32_16x16x32_bf16 v[76:79], v[156:159], v[200:203], v[76:79]
    v_cvt_pk_bf16_f32 v152, v136, v137
    v_cvt_pk_bf16_f32 v153, v138, v139
    v_mfma_f32_16x16x32_bf16 v[144:147], v[232:235], v[180:183], v[144:147]
    ds_read_b128 v[104:107], v24 offset:16384
    ds_read_b128 v[108:111], v24 offset:18432
    ds_read_b64_tr_b16 v[172:173], v16 offset:24832
    v_mfma_f32_16x16x32_bf16 v[148:151], v[236:239], v[180:183], v[148:151]
    ds_read_b128 v[112:115], v25 offset:16384
    ds_read_b128 v[116:119], v25 offset:18432
    ds_read_b64_tr_b16 v[174:175], v16 offset:25856
    v_mfma_f32_16x16x32_bf16 v[144:147], v[240:243], v[184:187], v[144:147]
    ds_read_b128 v[120:123], v24 offset:32768
    ds_read_b128 v[124:127], v24 offset:34816
    ds_read_b64_tr_b16 v[176:177], v17 offset:256
    v_mfma_f32_16x16x32_bf16 v[148:151], v[244:247], v[184:187], v[148:151]
    ds_read_b128 v[128:131], v25 offset:32768
    ds_read_b128 v[132:135], v25 offset:34816
    ds_read_b64_tr_b16 v[178:179], v17 offset:1280
    v_mfma_f32_16x16x32_bf16 v[92:95], v[156:159], v[204:207], v[92:95]
    v_cvt_pk_bf16_f32 v154, v140, v141
    v_cvt_pk_bf16_f32 v155, v142, v143
    v_mfma_f32_16x16x32_bf16 v[144:147], v[248:251], v[188:191], v[144:147]
    ds_read_b64_tr_b16 v[180:181], v17 offset:8448
    v_mfma_f32_16x16x32_bf16 v[148:151], v[252:255], v[188:191], v[148:151]
    ds_read_b64_tr_b16 v[182:183], v17 offset:9472
    s_waitcnt lgkmcnt(15)
    v_mfma_f32_16x16x32_bf16 v[136:139], v[224:227], v[160:163], 0
    ds_read_b64_tr_b16 v[184:185], v17 offset:16640
    v_mfma_f32_16x16x32_bf16 v[140:143], v[228:231], v[160:163], 0
    ds_read_b64_tr_b16 v[186:187], v17 offset:17664
    v_mfma_f32_16x16x32_bf16 v[32:35], v[152:155], v[200:203], v[32:35]
    v_cvt_pk_bf16_f32 v156, v144, v145
    v_cvt_pk_bf16_f32 v157, v146, v147
    v_mfma_f32_16x16x32_bf16 v[136:139], v[232:235], v[164:167], v[136:139]
    s_waitcnt lgkmcnt(5)
    s_barrier
    ds_read_b64_tr_b16 v[188:189], v17 offset:24832
    v_mfma_f32_16x16x32_bf16 v[140:143], v[236:239], v[164:167], v[140:143]
    ds_read_b64_tr_b16 v[190:191], v17 offset:25856
    v_mfma_f32_16x16x32_bf16 v[136:139], v[240:243], v[168:171], v[136:139]
    ds_read_b64_tr_b16 v[160:161], v18 offset:0
    v_mfma_f32_16x16x32_bf16 v[140:143], v[244:247], v[168:171], v[140:143]
    ds_read_b64_tr_b16 v[162:163], v18 offset:256
    v_mfma_f32_16x16x32_bf16 v[48:51], v[152:155], v[204:207], v[48:51]
    v_cvt_pk_bf16_f32 v158, v148, v149
    v_cvt_pk_bf16_f32 v159, v150, v151
    v_mfma_f32_16x16x32_bf16 v[136:139], v[248:251], v[172:175], v[136:139]
    ds_read_b64_tr_b16 v[164:165], v18 offset:1024
    v_mfma_f32_16x16x32_bf16 v[140:143], v[252:255], v[172:175], v[140:143]
    ds_read_b64_tr_b16 v[166:167], v18 offset:1280
    s_waitcnt lgkmcnt(8)
    v_mfma_f32_16x16x32_bf16 v[144:147], v[224:227], v[176:179], 0
    ds_read_b64_tr_b16 v[168:169], v18 offset:2048
    v_mfma_f32_16x16x32_bf16 v[148:151], v[228:231], v[176:179], 0
    ds_read_b64_tr_b16 v[170:171], v18 offset:2304
    v_mfma_f32_16x16x32_bf16 v[36:39], v[156:159], v[200:203], v[36:39]
    v_cvt_pk_bf16_f32 v152, v136, v137
    v_cvt_pk_bf16_f32 v153, v138, v139
    v_mfma_f32_16x16x32_bf16 v[144:147], v[232:235], v[180:183], v[144:147]
    ds_read_b64_tr_b16 v[172:173], v18 offset:3072
    v_mfma_f32_16x16x32_bf16 v[148:151], v[236:239], v[180:183], v[148:151]
    ds_read_b64_tr_b16 v[174:175], v18 offset:3328
    s_waitcnt lgkmcnt(8)
    v_mfma_f32_16x16x32_bf16 v[144:147], v[240:243], v[184:187], v[144:147]
    ds_read_b64_tr_b16 v[176:177], v4 offset:512
    v_mfma_f32_16x16x32_bf16 v[148:151], v[244:247], v[184:187], v[148:151]
    ds_read_b64_tr_b16 v[178:179], v4 offset:1536
    v_mfma_f32_16x16x32_bf16 v[52:55], v[156:159], v[204:207], v[52:55]
    v_cvt_pk_bf16_f32 v154, v140, v141
    v_cvt_pk_bf16_f32 v155, v142, v143
    v_mfma_f32_16x16x32_bf16 v[144:147], v[248:251], v[188:191], v[144:147]
    ds_read_b64_tr_b16 v[180:181], v4 offset:8704
    v_mfma_f32_16x16x32_bf16 v[148:151], v[252:255], v[188:191], v[148:151]
    ds_read_b64_tr_b16 v[182:183], v4 offset:9728
    s_waitcnt lgkmcnt(8)
    v_mfma_f32_16x16x32_bf16 v[136:139], v[104:107], v[160:163], 0
    ds_read_b64_tr_b16 v[184:185], v4 offset:16896
    v_mfma_f32_16x16x32_bf16 v[140:143], v[108:111], v[160:163], 0
    ds_read_b64_tr_b16 v[186:187], v4 offset:17920
    v_mfma_f32_16x16x32_bf16 v[40:43], v[152:155], v[200:203], v[40:43]
    v_cvt_pk_bf16_f32 v156, v144, v145
    v_cvt_pk_bf16_f32 v157, v146, v147
    v_mfma_f32_16x16x32_bf16 v[136:139], v[112:115], v[164:167], v[136:139]
    ds_read_b64_tr_b16 v[188:189], v4 offset:25088
    v_mfma_f32_16x16x32_bf16 v[140:143], v[116:119], v[164:167], v[140:143]
    ds_read_b64_tr_b16 v[190:191], v4 offset:26112
    s_waitcnt lgkmcnt(8)
    v_mfma_f32_16x16x32_bf16 v[136:139], v[120:123], v[168:171], v[136:139]
    ds_read_b64_tr_b16 v[160:161], v5 offset:512
    v_mfma_f32_16x16x32_bf16 v[140:143], v[124:127], v[168:171], v[140:143]
    ds_read_b64_tr_b16 v[162:163], v5 offset:1536
    v_mfma_f32_16x16x32_bf16 v[56:59], v[152:155], v[204:207], v[56:59]
    v_cvt_pk_bf16_f32 v158, v148, v149
    v_cvt_pk_bf16_f32 v159, v150, v151
    v_mfma_f32_16x16x32_bf16 v[136:139], v[128:131], v[172:175], v[136:139]
    ds_read_b64_tr_b16 v[164:165], v5 offset:8704
    v_mfma_f32_16x16x32_bf16 v[140:143], v[132:135], v[172:175], v[140:143]
    ds_read_b64_tr_b16 v[166:167], v5 offset:9728
    s_waitcnt lgkmcnt(8)
    v_mfma_f32_16x16x32_bf16 v[144:147], v[104:107], v[176:179], 0
    ds_read_b64_tr_b16 v[168:169], v5 offset:16896
    v_mfma_f32_16x16x32_bf16 v[148:151], v[108:111], v[176:179], 0
    ds_read_b64_tr_b16 v[170:171], v5 offset:17920
    v_mfma_f32_16x16x32_bf16 v[44:47], v[156:159], v[200:203], v[44:47]
    v_cvt_pk_bf16_f32 v152, v136, v137
    v_cvt_pk_bf16_f32 v153, v138, v139
    v_mfma_f32_16x16x32_bf16 v[144:147], v[112:115], v[180:183], v[144:147]
    ds_read_b64_tr_b16 v[172:173], v5 offset:25088
    v_mfma_f32_16x16x32_bf16 v[148:151], v[116:119], v[180:183], v[148:151]
    ds_read_b64_tr_b16 v[174:175], v5 offset:26112
    s_waitcnt lgkmcnt(8)
    v_mfma_f32_16x16x32_bf16 v[144:147], v[120:123], v[184:187], v[144:147]
    ds_read_b64_tr_b16 v[176:177], v4 offset:768
    v_mfma_f32_16x16x32_bf16 v[148:151], v[124:127], v[184:187], v[148:151]
    ds_read_b64_tr_b16 v[178:179], v4 offset:1792
    v_mfma_f32_16x16x32_bf16 v[60:63], v[156:159], v[204:207], v[60:63]
    v_cvt_pk_bf16_f32 v154, v140, v141
    v_cvt_pk_bf16_f32 v155, v142, v143
    v_mfma_f32_16x16x32_bf16 v[144:147], v[128:131], v[188:191], v[144:147]
    ds_read_b64_tr_b16 v[180:181], v4 offset:8960
    v_mfma_f32_16x16x32_bf16 v[148:151], v[132:135], v[188:191], v[148:151]
    ds_read_b64_tr_b16 v[182:183], v4 offset:9984
    s_waitcnt lgkmcnt(8)
    v_mfma_f32_16x16x32_bf16 v[136:139], v[104:107], v[160:163], 0
    ds_read_b64_tr_b16 v[184:185], v4 offset:17152
    v_mfma_f32_16x16x32_bf16 v[140:143], v[108:111], v[160:163], 0
    ds_read_b64_tr_b16 v[186:187], v4 offset:18176
    v_mfma_f32_16x16x32_bf16 v[96:99], v[152:155], v[208:211], v[96:99]
    v_cvt_pk_bf16_f32 v156, v144, v145
    v_cvt_pk_bf16_f32 v157, v146, v147
    v_mfma_f32_16x16x32_bf16 v[136:139], v[112:115], v[164:167], v[136:139]
    ds_read_b32 v21, v22
    ds_read_b64_tr_b16 v[188:189], v4 offset:25344
    v_mfma_f32_16x16x32_bf16 v[140:143], v[116:119], v[164:167], v[140:143]
    ds_read_b64_tr_b16 v[190:191], v4 offset:26368
    s_waitcnt lgkmcnt(9)
    v_mfma_f32_16x16x32_bf16 v[136:139], v[120:123], v[168:171], v[136:139]
    ds_read_b64_tr_b16 v[160:161], v5 offset:768
    v_mfma_f32_16x16x32_bf16 v[140:143], v[124:127], v[168:171], v[140:143]
    ds_read_b64_tr_b16 v[162:163], v5 offset:1792
    v_mfma_f32_16x16x32_bf16 v[100:103], v[152:155], v[212:215], v[100:103]
    v_cvt_pk_bf16_f32 v158, v148, v149
    v_cvt_pk_bf16_f32 v159, v150, v151
    v_mfma_f32_16x16x32_bf16 v[136:139], v[128:131], v[172:175], v[136:139]
    ds_read_b64_tr_b16 v[164:165], v5 offset:8960
    v_mfma_f32_16x16x32_bf16 v[140:143], v[132:135], v[172:175], v[140:143]
    ds_read_b64_tr_b16 v[166:167], v5 offset:9984
    s_waitcnt lgkmcnt(9)
    v_mfma_f32_16x16x32_bf16 v[144:147], v[104:107], v[176:179], 0
    ds_read_b64_tr_b16 v[168:169], v5 offset:17152
    v_mfma_f32_16x16x32_bf16 v[148:151], v[108:111], v[176:179], 0
    ds_read_b64_tr_b16 v[170:171], v5 offset:18176
    v_mfma_f32_16x16x32_bf16 v[64:67], v[156:159], v[208:211], v[64:67]
    v_cvt_pk_bf16_f32 v152, v136, v137
    v_cvt_pk_bf16_f32 v153, v138, v139
    v_mfma_f32_16x16x32_bf16 v[144:147], v[112:115], v[180:183], v[144:147]
    s_waitcnt lgkmcnt(8)
    v_cmp_gt_u32 vcc, 34, v21
    ds_read_b64_tr_b16 v[172:173], v5 offset:25344
    v_mfma_f32_16x16x32_bf16 v[148:151], v[116:119], v[180:183], v[148:151]
    s_cbranch_vccnz L_cs57
L_co57:
    ds_read_b64_tr_b16 v[174:175], v5 offset:26368
    s_waitcnt lgkmcnt(8)
    v_mfma_f32_16x16x32_bf16 v[144:147], v[120:123], v[184:187], v[144:147]
    ds_read_b64_tr_b16 v[176:177], v18 offset:4096
    v_mfma_f32_16x16x32_bf16 v[148:151], v[124:127], v[184:187], v[148:151]
    ds_read_b32 v21, v22
    ds_read_b64_tr_b16 v[178:179], v18 offset:4352
    v_mfma_f32_16x16x32_bf16 v[80:83], v[156:159], v[212:215], v[80:83]
    v_cvt_pk_bf16_f32 v154, v140, v141
    v_cvt_pk_bf16_f32 v155, v142, v143
    v_mfma_f32_16x16x32_bf16 v[144:147], v[128:131], v[188:191], v[144:147]
    ds_read_b64_tr_b16 v[180:181], v18 offset:5120
    v_mfma_f32_16x16x32_bf16 v[148:151], v[132:135], v[188:191], v[148:151]
    ds_read_b64_tr_b16 v[182:183], v18 offset:5376
    s_waitcnt lgkmcnt(9)
    v_mfma_f32_16x16x32_bf16 v[136:139], v[104:107], v[160:163], 0
    s_waitcnt lgkmcnt(3)
    v_cmp_gt_u32 vcc, 35, v21
    ds_read_b64_tr_b16 v[184:185], v18 offset:6144
    v_mfma_f32_16x16x32_bf16 v[140:143], v[108:111], v[160:163], 0
    s_cbranch_vccnz L_cs58
L_co58:
    ds_read_b64_tr_b16 v[186:187], v18 offset:6400
    v_mfma_f32_16x16x32_bf16 v[68:71], v[152:155], v[208:211], v[68:71]
    v_cvt_pk_bf16_f32 v156, v144, v145
    v_cvt_pk_bf16_f32 v157, v146, v147
    v_mfma_f32_16x16x32_bf16 v[136:139], v[112:115], v[164:167], v[136:139]
    ds_read_b128 v[224:227], v24 offset:0
    ds_read_b128 v[228:231], v24 offset:2048
    ds_read_b64_tr_b16 v[188:189], v18 offset:7168
    v_mfma_f32_16x16x32_bf16 v[140:143], v[116:119], v[164:167], v[140:143]
    ds_read_b128 v[232:235], v25 offset:0
    ds_read_b128 v[236:239], v25 offset:2048
    ds_read_b64_tr_b16 v[190:191], v18 offset:7424
    v_mfma_f32_16x16x32_bf16 v[136:139], v[120:123], v[168:171], v[136:139]
    ds_read_b128 v[240:243], v24 offset:16384
    ds_read_b128 v[244:247], v24 offset:18432
    ds_read_b64_tr_b16 v[160:161], v4 offset:33280
    v_mfma_f32_16x16x32_bf16 v[140:143], v[124:127], v[168:171], v[140:143]
    ds_read_b128 v[248:251], v25 offset:16384
    ds_read_b128 v[252:255], v25 offset:18432
    ds_read_b64_tr_b16 v[162:163], v4 offset:34304
    v_mfma_f32_16x16x32_bf16 v[84:87], v[152:155], v[212:215], v[84:87]
    v_cvt_pk_bf16_f32 v158, v148, v149
    v_cvt_pk_bf16_f32 v159, v150, v151
    v_mfma_f32_16x16x32_bf16 v[136:139], v[128:131], v[172:175], v[136:139]
    ds_read_b64_tr_b16 v[164:165], v4 offset:41472
    v_mfma_f32_16x16x32_bf16 v[140:143], v[132:135], v[172:175], v[140:143]
    ds_read_b64_tr_b16 v[166:167], v4 offset:42496
    s_waitcnt lgkmcnt(12)
    v_mfma_f32_16x16x32_bf16 v[144:147], v[224:227], v[176:179], 0
    ds_read_b64_tr_b16 v[168:169], v4 offset:49664
    v_mfma_f32_16x16x32_bf16 v[148:151], v[228:231], v[176:179], 0
    ds_read_b64_tr_b16 v[170:171], v4 offset:50688
    v_mfma_f32_16x16x32_bf16 v[72:75], v[156:159], v[208:211], v[72:75]
    v_cvt_pk_bf16_f32 v152, v136, v137
    v_cvt_pk_bf16_f32 v153, v138, v139
    s_waitcnt lgkmcnt(11)
    v_mfma_f32_16x16x32_bf16 v[144:147], v[232:235], v[180:183], v[144:147]
    ds_read_b64_tr_b16 v[172:173], v4 offset:57856
    v_mfma_f32_16x16x32_bf16 v[148:151], v[236:239], v[180:183], v[148:151]
    ds_read_b64_tr_b16 v[174:175], v4 offset:58880
    s_waitcnt lgkmcnt(10)
    v_mfma_f32_16x16x32_bf16 v[144:147], v[240:243], v[184:187], v[144:147]
    ds_read_b64_tr_b16 v[176:177], v5 offset:33280
    v_mfma_f32_16x16x32_bf16 v[148:151], v[244:247], v[184:187], v[148:151]
    ds_read_b64_tr_b16 v[178:179], v5 offset:34304
    v_mfma_f32_16x16x32_bf16 v[88:91], v[156:159], v[212:215], v[88:91]
    v_cvt_pk_bf16_f32 v154, v140, v141
    v_cvt_pk_bf16_f32 v155, v142, v143
    s_waitcnt lgkmcnt(9)
    v_mfma_f32_16x16x32_bf16 v[144:147], v[248:251], v[188:191], v[144:147]
    ds_read_b64_tr_b16 v[180:181], v5 offset:41472
    v_mfma_f32_16x16x32_bf16 v[148:151], v[252:255], v[188:191], v[148:151]
    ds_read_b64_tr_b16 v[182:183], v5 offset:42496
    s_waitcnt lgkmcnt(8)
    v_mfma_f32_16x16x32_bf16 v[136:139], v[224:227], v[160:163], 0
    ds_read_b64_tr_b16 v[184:185], v5 offset:49664
    v_mfma_f32_16x16x32_bf16 v[140:143], v[228:231], v[160:163], 0
    ds_read_b64_tr_b16 v[186:187], v5 offset:50688
    v_mfma_f32_16x16x32_bf16 v[76:79], v[152:155], v[208:211], v[76:79]
    v_cvt_pk_bf16_f32 v156, v144, v145
    v_cvt_pk_bf16_f32 v157, v146, v147
    v_mfma_f32_16x16x32_bf16 v[136:139], v[232:235], v[164:167], v[136:139]
    ds_read_b64_tr_b16 v[188:189], v5 offset:57856
    v_mfma_f32_16x16x32_bf16 v[140:143], v[236:239], v[164:167], v[140:143]
    ds_read_b64_tr_b16 v[190:191], v5 offset:58880
    s_waitcnt lgkmcnt(8)
    v_mfma_f32_16x16x32_bf16 v[136:139], v[240:243], v[168:171], v[136:139]
    ds_read_b64_tr_b16 v[160:161], v4 offset:33536
    v_mfma_f32_16x16x32_bf16 v[140:143], v[244:247], v[168:171], v[140:143]
    ds_read_b64_tr_b16 v[162:163], v4 offset:34560
    v_mfma_f32_16x16x32_bf16 v[92:95], v[152:155], v[212:215], v[92:95]
    v_cvt_pk_bf16_f32 v158, v148, v149
    v_cvt_pk_bf16_f32 v159, v150, v151
    v_mfma_f32_16x16x32_bf16 v[136:139], v[248:251], v[172:175], v[136:139]
    ds_read_b64_tr_b16 v[164:165], v4 offset:41728
    v_mfma_f32_16x16x32_bf16 v[140:143], v[252:255], v[172:175], v[140:143]
    ds_read_b64_tr_b16 v[166:167], v4 offset:42752
    s_waitcnt lgkmcnt(8)
    v_mfma_f32_16x16x32_bf16 v[144:147], v[224:227], v[176:179], 0
    ds_read_b64_tr_b16 v[168:169], v4 offset:49920
    v_mfma_f32_16x16x32_bf16 v[148:151], v[228:231], v[176:179], 0
    ds_read_b64_tr_b16 v[170:171], v4 offset:50944
    v_mfma_f32_16x16x32_bf16 v[96:99], v[156:159], v[216:219], v[96:99]
    v_cvt_pk_bf16_f32 v152, v136, v137
    v_cvt_pk_bf16_f32 v153, v138, v139
    v_mfma_f32_16x16x32_bf16 v[144:147], v[232:235], v[180:183], v[144:147]
    ds_read_b64_tr_b16 v[172:173], v4 offset:58112
    v_mfma_f32_16x16x32_bf16 v[148:151], v[236:239], v[180:183], v[148:151]
    ds_read_b64_tr_b16 v[174:175], v4 offset:59136
    s_waitcnt lgkmcnt(8)
    v_mfma_f32_16x16x32_bf16 v[144:147], v[240:243], v[184:187], v[144:147]
    ds_read_b64_tr_b16 v[176:177], v5 offset:33536
    v_mfma_f32_16x16x32_bf16 v[148:151], v[244:247], v[184:187], v[148:151]
    ds_read_b64_tr_b16 v[178:179], v5 offset:34560
    v_mfma_f32_16x16x32_bf16 v[100:103], v[156:159], v[220:223], v[100:103]
    v_cvt_pk_bf16_f32 v154, v140, v141
    v_cvt_pk_bf16_f32 v155, v142, v143
    v_mfma_f32_16x16x32_bf16 v[144:147], v[248:251], v[188:191], v[144:147]
    ds_read_b64_tr_b16 v[180:181], v5 offset:41728
    v_mfma_f32_16x16x32_bf16 v[148:151], v[252:255], v[188:191], v[148:151]
    ds_read_b64_tr_b16 v[182:183], v5 offset:42752
    s_waitcnt lgkmcnt(8)
    v_mfma_f32_16x16x32_bf16 v[136:139], v[224:227], v[160:163], 0
    ds_read_b64_tr_b16 v[184:185], v5 offset:49920
    v_cvt_pk_bf16_f32 v96, v96, v97
    v_mfma_f32_16x16x32_bf16 v[140:143], v[228:231], v[160:163], 0
    ds_read_b64_tr_b16 v[186:187], v5 offset:50944
    v_cvt_pk_bf16_f32 v97, v98, v99
    v_mfma_f32_16x16x32_bf16 v[64:67], v[152:155], v[216:219], v[64:67]
    v_cvt_pk_bf16_f32 v156, v144, v145
    v_cvt_pk_bf16_f32 v157, v146, v147
    v_mfma_f32_16x16x32_bf16 v[136:139], v[232:235], v[164:167], v[136:139]
    ds_read_b64_tr_b16 v[188:189], v5 offset:58112
    v_cvt_pk_bf16_f32 v100, v100, v101
    v_mfma_f32_16x16x32_bf16 v[140:143], v[236:239], v[164:167], v[140:143]
    ds_read_b64_tr_b16 v[190:191], v5 offset:59136
    s_waitcnt lgkmcnt(8)
    v_mfma_f32_16x16x32_bf16 v[136:139], v[240:243], v[168:171], v[136:139]
    ds_read_b64_tr_b16 v[160:161], v4 offset:32768
    v_cvt_pk_bf16_f32 v101, v102, v103
    v_mfma_f32_16x16x32_bf16 v[140:143], v[244:247], v[168:171], v[140:143]
    ds_read_b64_tr_b16 v[162:163], v4 offset:33792
    v_mov_b32_dpp v98, v96 row_ror:8 row_mask:0xf bank_mask:0xf
    v_mfma_f32_16x16x32_bf16 v[80:83], v[152:155], v[220:223], v[80:83]
    v_cvt_pk_bf16_f32 v158, v148, v149
    v_cvt_pk_bf16_f32 v159, v150, v151
    v_mfma_f32_16x16x32_bf16 v[136:139], v[248:251], v[172:175], v[136:139]
    ds_read_b64_tr_b16 v[164:165], v4 offset:40960
    v_mov_b32_dpp v99, v97 row_ror:8 row_mask:0xf bank_mask:0xf
    v_mfma_f32_16x16x32_bf16 v[140:143], v[252:255], v[172:175], v[140:143]
    ds_read_b64_tr_b16 v[166:167], v4 offset:41984
    s_waitcnt lgkmcnt(8)
    v_mfma_f32_16x16x32_bf16 v[144:147], v[224:227], v[176:179], 0
    ds_read_b64_tr_b16 v[168:169], v4 offset:49152
    v_mov_b32_dpp v102, v100 row_ror:8 row_mask:0xf bank_mask:0xf
    v_mfma_f32_16x16x32_bf16 v[148:151], v[228:231], v[176:179], 0
    ds_read_b64_tr_b16 v[170:171], v4 offset:50176
    v_mov_b32_dpp v103, v101 row_ror:8 row_mask:0xf bank_mask:0xf
    v_mfma_f32_16x16x32_bf16 v[68:71], v[156:159], v[216:219], v[68:71]
    v_cvt_pk_bf16_f32 v152, v136, v137
    v_cvt_pk_bf16_f32 v153, v138, v139
    v_mfma_f32_16x16x32_bf16 v[144:147], v[232:235], v[180:183], v[144:147]
    ds_read_b64_tr_b16 v[172:173], v4 offset:57344
    v_cndmask_b32 v96, v99, v96, s[48:49]
    v_mfma_f32_16x16x32_bf16 v[148:151], v[236:239], v[180:183], v[148:151]
    ds_read_b64_tr_b16 v[174:175], v4 offset:58368
    s_waitcnt lgkmcnt(8)
    v_mfma_f32_16x16x32_bf16 v[144:147], v[240:243], v[184:187], v[144:147]
    ds_read_b64_tr_b16 v[176:177], v5 offset:32768
    v_cndmask_b32 v97, v97, v98, s[48:49]
    v_mfma_f32_16x16x32_bf16 v[148:151], v[244:247], v[184:187], v[148:151]
    ds_read_b64_tr_b16 v[178:179], v5 offset:33792
    v_cndmask_b32 v100, v103, v100, s[48:49]
    v_mfma_f32_16x16x32_bf16 v[84:87], v[156:159], v[220:223], v[84:87]
    v_cvt_pk_bf16_f32 v154, v140, v141
    v_cvt_pk_bf16_f32 v155, v142, v143
    v_mfma_f32_16x16x32_bf16 v[144:147], v[248:251], v[188:191], v[144:147]
    ds_read_b64_tr_b16 v[180:181], v5 offset:40960
    v_cndmask_b32 v101, v101, v102, s[48:49]
    v_mfma_f32_16x16x32_bf16 v[148:151], v[252:255], v[188:191], v[148:151]
    ds_read_b64_tr_b16 v[182:183], v5 offset:41984
    s_waitcnt lgkmcnt(8)
    v_mfma_f32_16x16x32_bf16 v[136:139], v[224:227], v[160:163], 0
    ds_read_b64_tr_b16 v[184:185], v5 offset:49152
    v_cndmask_b32 v28, v96, v97, s[50:51]
    v_mfma_f32_16x16x32_bf16 v[140:143], v[228:231], v[160:163], 0
    ds_read_b64_tr_b16 v[186:187], v5 offset:50176
    v_cndmask_b32 v30, v97, v96, s[50:51]
    v_mfma_f32_16x16x32_bf16 v[72:75], v[152:155], v[216:219], v[72:75]
    v_cvt_pk_bf16_f32 v156, v144, v145
    v_cvt_pk_bf16_f32 v157, v146, v147
    v_mfma_f32_16x16x32_bf16 v[136:139], v[232:235], v[164:167], v[136:139]
    ds_read_b64_tr_b16 v[188:189], v5 offset:57344
    v_cndmask_b32 v29, v100, v101, s[50:51]
    v_mfma_f32_16x16x32_bf16 v[140:143], v[236:239], v[164:167], v[140:143]
    ds_read_b64_tr_b16 v[190:191], v5 offset:58368
    s_waitcnt lgkmcnt(8)
    v_mfma_f32_16x16x32_bf16 v[136:139], v[240:243], v[168:171], v[136:139]
    ds_read_b64_tr_b16 v[160:161], v4 offset:33024
    v_cndmask_b32 v31, v101, v100, s[50:51]
    v_mfma_f32_16x16x32_bf16 v[140:143], v[244:247], v[168:171], v[140:143]
    ds_read_b64_tr_b16 v[162:163], v4 offset:34048
    v_cvt_pk_bf16_f32 v64, v64, v65
    v_mfma_f32_16x16x32_bf16 v[88:91], v[152:155], v[220:223], v[88:91]
    v_cvt_pk_bf16_f32 v158, v148, v149
    v_cvt_pk_bf16_f32 v159, v150, v151
    v_mfma_f32_16x16x32_bf16 v[136:139], v[248:251], v[172:175], v[136:139]
    ds_read_b64_tr_b16 v[164:165], v4 offset:41216
    v_cvt_pk_bf16_f32 v65, v66, v67
    v_mfma_f32_16x16x32_bf16 v[140:143], v[252:255], v[172:175], v[140:143]
    ds_read_b64_tr_b16 v[166:167], v4 offset:42240
    s_waitcnt lgkmcnt(8)
    v_mfma_f32_16x16x32_bf16 v[144:147], v[224:227], v[176:179], 0
    ds_read_b64_tr_b16 v[168:169], v4 offset:49408
    v_cvt_pk_bf16_f32 v66, v68, v69
    v_mfma_f32_16x16x32_bf16 v[148:151], v[228:231], v[176:179], 0
    ds_read_b64_tr_b16 v[170:171], v4 offset:50432
    v_mov_b32 v67, s53
    v_mfma_f32_16x16x32_bf16 v[76:79], v[156:159], v[216:219], v[76:79]
    v_cvt_pk_bf16_f32 v152, v136, v137
    v_cvt_pk_bf16_f32 v153, v138, v139
    v_mfma_f32_16x16x32_bf16 v[144:147], v[232:235], v[180:183], v[144:147]
    ds_read_b64_tr_b16 v[172:173], v4 offset:57600
    buffer_store_dwordx4 v[64:67], v10, s[68:71], s91 offen offset:0 sc1
    v_mfma_f32_16x16x32_bf16 v[148:151], v[236:239], v[180:183], v[148:151]
    ds_read_b64_tr_b16 v[174:175], v4 offset:58624
    s_waitcnt lgkmcnt(8)
    v_mfma_f32_16x16x32_bf16 v[144:147], v[240:243], v[184:187], v[144:147]
    ds_read_b64_tr_b16 v[176:177], v5 offset:33024
    v_cvt_pk_bf16_f32 v80, v80, v81
    v_mfma_f32_16x16x32_bf16 v[148:151], v[244:247], v[184:187], v[148:151]
    ds_read_b64_tr_b16 v[178:179], v5 offset:34048
    v_cvt_pk_bf16_f32 v81, v82, v83
    v_mfma_f32_16x16x32_bf16 v[92:95], v[156:159], v[220:223], v[92:95]
    v_cvt_pk_bf16_f32 v154, v140, v141
    v_cvt_pk_bf16_f32 v155, v142, v143
    v_mfma_f32_16x16x32_bf16 v[144:147], v[248:251], v[188:191], v[144:147]
    ds_read_b64_tr_b16 v[180:181], v5 offset:41216
    v_cvt_pk_bf16_f32 v82, v84, v85
    v_mfma_f32_16x16x32_bf16 v[148:151], v[252:255], v[188:191], v[148:151]
    ds_read_b64_tr_b16 v[182:183], v5 offset:42240
    s_waitcnt lgkmcnt(8)
    v_mfma_f32_16x16x32_bf16 v[136:139], v[224:227], v[160:163], 0
    ds_read_b64_tr_b16 v[184:185], v5 offset:49408
    v_mov_b32 v83, s53
    v_mfma_f32_16x16x32_bf16 v[140:143], v[228:231], v[160:163], 0
    ds_read_b64_tr_b16 v[186:187], v5 offset:50432
    buffer_store_dwordx4 v[80:83], v10, s[68:71], s92 offen offset:0 sc1
    v_mfma_f32_16x16x32_bf16 v[32:35], v[152:155], v[216:219], v[32:35]
    v_cvt_pk_bf16_f32 v156, v144, v145
    v_cvt_pk_bf16_f32 v157, v146, v147
    v_mfma_f32_16x16x32_bf16 v[136:139], v[232:235], v[164:167], v[136:139]
    ds_read_b64_tr_b16 v[188:189], v5 offset:57600
    v_cvt_pk_bf16_f32 v68, v70, v71
    v_mfma_f32_16x16x32_bf16 v[140:143], v[236:239], v[164:167], v[140:143]
    ds_read_b64_tr_b16 v[190:191], v5 offset:58624
    s_waitcnt lgkmcnt(8)
    v_mfma_f32_16x16x32_bf16 v[136:139], v[240:243], v[168:171], v[136:139]
    ds_read_b64_tr_b16 v[160:161], v4 offset:0
    v_cvt_pk_bf16_f32 v69, v72, v73
    v_mfma_f32_16x16x32_bf16 v[140:143], v[244:247], v[168:171], v[140:143]
    ds_read_b64_tr_b16 v[162:163], v4 offset:1024
    v_cvt_pk_bf16_f32 v70, v74, v75
    v_mfma_f32_16x16x32_bf16 v[48:51], v[152:155], v[220:223], v[48:51]
    v_cvt_pk_bf16_f32 v158, v148, v149
    v_cvt_pk_bf16_f32 v159, v150, v151
    v_mfma_f32_16x16x32_bf16 v[136:139], v[248:251], v[172:175], v[136:139]
    ds_read_b64_tr_b16 v[164:165], v4 offset:8192
    v_mov_b32 v71, s53
    v_mfma_f32_16x16x32_bf16 v[140:143], v[252:255], v[172:175], v[140:143]
    ds_read_b64_tr_b16 v[166:167], v4 offset:9216
    s_waitcnt lgkmcnt(8)
    v_mfma_f32_16x16x32_bf16 v[144:147], v[224:227], v[176:179], 0
    ds_read_b64_tr_b16 v[168:169], v4 offset:16384
    buffer_store_dwordx4 v[68:71], v10, s[68:71], s91 offen offset:1024 sc1
    v_mfma_f32_16x16x32_bf16 v[148:151], v[228:231], v[176:179], 0
    ds_read_b64_tr_b16 v[170:171], v4 offset:17408
    v_cvt_pk_bf16_f32 v84, v86, v87
    v_mfma_f32_16x16x32_bf16 v[36:39], v[156:159], v[216:219], v[36:39]
    v_cvt_pk_bf16_f32 v152, v136, v137
    v_cvt_pk_bf16_f32 v153, v138, v139
    v_mfma_f32_16x16x32_bf16 v[144:147], v[232:235], v[180:183], v[144:147]
    ds_read_b64_tr_b16 v[172:173], v4 offset:24576
    v_cvt_pk_bf16_f32 v85, v88, v89
    v_mfma_f32_16x16x32_bf16 v[148:151], v[236:239], v[180:183], v[148:151]
    ds_read_b64_tr_b16 v[174:175], v4 offset:25600
    s_waitcnt lgkmcnt(8)
    v_mfma_f32_16x16x32_bf16 v[144:147], v[240:243], v[184:187], v[144:147]
    ds_read_b64_tr_b16 v[176:177], v5 offset:0
    v_cvt_pk_bf16_f32 v86, v90, v91
    v_mfma_f32_16x16x32_bf16 v[148:151], v[244:247], v[184:187], v[148:151]
    ds_read_b64_tr_b16 v[178:179], v5 offset:1024
    v_mov_b32 v87, s53
    v_mfma_f32_16x16x32_bf16 v[52:55], v[156:159], v[220:223], v[52:55]
    v_cvt_pk_bf16_f32 v154, v140, v141
    v_cvt_pk_bf16_f32 v155, v142, v143
    v_mfma_f32_16x16x32_bf16 v[144:147], v[248:251], v[188:191], v[144:147]
    ds_read_b64_tr_b16 v[180:181], v5 offset:8192
    buffer_store_dwordx4 v[84:87], v10, s[68:71], s92 offen offset:1024 sc1
    v_mfma_f32_16x16x32_bf16 v[148:151], v[252:255], v[188:191], v[148:151]
    ds_read_b64_tr_b16 v[182:183], v5 offset:9216
    s_waitcnt lgkmcnt(8)
    v_mfma_f32_16x16x32_bf16 v[136:139], v[104:107], v[160:163], 0
    ds_read_b64_tr_b16 v[184:185], v5 offset:16384
    v_cvt_pk_bf16_f32 v72, v76, v77
    v_mfma_f32_16x16x32_bf16 v[140:143], v[108:111], v[160:163], 0
    ds_read_b64_tr_b16 v[186:187], v5 offset:17408
    v_cvt_pk_bf16_f32 v73, v78, v79
    v_mfma_f32_16x16x32_bf16 v[40:43], v[152:155], v[216:219], v[40:43]
    v_cvt_pk_bf16_f32 v156, v144, v145
    v_cvt_pk_bf16_f32 v157, v146, v147
    v_mfma_f32_16x16x32_bf16 v[136:139], v[112:115], v[164:167], v[136:139]
    ds_read_b64_tr_b16 v[188:189], v5 offset:24576
    v_mov_b32 v74, v30
    v_mfma_f32_16x16x32_bf16 v[140:143], v[116:119], v[164:167], v[140:143]
    ds_read_b64_tr_b16 v[190:191], v5 offset:25600
    s_waitcnt lgkmcnt(8)
    v_mfma_f32_16x16x32_bf16 v[136:139], v[120:123], v[168:171], v[136:139]
    ds_read_b64_tr_b16 v[160:161], v4 offset:256
    v_mov_b32 v75, s53
    v_mfma_f32_16x16x32_bf16 v[140:143], v[124:127], v[168:171], v[140:143]
    ds_read_b64_tr_b16 v[162:163], v4 offset:1280
    buffer_store_dwordx4 v[72:75], v10, s[68:71], s91 offen offset:2048 sc1
    v_mfma_f32_16x16x32_bf16 v[56:59], v[152:155], v[220:223], v[56:59]
    v_cvt_pk_bf16_f32 v158, v148, v149
    v_cvt_pk_bf16_f32 v159, v150, v151
    v_mfma_f32_16x16x32_bf16 v[136:139], v[128:131], v[172:175], v[136:139]
    ds_read_b64_tr_b16 v[164:165], v4 offset:8448
    v_cvt_pk_bf16_f32 v88, v92, v93
    v_mfma_f32_16x16x32_bf16 v[140:143], v[132:135], v[172:175], v[140:143]
    ds_read_b64_tr_b16 v[166:167], v4 offset:9472
    s_waitcnt lgkmcnt(8)
    v_mfma_f32_16x16x32_bf16 v[144:147], v[104:107], v[176:179], 0
    ds_read_b64_tr_b16 v[168:169], v4 offset:16640
    v_cvt_pk_bf16_f32 v89, v94, v95
    v_mfma_f32_16x16x32_bf16 v[148:151], v[108:111], v[176:179], 0
    ds_read_b64_tr_b16 v[170:171], v4 offset:17664
    v_mov_b32 v90, v31
    v_mfma_f32_16x16x32_bf16 v[44:47], v[156:159], v[216:219], v[44:47]
    v_cvt_pk_bf16_f32 v152, v136, v137
    v_cvt_pk_bf16_f32 v153, v138, v139
    v_mfma_f32_16x16x32_bf16 v[144:147], v[112:115], v[180:183], v[144:147]
    ds_read_b64_tr_b16 v[172:173], v4 offset:24832
    v_mov_b32 v91, s53
    v_mfma_f32_16x16x32_bf16 v[148:151], v[116:119], v[180:183], v[148:151]
    ds_read_b64_tr_b16 v[174:175], v4 offset:25856
    s_waitcnt lgkmcnt(8)
    v_mfma_f32_16x16x32_bf16 v[144:147], v[120:123], v[184:187], v[144:147]
    ds_read_b64_tr_b16 v[176:177], v5 offset:256
    buffer_store_dwordx4 v[88:91], v10, s[68:71], s92 offen offset:2048 sc1
    v_mfma_f32_16x16x32_bf16 v[148:151], v[124:127], v[184:187], v[148:151]
    ds_read_b64_tr_b16 v[178:179], v5 offset:1280
    v_mfma_f32_16x16x32_bf16 v[60:63], v[156:159], v[220:223], v[60:63]
    v_cvt_pk_bf16_f32 v154, v140, v141
    v_cvt_pk_bf16_f32 v155, v142, v143
    v_mfma_f32_16x16x32_bf16 v[144:147], v[128:131], v[188:191], v[144:147]
    ds_read_b64_tr_b16 v[180:181], v5 offset:8448
    v_mfma_f32_16x16x32_bf16 v[148:151], v[132:135], v[188:191], v[148:151]
    ds_read_b64_tr_b16 v[182:183], v5 offset:9472
    s_waitcnt lgkmcnt(8)
    v_mfma_f32_16x16x32_bf16 v[136:139], v[104:107], v[160:163], 0
    ds_read_b64_tr_b16 v[184:185], v5 offset:16640
    v_mfma_f32_16x16x32_bf16 v[140:143], v[108:111], v[160:163], 0
    ds_read_b64_tr_b16 v[186:187], v5 offset:17664
    v_mfma_f32_16x16x32_bf16 v[32:35], v[152:155], v[208:211], v[32:35]
    v_cvt_pk_bf16_f32 v156, v144, v145
    v_cvt_pk_bf16_f32 v157, v146, v147
    v_mfma_f32_16x16x32_bf16 v[136:139], v[112:115], v[164:167], v[136:139]
    ds_read_b64_tr_b16 v[188:189], v5 offset:24832
    v_mfma_f32_16x16x32_bf16 v[140:143], v[116:119], v[164:167], v[140:143]
    ds_read_b64_tr_b16 v[190:191], v5 offset:25856
    s_waitcnt lgkmcnt(8)
    v_mfma_f32_16x16x32_bf16 v[136:139], v[120:123], v[168:171], v[136:139]
    v_mfma_f32_16x16x32_bf16 v[140:143], v[124:127], v[168:171], v[140:143]
    v_mfma_f32_16x16x32_bf16 v[48:51], v[152:155], v[212:215], v[48:51]
    v_cvt_pk_bf16_f32 v158, v148, v149
    v_cvt_pk_bf16_f32 v159, v150, v151
    v_mfma_f32_16x16x32_bf16 v[136:139], v[128:131], v[172:175], v[136:139]
    v_mfma_f32_16x16x32_bf16 v[140:143], v[132:135], v[172:175], v[140:143]
    s_waitcnt lgkmcnt(4)
    v_mfma_f32_16x16x32_bf16 v[144:147], v[104:107], v[176:179], 0
    v_mfma_f32_16x16x32_bf16 v[148:151], v[108:111], v[176:179], 0
    v_mfma_f32_16x16x32_bf16 v[36:39], v[156:159], v[208:211], v[36:39]
    s_nop 2
    v_cvt_pk_bf16_f32 v152, v136, v137
    v_cvt_pk_bf16_f32 v153, v138, v139
    v_mfma_f32_16x16x32_bf16 v[144:147], v[112:115], v[180:183], v[144:147]
    v_mfma_f32_16x16x32_bf16 v[148:151], v[116:119], v[180:183], v[148:151]
    s_waitcnt lgkmcnt(0)
    v_mfma_f32_16x16x32_bf16 v[144:147], v[120:123], v[184:187], v[144:147]
    v_mfma_f32_16x16x32_bf16 v[148:151], v[124:127], v[184:187], v[148:151]
    v_mfma_f32_16x16x32_bf16 v[52:55], v[156:159], v[212:215], v[52:55]
    v_cvt_pk_bf16_f32 v154, v140, v141
    v_cvt_pk_bf16_f32 v155, v142, v143
    v_mfma_f32_16x16x32_bf16 v[144:147], v[128:131], v[188:191], v[144:147]
    v_mfma_f32_16x16x32_bf16 v[148:151], v[132:135], v[188:191], v[148:151]
    v_mfma_f32_16x16x32_bf16 v[40:43], v[152:155], v[208:211], v[40:43]
    s_nop 5
    v_cvt_pk_bf16_f32 v156, v144, v145
    v_cvt_pk_bf16_f32 v157, v146, v147
    v_mfma_f32_16x16x32_bf16 v[56:59], v[152:155], v[212:215], v[56:59]
    v_cvt_pk_bf16_f32 v158, v148, v149
    v_cvt_pk_bf16_f32 v159, v150, v151
    s_nop 1
    v_mfma_f32_16x16x32_bf16 v[44:47], v[156:159], v[208:211], v[44:47]
    v_cvt_pk_bf16_f32 v48, v48, v49
    v_cvt_pk_bf16_f32 v49, v50, v51
    v_mfma_f32_16x16x32_bf16 v[60:63], v[156:159], v[212:215], v[60:63]
    v_cvt_pk_bf16_f32 v50, v52, v53
    v_mov_b32 v51, s53
    buffer_store_dwordx4 v[48:51], v10, s[68:71], s90 offen offset:0 sc1
    v_cvt_pk_bf16_f32 v52, v54, v55
    v_cvt_pk_bf16_f32 v53, v56, v57
    v_cvt_pk_bf16_f32 v54, v58, v59
    v_mov_b32 v55, s53
    buffer_store_dwordx4 v[52:55], v10, s[68:71], s90 offen offset:1024 sc1
    v_cvt_pk_bf16_f32 v56, v60, v61
    v_cvt_pk_bf16_f32 v57, v62, v63
    v_mov_b32 v58, v29
    v_mov_b32 v59, s53
    buffer_store_dwordx4 v[56:59], v10, s[68:71], s90 offen offset:2048 sc1
    s_mov_b32 s87, 0
    s_mov_b32 s3, 0xffff0000
    v_lshlrev_b32 v100, 16, v28
    v_and_b32 v101, s3, v28
L_fa_lp:
    buffer_load_dword v9, v8, s[68:71], s12 offen sc1
    s_add_u32 s87, s87, 1
    s_cmp_lt_u32 s87, 0x10000
    s_waitcnt vmcnt(0)
    s_cbranch_scc0 L_fa_full
    v_cmp_ne_u32 vcc, s53, v9
    s_cbranch_vccnz L_fa_lp
L_fa_full:
    buffer_load_dwordx4 v[104:107], v10, s[68:71], s81 offen offset:0 sc1
    buffer_load_dwordx4 v[108:111], v10, s[68:71], s81 offen offset:1024 sc1
    buffer_load_dwordx4 v[112:115], v10, s[68:71], s81 offen offset:2048 sc1
    buffer_load_dwordx4 v[116:119], v10, s[68:71], s82 offen offset:0 sc1
    buffer_load_dwordx4 v[120:123], v10, s[68:71], s82 offen offset:1024 sc1
    buffer_load_dwordx4 v[124:127], v10, s[68:71], s82 offen offset:2048 sc1
    buffer_load_dwordx4 v[128:131], v10, s[68:71], s83 offen offset:0 sc1
    buffer_load_dwordx4 v[132:135], v10, s[68:71], s83 offen offset:1024 sc1
    buffer_load_dwordx4 v[136:139], v10, s[68:71], s83 offen offset:2048 sc1
    s_waitcnt vmcnt(8)
    v_xor_b32 v9, s53, v107
    s_waitcnt vmcnt(7)
    v_bitop3_b32 v9, v111, s53, v9 bitop3:0xbe
    s_waitcnt vmcnt(6)
    v_bitop3_b32 v9, v115, s53, v9 bitop3:0xbe
    s_waitcnt vmcnt(5)
    v_bitop3_b32 v9, v119, s53, v9 bitop3:0xbe
    s_waitcnt vmcnt(4)
    v_bitop3_b32 v9, v123, s53, v9 bitop3:0xbe
    s_waitcnt vmcnt(3)
    v_bitop3_b32 v9, v127, s53, v9 bitop3:0xbe
    s_waitcnt vmcnt(2)
    v_bitop3_b32 v9, v131, s53, v9 bitop3:0xbe
    s_waitcnt vmcnt(1)
    v_bitop3_b32 v9, v135, s53, v9 bitop3:0xbe
    s_waitcnt vmcnt(0)
    v_bitop3_b32 v9, v139, s53, v9 bitop3:0xbe
    v_cmp_ne_u32 vcc, 0, v9
    s_cmp_lt_u32 s87, 0x10000
    s_cbranch_scc0 L_fa_ok
    s_cbranch_vccnz L_fa_lp
L_fa_ok:
    v_lshlrev_b32 v144, 16, v116
    v_and_b32 v145, s3, v116
    v_lshlrev_b32 v146, 16, v117
    v_and_b32 v147, s3, v117
    v_lshlrev_b32 v148, 16, v118
    v_and_b32 v149, s3, v118
    v_lshlrev_b32 v150, 16, v120
    v_and_b32 v151, s3, v120
    v_pk_add_f32 v[32:33], v[32:33], v[144:145]
    v_pk_add_f32 v[34:35], v[34:35], v[146:147]
    v_pk_add_f32 v[36:37], v[36:37], v[148:149]
    v_pk_add_f32 v[38:39], v[38:39], v[150:151]
    v_lshlrev_b32 v144, 16, v121
    v_and_b32 v145, s3, v121
    v_lshlrev_b32 v146, 16, v122
    v_and_b32 v147, s3, v122
    v_lshlrev_b32 v148, 16, v124
    v_and_b32 v149, s3, v124
    v_lshlrev_b32 v150, 16, v125
    v_and_b32 v151, s3, v125
    v_pk_add_f32 v[40:41], v[40:41], v[144:145]
    v_pk_add_f32 v[42:43], v[42:43], v[146:147]
    v_pk_add_f32 v[44:45], v[44:45], v[148:149]
    v_pk_add_f32 v[46:47], v[46:47], v[150:151]
    v_lshlrev_b32 v144, 16, v126
    v_and_b32 v145, s3, v126
    v_pk_add_f32 v[100:101], v[100:101], v[144:145]
    v_lshlrev_b32 v144, 16, v128
    v_and_b32 v145, s3, v128
    v_lshlrev_b32 v146, 16, v129
    v_and_b32 v147, s3, v129
    v_lshlrev_b32 v148, 16, v130
    v_and_b32 v149, s3, v130
    v_lshlrev_b32 v150, 16, v132
    v_and_b32 v151, s3, v132
    v_pk_add_f32 v[32:33], v[32:33], v[144:145]
    v_pk_add_f32 v[34:35], v[34:35], v[146:147]
    v_pk_add_f32 v[36:37], v[36:37], v[148:149]
    v_pk_add_f32 v[38:39], v[38:39], v[150:151]
    v_lshlrev_b32 v144, 16, v133
    v_and_b32 v145, s3, v133
    v_lshlrev_b32 v146, 16, v134
    v_and_b32 v147, s3, v134
    v_lshlrev_b32 v148, 16, v136
    v_and_b32 v149, s3, v136
    v_lshlrev_b32 v150, 16, v137
    v_and_b32 v151, s3, v137
    v_pk_add_f32 v[40:41], v[40:41], v[144:145]
    v_pk_add_f32 v[42:43], v[42:43], v[146:147]
    v_pk_add_f32 v[44:45], v[44:45], v[148:149]
    v_pk_add_f32 v[46:47], v[46:47], v[150:151]
    v_lshlrev_b32 v144, 16, v138
    v_and_b32 v145, s3, v138
    v_pk_add_f32 v[100:101], v[100:101], v[144:145]
    s_cmp_eq_u32 s88, 0
    s_cbranch_scc0 L_noep
    s_add_u32 s11, s14, 4
    v_mov_b32 v15, s11
    buffer_store_dword v15, v13, s[64:67], 0 offen sc1
L_noep:
    v_lshlrev_b32 v144, 16, v104
    v_and_b32 v145, s3, v104
    v_lshlrev_b32 v146, 16, v105
    v_and_b32 v147, s3, v105
    v_lshlrev_b32 v148, 16, v106
    v_and_b32 v149, s3, v106
    v_lshlrev_b32 v150, 16, v108
    v_and_b32 v151, s3, v108
    v_pk_add_f32 v[32:33], v[32:33], v[144:145]
    v_pk_add_f32 v[34:35], v[34:35], v[146:147]
    v_pk_add_f32 v[36:37], v[36:37], v[148:149]
    v_pk_add_f32 v[38:39], v[38:39], v[150:151]
    v_lshlrev_b32 v144, 16, v109
    v_and_b32 v145, s3, v109
    v_lshlrev_b32 v146, 16, v110
    v_and_b32 v147, s3, v110
    v_lshlrev_b32 v148, 16, v112
    v_and_b32 v149, s3, v112
    v_lshlrev_b32 v150, 16, v113
    v_and_b32 v151, s3, v113
    v_pk_add_f32 v[40:41], v[40:41], v[144:145]
    v_pk_add_f32 v[42:43], v[42:43], v[146:147]
    v_pk_add_f32 v[44:45], v[44:45], v[148:149]
    v_pk_add_f32 v[46:47], v[46:47], v[150:151]
    v_lshlrev_b32 v144, 16, v114
    v_and_b32 v145, s3, v114
    v_pk_add_f32 v[100:101], v[100:101], v[144:145]
    v_cvt_pk_bf16_f32 v144, v32, v33
    v_cvt_pk_bf16_f32 v145, v34, v35
    v_cvt_pk_bf16_f32 v146, v36, v37
    v_cvt_pk_bf16_f32 v147, v38, v39
    v_cvt_pk_bf16_f32 v148, v40, v41
    v_cvt_pk_bf16_f32 v149, v42, v43
    v_cvt_pk_bf16_f32 v150, v44, v45
    v_cvt_pk_bf16_f32 v151, v46, v47
    v_cvt_pk_bf16_f32 v100, v100, v101
    v_permlane16_swap_b32 v144, v146
    v_permlane16_swap_b32 v145, v147
    v_permlane16_swap_b32 v148, v150
    v_permlane16_swap_b32 v149, v151
    buffer_store_dword v100, v6, s[72:75], s89 offen
    buffer_store_dwordx4 v[144:147], v7, s[72:75], s93 offen offset:0
    buffer_store_dwordx4 v[148:151], v7, s[72:75], s93 offen offset:64
    s_endpgm
L_cs25:
    s_mov_b32 s87, 0
L_cl25:
    ds_read_b32 v21, v22
    s_add_u32 s87, s87, 1
    s_cmp_lt_u32 s87, 0x100000
    s_waitcnt lgkmcnt(0)
    s_cbranch_scc0 L_co25
    v_cmp_gt_u32 vcc, 1, v21
    s_cbranch_vccnz L_cl25
    s_branch L_co25
L_cs26:
    s_mov_b32 s87, 0
L_cl26:
    ds_read_b32 v21, v22
    s_add_u32 s87, s87, 1
    s_cmp_lt_u32 s87, 0x100000
    s_waitcnt lgkmcnt(0)
    s_cbranch_scc0 L_co26
    v_cmp_gt_u32 vcc, 2, v21
    s_cbranch_vccnz L_cl26
    s_branch L_co26
L_cs27:
    s_mov_b32 s87, 0
L_cl27:
    ds_read_b32 v21, v22
    s_add_u32 s87, s87, 1
    s_cmp_lt_u32 s87, 0x100000
    s_waitcnt lgkmcnt(0)
    s_cbranch_scc0 L_co27
    v_cmp_gt_u32 vcc, 3, v21
    s_cbranch_vccnz L_cl27
    s_branch L_co27
L_cs28:
    s_mov_b32 s87, 0
L_cl28:
    ds_read_b32 v21, v22
    s_add_u32 s87, s87, 1
    s_cmp_lt_u32 s87, 0x100000
    s_waitcnt lgkmcnt(0)
    s_cbranch_scc0 L_co28
    v_cmp_gt_u32 vcc, 4, v21
    s_cbranch_vccnz L_cl28
    s_branch L_co28
L_cs29:
    s_mov_b32 s87, 0
L_cl29:
    ds_read_b32 v21, v22
    s_add_u32 s87, s87, 1
    s_cmp_lt_u32 s87, 0x100000
    s_waitcnt lgkmcnt(0)
    s_cbranch_scc0 L_co29
    v_cmp_gt_u32 vcc, 5, v21
    s_cbranch_vccnz L_cl29
    s_branch L_co29
L_cs30:
    s_mov_b32 s87, 0
L_cl30:
    ds_read_b32 v21, v22
    s_add_u32 s87, s87, 1
    s_cmp_lt_u32 s87, 0x100000
    s_waitcnt lgkmcnt(0)
    s_cbranch_scc0 L_co30
    v_cmp_gt_u32 vcc, 6, v21
    s_cbranch_vccnz L_cl30
    s_branch L_co30
L_cs31:
    s_mov_b32 s87, 0
L_cl31:
    ds_read_b32 v21, v22
    s_add_u32 s87, s87, 1
    s_cmp_lt_u32 s87, 0x100000
    s_waitcnt lgkmcnt(0)
    s_cbranch_scc0 L_co31
    v_cmp_gt_u32 vcc, 7, v21
    s_cbranch_vccnz L_cl31
    s_branch L_co31
L_cs32:
    s_mov_b32 s87, 0
L_cl32:
    ds_read_b32 v21, v22
    s_add_u32 s87, s87, 1
    s_cmp_lt_u32 s87, 0x100000
    s_waitcnt lgkmcnt(0)
    s_cbranch_scc0 L_co32
    v_cmp_gt_u32 vcc, 8, v21
    s_cbranch_vccnz L_cl32
    s_branch L_co32
L_cs33:
    s_mov_b32 s87, 0
L_cl33:
    ds_read_b32 v21, v22
    s_add_u32 s87, s87, 1
    s_cmp_lt_u32 s87, 0x100000
    s_waitcnt lgkmcnt(0)
    s_cbranch_scc0 L_co33
    v_cmp_gt_u32 vcc, 9, v21
    s_cbranch_vccnz L_cl33
    s_branch L_co33
L_cs34:
    s_mov_b32 s87, 0
L_cl34:
    ds_read_b32 v21, v22
    s_add_u32 s87, s87, 1
    s_cmp_lt_u32 s87, 0x100000
    s_waitcnt lgkmcnt(0)
    s_cbranch_scc0 L_co34
    v_cmp_gt_u32 vcc, 10, v21
    s_cbranch_vccnz L_cl34
    s_branch L_co34
L_cs35:
    s_mov_b32 s87, 0
L_cl35:
    ds_read_b32 v21, v22
    s_add_u32 s87, s87, 1
    s_cmp_lt_u32 s87, 0x100000
    s_waitcnt lgkmcnt(0)
    s_cbranch_scc0 L_co35
    v_cmp_gt_u32 vcc, 11, v21
    s_cbranch_vccnz L_cl35
    s_branch L_co35
L_cs36:
    s_mov_b32 s87, 0
L_cl36:
    ds_read_b32 v21, v22
    s_add_u32 s87, s87, 1
    s_cmp_lt_u32 s87, 0x100000
    s_waitcnt lgkmcnt(0)
    s_cbranch_scc0 L_co36
    v_cmp_gt_u32 vcc, 12, v21
    s_cbranch_vccnz L_cl36
    s_branch L_co36
L_cs37:
    s_mov_b32 s87, 0
L_cl37:
    ds_read_b32 v21, v22
    s_add_u32 s87, s87, 1
    s_cmp_lt_u32 s87, 0x100000
    s_waitcnt lgkmcnt(0)
    s_cbranch_scc0 L_co37
    v_cmp_gt_u32 vcc, 13, v21
    s_cbranch_vccnz L_cl37
    s_branch L_co37
L_cs38:
    s_mov_b32 s87, 0
L_cl38:
    ds_read_b32 v21, v22
    s_add_u32 s87, s87, 1
    s_cmp_lt_u32 s87, 0x100000
    s_waitcnt lgkmcnt(0)
    s_cbranch_scc0 L_co38
    v_cmp_gt_u32 vcc, 14, v21
    s_cbranch_vccnz L_cl38
    s_branch L_co38
L_cs39:
    s_mov_b32 s87, 0
L_cl39:
    ds_read_b32 v21, v22
    s_add_u32 s87, s87, 1
    s_cmp_lt_u32 s87, 0x100000
    s_waitcnt lgkmcnt(0)
    s_cbranch_scc0 L_co39
    v_cmp_gt_u32 vcc, 15, v21
    s_cbranch_vccnz L_cl39
    s_branch L_co39
L_cs40:
    s_mov_b32 s87, 0
L_cl40:
    ds_read_b32 v21, v22
    s_add_u32 s87, s87, 1
    s_cmp_lt_u32 s87, 0x100000
    s_waitcnt lgkmcnt(0)
    s_cbranch_scc0 L_co40
    v_cmp_gt_u32 vcc, 16, v21
    s_cbranch_vccnz L_cl40
    s_branch L_co40
L_cs41:
    s_mov_b32 s87, 0
L_cl41:
    ds_read_b32 v21, v22
    s_add_u32 s87, s87, 1
    s_cmp_lt_u32 s87, 0x100000
    s_waitcnt lgkmcnt(0)
    s_cbranch_scc0 L_co41
    v_cmp_gt_u32 vcc, 17, v21
    s_cbranch_vccnz L_cl41
    s_branch L_co41
L_cs42:
    s_mov_b32 s87, 0
L_cl42:
    ds_read_b32 v21, v22
    s_add_u32 s87, s87, 1
    s_cmp_lt_u32 s87, 0x100000
    s_waitcnt lgkmcnt(0)
    s_cbranch_scc0 L_co42
    v_cmp_gt_u32 vcc, 18, v21
    s_cbranch_vccnz L_cl42
    s_branch L_co42
L_cs43:
    s_mov_b32 s87, 0
L_cl43:
    ds_read_b32 v21, v22
    s_add_u32 s87, s87, 1
    s_cmp_lt_u32 s87, 0x100000
    s_waitcnt lgkmcnt(0)
    s_cbranch_scc0 L_co43
    v_cmp_gt_u32 vcc, 19, v21
    s_cbranch_vccnz L_cl43
    s_branch L_co43
L_cs44:
    s_mov_b32 s87, 0
L_cl44:
    ds_read_b32 v21, v22
    s_add_u32 s87, s87, 1
    s_cmp_lt_u32 s87, 0x100000
    s_waitcnt lgkmcnt(0)
    s_cbranch_scc0 L_co44
    v_cmp_gt_u32 vcc, 20, v21
    s_cbranch_vccnz L_cl44
    s_branch L_co44
L_cs45:
    s_mov_b32 s87, 0
L_cl45:
    ds_read_b32 v21, v22
    s_add_u32 s87, s87, 1
    s_cmp_lt_u32 s87, 0x100000
    s_waitcnt lgkmcnt(0)
    s_cbranch_scc0 L_co45
    v_cmp_gt_u32 vcc, 21, v21
    s_cbranch_vccnz L_cl45
    s_branch L_co45
L_p_spin1:
    s_mov_b32 s87, 0
L_p_lp1:
    buffer_load_dwordx4 v[208:211], v10, s[56:59], s77 offen offset:0 sc1
    buffer_load_dwordx4 v[212:215], v10, s[56:59], s77 offen offset:1024 sc1
    buffer_load_dwordx4 v[216:219], v10, s[56:59], s77 offen offset:2048 sc1
    buffer_load_dwordx4 v[220:223], v10, s[56:59], s77 offen offset:3072 sc1
    buffer_load_dword v14, v11, s[56:59], s77 offen sc1
    s_add_u32 s87, s87, 1
    s_cmp_lt_u32 s87, 0x10000
    s_waitcnt vmcnt(0)
    s_cbranch_scc0 L_p_ok1
    v_bitop3_b32 v14, v208, v212, v14 bitop3:0x96
    v_bitop3_b32 v26, v209, v213, v217 bitop3:0x96
    v_bitop3_b32 v27, v210, v214, v218 bitop3:0x96
    v_bitop3_b32 v9, v211, v215, v219 bitop3:0x96
    v_bitop3_b32 v14, v216, v220, v14 bitop3:0x96
    v_xor_b32 v26, v221, v26
    v_xor_b32 v27, v222, v27
    v_xor_b32 v9, v223, v9
    v_alignbit_b32 v26, v26, v26, 5
    v_alignbit_b32 v27, v27, v27, 10
    v_alignbit_b32 v9, v9, v9, 15
    v_bitop3_b32 v14, v26, v27, v14 bitop3:0x96
    v_xor_b32 v14, v9, v14
    v_cmp_ne_u32 vcc, s53, v14
    s_cbranch_vccnz L_p_lp1
    s_branch L_p_ok1
L_p_spin2:
    s_mov_b32 s87, 0
L_p_lp2:
    buffer_load_dwordx4 v[192:195], v10, s[56:59], s78 offen offset:0 sc1
    buffer_load_dwordx4 v[196:199], v10, s[56:59], s78 offen offset:1024 sc1
    buffer_load_dwordx4 v[200:203], v10, s[56:59], s78 offen offset:2048 sc1
    buffer_load_dwordx4 v[204:207], v10, s[56:59], s78 offen offset:3072 sc1
    buffer_load_dword v14, v11, s[56:59], s78 offen sc1
    s_add_u32 s87, s87, 1
    s_cmp_lt_u32 s87, 0x10000
    s_waitcnt vmcnt(0)
    s_cbranch_scc0 L_p_ok2
    v_bitop3_b32 v14, v192, v196, v14 bitop3:0x96
    v_bitop3_b32 v26, v193, v197, v201 bitop3:0x96
    v_bitop3_b32 v27, v194, v198, v202 bitop3:0x96
    v_bitop3_b32 v9, v195, v199, v203 bitop3:0x96
    v_bitop3_b32 v14, v200, v204, v14 bitop3:0x96
    v_xor_b32 v26, v205, v26
    v_xor_b32 v27, v206, v27
    v_xor_b32 v9, v207, v9
    v_alignbit_b32 v26, v26, v26, 5
    v_alignbit_b32 v27, v27, v27, 10
    v_alignbit_b32 v9, v9, v9, 15
    v_bitop3_b32 v14, v26, v27, v14 bitop3:0x96
    v_xor_b32 v14, v9, v14
    v_cmp_ne_u32 vcc, s53, v14
    s_cbranch_vccnz L_p_lp2
    s_branch L_p_ok2
L_p_spin3:
    s_mov_b32 s87, 0
L_p_lp3:
    buffer_load_dwordx4 v[208:211], v10, s[56:59], s79 offen offset:0 sc1
    buffer_load_dwordx4 v[212:215], v10, s[56:59], s79 offen offset:1024 sc1
    buffer_load_dwordx4 v[216:219], v10, s[56:59], s79 offen offset:2048 sc1
    buffer_load_dwordx4 v[220:223], v10, s[56:59], s79 offen offset:3072 sc1
    buffer_load_dword v14, v11, s[56:59], s79 offen sc1
    s_add_u32 s87, s87, 1
    s_cmp_lt_u32 s87, 0x10000
    s_waitcnt vmcnt(0)
    s_cbranch_scc0 L_p_ok3
    v_bitop3_b32 v14, v208, v212, v14 bitop3:0x96
    v_bitop3_b32 v26, v209, v213, v217 bitop3:0x96
    v_bitop3_b32 v27, v210, v214, v218 bitop3:0x96
    v_bitop3_b32 v9, v211, v215, v219 bitop3:0x96
    v_bitop3_b32 v14, v216, v220, v14 bitop3:0x96
    v_xor_b32 v26, v221, v26
    v_xor_b32 v27, v222, v27
    v_xor_b32 v9, v223, v9
    v_alignbit_b32 v26, v26, v26, 5
    v_alignbit_b32 v27, v27, v27, 10
    v_alignbit_b32 v9, v9, v9, 15
    v_bitop3_b32 v14, v26, v27, v14 bitop3:0x96
    v_xor_b32 v14, v9, v14
    v_cmp_ne_u32 vcc, s53, v14
    s_cbranch_vccnz L_p_lp3
    s_branch L_p_ok3
L_cs46:
    s_mov_b32 s87, 0
L_cl46:
    ds_read_b32 v21, v22
    s_add_u32 s87, s87, 1
    s_cmp_lt_u32 s87, 0x100000
    s_waitcnt lgkmcnt(0)
    s_cbranch_scc0 L_co46
    v_cmp_gt_u32 vcc, 23, v21
    s_cbranch_vccnz L_cl46
    s_branch L_co46
L_cs47:
    s_mov_b32 s87, 0
L_cl47:
    ds_read_b32 v21, v22
    s_add_u32 s87, s87, 1
    s_cmp_lt_u32 s87, 0x100000
    s_waitcnt lgkmcnt(0)
    s_cbranch_scc0 L_co47
    v_cmp_gt_u32 vcc, 24, v21
    s_cbranch_vccnz L_cl47
    s_branch L_co47
L_cs48:
    s_mov_b32 s87, 0
L_cl48:
    ds_read_b32 v21, v22
    s_add_u32 s87, s87, 1
    s_cmp_lt_u32 s87, 0x100000
    s_waitcnt lgkmcnt(0)
    s_cbranch_scc0 L_co48
    v_cmp_gt_u32 vcc, 25, v21
    s_cbranch_vccnz L_cl48
    s_branch L_co48
L_cs49:
    s_mov_b32 s87, 0
L_cl49:
    ds_read_b32 v21, v22
    s_add_u32 s87, s87, 1
    s_cmp_lt_u32 s87, 0x100000
    s_waitcnt lgkmcnt(0)
    s_cbranch_scc0 L_co49
    v_cmp_gt_u32 vcc, 26, v21
    s_cbranch_vccnz L_cl49
    s_branch L_co49
L_cs50:
    s_mov_b32 s87, 0
L_cl50:
    ds_read_b32 v21, v22
    s_add_u32 s87, s87, 1
    s_cmp_lt_u32 s87, 0x100000
    s_waitcnt lgkmcnt(0)
    s_cbranch_scc0 L_co50
    v_cmp_gt_u32 vcc, 27, v21
    s_cbranch_vccnz L_cl50
    s_branch L_co50
L_cs51:
    s_mov_b32 s87, 0
L_cl51:
    ds_read_b32 v21, v22
    s_add_u32 s87, s87, 1
    s_cmp_lt_u32 s87, 0x100000
    s_waitcnt lgkmcnt(0)
    s_cbranch_scc0 L_co51
    v_cmp_gt_u32 vcc, 28, v21
    s_cbranch_vccnz L_cl51
    s_branch L_co51
L_cs52:
    s_mov_b32 s87, 0
L_cl52:
    ds_read_b32 v21, v22
    s_add_u32 s87, s87, 1
    s_cmp_lt_u32 s87, 0x100000
    s_waitcnt lgkmcnt(0)
    s_cbranch_scc0 L_co52
    v_cmp_gt_u32 vcc, 29, v21
    s_cbranch_vccnz L_cl52
    s_branch L_co52
L_cs53:
    s_mov_b32 s87, 0
L_cl53:
    ds_read_b32 v21, v22
    s_add_u32 s87, s87, 1
    s_cmp_lt_u32 s87, 0x100000
    s_waitcnt lgkmcnt(0)
    s_cbranch_scc0 L_co53
    v_cmp_gt_u32 vcc, 30, v21
    s_cbranch_vccnz L_cl53
    s_branch L_co53
L_cs54:
    s_mov_b32 s87, 0
L_cl54:
    ds_read_b32 v21, v22
    s_add_u32 s87, s87, 1
    s_cmp_lt_u32 s87, 0x100000
    s_waitcnt lgkmcnt(0)
    s_cbranch_scc0 L_co54
    v_cmp_gt_u32 vcc, 31, v21
    s_cbranch_vccnz L_cl54
    s_branch L_co54
L_cs55:
    s_mov_b32 s87, 0
L_cl55:
    ds_read_b32 v21, v22
    s_add_u32 s87, s87, 1
    s_cmp_lt_u32 s87, 0x100000
    s_waitcnt lgkmcnt(0)
    s_cbranch_scc0 L_co55
    v_cmp_gt_u32 vcc, 32, v21
    s_cbranch_vccnz L_cl55
    s_branch L_co55
L_cs56:
    s_mov_b32 s87, 0
L_cl56:
    ds_read_b32 v21, v22
    s_add_u32 s87, s87, 1
    s_cmp_lt_u32 s87, 0x100000
    s_waitcnt lgkmcnt(0)
    s_cbranch_scc0 L_co56
    v_cmp_gt_u32 vcc, 33, v21
    s_cbranch_vccnz L_cl56
    s_branch L_co56
L_cs57:
    s_mov_b32 s87, 0
L_cl57:
    ds_read_b32 v21, v22
    s_add_u32 s87, s87, 1
    s_cmp_lt_u32 s87, 0x100000
    s_waitcnt lgkmcnt(0)
    s_cbranch_scc0 L_co57
    v_cmp_gt_u32 vcc, 34, v21
    s_cbranch_vccnz L_cl57
    s_branch L_co57
L_cs58:
    s_mov_b32 s87, 0
L_cl58:
    ds_read_b32 v21, v22
    s_add_u32 s87, s87, 1
    s_cmp_lt_u32 s87, 0x100000
    s_waitcnt lgkmcnt(0)
    s_cbranch_scc0 L_co58
    v_cmp_gt_u32 vcc, 35, v21
    s_cbranch_vccnz L_cl58
    s_branch L_co58
L_end:
    s_endpgm
.section .rodata,"a"
.p2align 6
.amdhsa_kernel concat_heads__mha_block_cached__mha_block_cached__near_ridge_kernel
  .amdhsa_next_free_vgpr 256
  .amdhsa_next_free_sgpr 102
  .amdhsa_accum_offset 256
  .amdhsa_group_segment_fixed_size 0
  .amdhsa_kernarg_size 104
  .amdhsa_user_sgpr_count 2
  .amdhsa_user_sgpr_kernarg_segment_ptr 1
  .amdhsa_system_sgpr_workgroup_id_x 1
.end_amdhsa_kernel
```
